```python
import torch

def _softmax(x, axis=-1):
    return torch.softmax(x, dim=axis)
def _gelu(x):
    return torch.nn.functional.gelu(x, approximate="tanh")
def _silu(x):
    return torch.nn.functional.silu(x)
def _sigmoid(x):
    return torch.sigmoid(x)
def _layernorm(x, axis=-1, eps=1e-5):
    m = x.mean(dim=axis, keepdim=True)
    v = x.var(dim=axis, keepdim=True, unbiased=False)
    return (x - m) / torch.sqrt(v + eps)
def _scatter_add(tgt, idx, src, axis=0):
    return tgt.clone().index_add_(axis, idx, src)
def _segment_sum(src, seg, n):
    out = torch.zeros((n,) + src.shape[1:], dtype=src.dtype)
    return out.index_add_(0, seg, src)
def _pad(x, pw):
    flat = tuple(v for pair in reversed(pw) for v in pair)
    return torch.nn.functional.pad(x, flat)

kernel_name = 'gated_mix__softmax_full_mha__geglu_ffn__prompt'

def setup_inputs():

    _w = (lambda a: (lambda t: t.to(torch.bfloat16) if t.is_floating_point() else t)(torch.as_tensor(a)))
    def _A_setup():
        B, S, D = 1, 2048, 512
        return {
            "x": _w((lambda *s: torch.randn(*s, dtype=torch.bfloat16) * 0.05)(B, S, D)),
            "wqkv": _w((lambda *s: torch.randn(*s, dtype=torch.bfloat16) * 0.8)(D, 3 * D)),
            "wo": _w((lambda *s: torch.randn(*s, dtype=torch.bfloat16) * 0.05)(D, D)),
        }
    _A_in = _A_setup()

    def _B_setup():
        B, S, D, F = 1, 2048, 512, 1376
        return {
            "x": _w((lambda *s: torch.randn(*s, dtype=torch.bfloat16) * 0.05)(B, S, D)),
            "w_gate": _w((lambda *s: torch.randn(*s, dtype=torch.bfloat16) * 0.1)(D, F)),
            "w_up": _w((lambda *s: torch.randn(*s, dtype=torch.bfloat16) * 0.1)(D, F)),
            "w_down": _w((lambda *s: torch.randn(*s, dtype=torch.bfloat16) * 0.1)(F, D)),
        }
    _B_in = _B_setup()

    return {
        "A_x": _A_in["x"],
        "A_wqkv": _A_in["wqkv"],
        "A_wo": _A_in["wo"],
        "B_x": _B_in["x"],
        "B_w_gate": _B_in["w_gate"],
        "B_w_up": _B_in["w_up"],
        "B_w_down": _B_in["w_down"],
        "gate_w": _w((lambda *s: torch.randn(*s, dtype=torch.bfloat16) * 0.05)(512) * 16.0),
    }

def reference(A_x, A_wqkv, A_wo, B_x, B_w_gate, B_w_up, B_w_down, gate_w):
    def _A_ref(x, wqkv, wo):
        B, S, D = x.shape
        H = 32; Dh = D // H
        qkv = (lambda x, *d: x.permute(*d))((x @ wqkv).reshape(B, S, 3, H, Dh), 2, 0, 3, 1, 4)
        q, k, v = qkv[0], qkv[1], qkv[2]
        scale = Dh ** -0.5
        scores = torch.einsum("bhqd,bhkd->bhqk", q, k) * scale
        p = _softmax(scores, axis=-1)
        o = torch.einsum("bhqk,bhkd->bhqd", p, v)
        return (lambda x, *d: x.permute(*d))(o, 0, 2, 1, 3).reshape(B, S, D) @ wo

    def _B_ref(x, w_gate, w_up, w_down):
        return (_gelu(x @ w_gate) * (x @ w_up)) @ w_down

    x = A_x
    g = _sigmoid((x * gate_w).sum(-1, keepdims=True))
    a = _A_ref(x, A_wqkv, A_wo)
    b = _B_ref(x, B_w_gate, B_w_up, B_w_down)
    return g * a + (1 - g) * b
```

```asm
; @launch grid=(256,1,1) block=(512,1,1) lds=163040
.amdgcn_target "amdgcn-amd-amdhsa--gfx950"
.text
.globl gated_mix__softmax_full_mha__geglu_ffn__prompt_kernel
.p2align 12
.fill 832, 4, 0xbf810000
.p2align 8
.type gated_mix__softmax_full_mha__geglu_ffn__prompt_kernel,@function
gated_mix__softmax_full_mha__geglu_ffn__prompt_kernel:
    s_cmp_ge_u32 s2, 256
    s_cbranch_scc1 K_END0
    s_load_dwordx4 s[40:43], s[0:1], 0
    s_load_dwordx2 s[44:45], s[0:1], 16
    s_load_dwordx4 s[48:51], s[0:1], 32
    s_load_dwordx4 s[52:55], s[0:1], 48
    s_load_dwordx4 s[56:59], s[0:1], 64
    s_load_dwordx2 s[60:61], s[0:1], 80
    v_lshrrev_b32 v1, 6, v0
    v_and_b32 v249, 63, v0
    v_readfirstlane_b32 s24, v1
    v_lshlrev_b32 v250, 4, v249
    s_and_b32 s25, s2, 7
    s_lshr_b32 s26, s2, 3
    s_and_b32 s27, s25, 1
    s_lshl_b32 s27, s27, 3
    s_and_b32 s32, s26, 7
    s_add_u32 s27, s27, s32
    s_lshr_b32 s28, s25, 1
    s_lshl_b32 s28, s28, 2
    s_lshr_b32 s33, s26, 3
    s_add_u32 s28, s28, s33
    s_lshl_b32 s33, s33, 2
    s_add_u32 s29, s32, s33
    s_and_b32 s32, s26, 3
    s_lshl_b32 s30, s25, 2
    s_add_u32 s30, s30, s32
    s_lshr_b32 s31, s26, 2
    s_cmp_lg_u32 s24, 0
    s_cbranch_scc1 C_NOCPF
    s_getpc_b64 s[4:5]
C_PC:
    s_sub_u32 s4, s4, C_PC-gated_mix__softmax_full_mha__geglu_ffn__prompt_kernel
    s_subb_u32 s5, s5, 0
    s_mov_b32 s6, K_LAST-gated_mix__softmax_full_mha__geglu_ffn__prompt_kernel
    s_mov_b32 s7, 0x00020000
    s_and_b32 s32, s26, 7
    s_lshl_b32 s32, s32, 13
    v_lshlrev_b32 v1, 7, v249
    buffer_load_dword v247, v1, s[4:7], s32 offen
C_NOCPF:
    s_cmp_lt_u32 s24, 4
    s_cbranch_scc1 COMP
    s_and_b32 s36, s24, 3
    s_lshl_b32 s32, s36, 15
    s_lshl_b32 s69, s36, 12
    s_lshl_b32 s37, s27, 17
    s_add_u32 s37, s37, s32
    v_lshrrev_b32 v190, 4, v249
    v_and_b32 v191, 7, v249
    v_xor_b32 v190, v190, v191
    v_lshlrev_b32 v190, 4, v190
    v_lshrrev_b32 v191, 3, v249
    v_lshl_add_u32 v160, v191, 10, v190
    v_xor_b32 v161, 64, v160
    v_add_u32 v161, 7168, v161
    v_add_u32 v162, 14336, v160
    v_add_u32 v163, 14336, v161
    s_mov_b32 s6, 2097152
    s_mov_b32 s7, 0x00020000
    s_mov_b32 s10, 1572864
    s_mov_b32 s11, 0x00020000
    s_mov_b32 s32, 21846
    s_mov_b32 s33, 2880
    v_add_u32 v190, 0, v249
    v_mul_u32_u24 v176, s32, v190
    v_lshrrev_b32 v176, 18, v176
    v_mad_u32_u24 v164, v176, s33, v250
    v_add_u32 v190, 64, v249
    v_mul_u32_u24 v177, s32, v190
    v_lshrrev_b32 v177, 18, v177
    v_mad_u32_u24 v165, v177, s33, v250
    v_add_u32 v190, 128, v249
    v_mul_u32_u24 v178, s32, v190
    v_lshrrev_b32 v178, 18, v178
    v_mad_u32_u24 v166, v178, s33, v250
    s_and_b32 s35, s24, 1
    s_mul_i32 s70, s35, 3104
    s_lshr_b32 s32, s36, 1
    s_mul_i32 s68, s32, 6176
    s_add_u32 s68, s68, s70
    s_mul_i32 s38, s36, 49152
    s_mul_i32 s32, s28, 192
    s_add_u32 s38, s38, s32
    s_waitcnt lgkmcnt(0)
    s_mov_b32 s4, s40
    s_mov_b32 s5, s41
    s_mov_b32 s8, s42
    s_mov_b32 s9, s43
    s_add_u32 s62, s29, 0
    s_and_b32 s62, s62, 7
    s_lshl_b32 s62, s62, 7
    s_add_u32 m0, s69, 0
    s_add_u32 s62, s62, s37
    buffer_load_dwordx4 v160, s[4:7], s62 offen offset:0 lds
    buffer_load_dwordx4 v161, s[4:7], s62 offen offset:1024 lds
    buffer_load_dwordx4 v162, s[4:7], s62 offen offset:2048 lds
    buffer_load_dwordx4 v163, s[4:7], s62 offen offset:3072 lds
    s_add_u32 s71, s29, 0
    s_and_b32 s71, s71, 7
    s_mul_i32 s71, s71, 196608
    s_add_u32 m0, s68, 131072
    s_add_u32 s71, s71, s38
    buffer_load_dwordx4 v164, s[8:11], s71 offen offset:0 lds
    buffer_load_dwordx4 v165, s[8:11], s71 offen offset:1024 lds
    buffer_load_dwordx4 v166, s[8:11], s71 offen offset:2048 lds
    s_add_u32 s62, s29, 1
    s_and_b32 s62, s62, 7
    s_lshl_b32 s62, s62, 7
    s_add_u32 m0, s69, 16384
    s_add_u32 s62, s62, s37
    buffer_load_dwordx4 v160, s[4:7], s62 offen offset:0 lds
    buffer_load_dwordx4 v161, s[4:7], s62 offen offset:1024 lds
    buffer_load_dwordx4 v162, s[4:7], s62 offen offset:2048 lds
    buffer_load_dwordx4 v163, s[4:7], s62 offen offset:3072 lds
    s_lshl_b32 s36, s36, 10
    s_mov_b32 s34, 2560
    s_mov_b32 s12, s60
    s_mov_b32 s13, s61
    s_mov_b32 s14, 25165824
    s_mov_b32 s15, 0x00020000
    s_cmp_eq_u32 s35, 0
    s_cselect_b32 s16, s48, s50
    s_cselect_b32 s17, s49, s51
    s_mov_b32 s18, 1409024
    s_mov_b32 s19, 0x00020000
    s_mul_i32 s39, s28, 5
    s_min_u32 s32, s28, 6
    s_add_u32 s39, s39, s32
    s_lshl_b32 s39, s39, 5
    s_bfe_u32 s32, s24, 0x10001
    s_mul_i32 s32, s32, 44032
    s_add_u32 s39, s39, s32
    s_cmp_lt_u32 s28, 6
    s_mov_b32 s32, 160
    s_cmov_b32 s32, 192
    v_mov_b32 v192, 2147483648
    v_mad_u32_u24 v167, v176, s34, v250
    v_mul_u32_u24 v190, 192, v176
    v_sub_u32 v190, v250, v190
    v_add_u32 v190, 0, v190
    v_cmp_gt_u32 vcc, s32, v190
    s_nop 1
    v_cndmask_b32 v167, v192, v167, vcc
    v_mad_u32_u24 v168, v177, s34, v250
    v_mul_u32_u24 v190, 192, v177
    v_sub_u32 v190, v250, v190
    v_add_u32 v190, 1024, v190
    v_cmp_gt_u32 vcc, s32, v190
    s_nop 1
    v_cndmask_b32 v168, v192, v168, vcc
    v_mad_u32_u24 v169, v178, s34, v250
    v_mul_u32_u24 v190, 192, v178
    v_sub_u32 v190, v250, v190
    v_add_u32 v190, 2048, v190
    v_cmp_gt_u32 vcc, s32, v190
    s_nop 1
    v_cndmask_b32 v169, v192, v169, vcc
    s_cmp_ge_u32 s24, 6
    s_cbranch_scc1 LB
    s_add_u32 s71, s29, 1
    s_and_b32 s71, s71, 7
    s_mul_i32 s71, s71, 196608
    s_add_u32 m0, s70, 143424
    s_add_u32 s71, s71, s38
    buffer_load_dwordx4 v164, s[8:11], s71 offen offset:0 lds
    buffer_load_dwordx4 v165, s[8:11], s71 offen offset:1024 lds
    buffer_load_dwordx4 v166, s[8:11], s71 offen offset:2048 lds
    s_waitcnt vmcnt(10)
    s_waitcnt vmcnt(7)
    s_barrier
    s_add_u32 s62, s29, 2
    s_and_b32 s62, s62, 7
    s_lshl_b32 s62, s62, 7
    s_add_u32 m0, s69, 32768
    s_add_u32 s62, s62, s37
    buffer_load_dwordx4 v160, s[4:7], s62 offen offset:0 lds
    buffer_load_dwordx4 v161, s[4:7], s62 offen offset:1024 lds
    buffer_load_dwordx4 v162, s[4:7], s62 offen offset:2048 lds
    buffer_load_dwordx4 v163, s[4:7], s62 offen offset:3072 lds
    s_add_u32 s71, s29, 2
    s_and_b32 s71, s71, 7
    s_mul_i32 s71, s71, 196608
    s_add_u32 m0, s70, 155776
    s_add_u32 s71, s71, s38
    buffer_load_dwordx4 v164, s[8:11], s71 offen offset:0 lds
    buffer_load_dwordx4 v165, s[8:11], s71 offen offset:1024 lds
    buffer_load_dwordx4 v166, s[8:11], s71 offen offset:2048 lds
    s_barrier
    s_waitcnt vmcnt(10)
    s_waitcnt vmcnt(7)
    s_barrier
    s_add_u32 s62, s29, 3
    s_and_b32 s62, s62, 7
    s_lshl_b32 s62, s62, 7
    s_add_u32 m0, s69, 49152
    s_add_u32 s62, s62, s37
    buffer_load_dwordx4 v160, s[4:7], s62 offen offset:0 lds
    buffer_load_dwordx4 v161, s[4:7], s62 offen offset:1024 lds
    buffer_load_dwordx4 v162, s[4:7], s62 offen offset:2048 lds
    buffer_load_dwordx4 v163, s[4:7], s62 offen offset:3072 lds
    s_add_u32 s71, s29, 3
    s_and_b32 s71, s71, 7
    s_mul_i32 s71, s71, 196608
    s_add_u32 m0, s70, 104480
    s_add_u32 s71, s71, s38
    buffer_load_dwordx4 v164, s[8:11], s71 offen offset:0 lds
    buffer_load_dwordx4 v165, s[8:11], s71 offen offset:1024 lds
    buffer_load_dwordx4 v166, s[8:11], s71 offen offset:2048 lds
    s_barrier
    s_waitcnt vmcnt(10)
    s_waitcnt vmcnt(7)
    s_barrier
    s_add_u32 s71, s29, 0
    s_and_b32 s71, s71, 7
    s_mul_i32 s71, s71, 176128
    s_add_u32 m0, s70, 120864
    s_add_u32 s71, s71, s39
    buffer_load_dwordx4 v167, s[16:19], s71 offen offset:0 lds
    buffer_load_dwordx4 v168, s[16:19], s71 offen offset:1024 lds
    buffer_load_dwordx4 v169, s[16:19], s71 offen offset:2048 lds
    s_add_u32 s62, s29, 4
    s_and_b32 s62, s62, 7
    s_lshl_b32 s62, s62, 7
    s_add_u32 m0, s69, 65536
    s_add_u32 s62, s62, s37
    buffer_load_dwordx4 v160, s[4:7], s62 offen offset:0 lds
    buffer_load_dwordx4 v161, s[4:7], s62 offen offset:1024 lds
    buffer_load_dwordx4 v162, s[4:7], s62 offen offset:2048 lds
    buffer_load_dwordx4 v163, s[4:7], s62 offen offset:3072 lds
    s_barrier
    s_waitcnt vmcnt(10)
    s_waitcnt vmcnt(7)
    s_barrier
    s_add_u32 s71, s29, 4
    s_and_b32 s71, s71, 7
    s_mul_i32 s71, s71, 196608
    s_add_u32 m0, s70, 137248
    s_add_u32 s71, s71, s38
    buffer_load_dwordx4 v164, s[8:11], s71 offen offset:0 lds
    buffer_load_dwordx4 v165, s[8:11], s71 offen offset:1024 lds
    buffer_load_dwordx4 v166, s[8:11], s71 offen offset:2048 lds
    s_mov_b32 s20, s54
    s_mov_b32 s21, s55
    s_mov_b32 s22, 1024
    s_mov_b32 s23, 0x00020000
    s_lshl_b32 s32, s29, 7
    v_add_u32 v190, s32, v250
    v_and_b32 v190, 1023, v190
    s_mov_b32 m0, 161952
    s_nop 0
    buffer_load_dwordx4 v190, s[20:23], 0 offen lds
    s_add_u32 s71, s29, 0
    s_and_b32 s71, s71, 7
    s_mul_i32 s71, s71, 176128
    s_add_u32 s71, s71, 88064
    s_add_u32 m0, s70, 149600
    s_add_u32 s71, s71, s39
    buffer_load_dwordx4 v167, s[16:19], s71 offen offset:0 lds
    buffer_load_dwordx4 v168, s[16:19], s71 offen offset:1024 lds
    buffer_load_dwordx4 v169, s[16:19], s71 offen offset:2048 lds
    s_barrier
    s_waitcnt vmcnt(11)
    s_barrier
    s_barrier
    s_waitcnt vmcnt(7)
    s_waitcnt vmcnt(4)
    s_barrier
    s_add_u32 s62, s29, 5
    s_and_b32 s62, s62, 7
    s_lshl_b32 s62, s62, 7
    s_add_u32 m0, s69, 81920
    s_add_u32 s62, s62, s37
    buffer_load_dwordx4 v160, s[4:7], s62 offen offset:0 lds
    buffer_load_dwordx4 v161, s[4:7], s62 offen offset:1024 lds
    buffer_load_dwordx4 v162, s[4:7], s62 offen offset:2048 lds
    buffer_load_dwordx4 v163, s[4:7], s62 offen offset:3072 lds
    s_add_u32 s71, s29, 5
    s_and_b32 s71, s71, 7
    s_mul_i32 s71, s71, 196608
    s_add_u32 m0, s70, 114688
    s_add_u32 s71, s71, s38
    buffer_load_dwordx4 v164, s[8:11], s71 offen offset:0 lds
    buffer_load_dwordx4 v165, s[8:11], s71 offen offset:1024 lds
    buffer_load_dwordx4 v166, s[8:11], s71 offen offset:2048 lds
    s_barrier
    s_add_u32 s71, s29, 1
    s_and_b32 s71, s71, 7
    s_mul_i32 s71, s71, 176128
    s_add_u32 m0, s70, 131072
    s_add_u32 s71, s71, s39
    buffer_load_dwordx4 v167, s[16:19], s71 offen offset:0 lds
    buffer_load_dwordx4 v168, s[16:19], s71 offen offset:1024 lds
    buffer_load_dwordx4 v169, s[16:19], s71 offen offset:2048 lds
    s_waitcnt vmcnt(10)
    s_barrier
    s_add_u32 s62, s29, 6
    s_and_b32 s62, s62, 7
    s_lshl_b32 s62, s62, 7
    s_add_u32 m0, s69, 98304
    s_add_u32 s62, s62, s37
    buffer_load_dwordx4 v160, s[4:7], s62 offen offset:0 lds
    buffer_load_dwordx4 v161, s[4:7], s62 offen offset:1024 lds
    buffer_load_dwordx4 v162, s[4:7], s62 offen offset:2048 lds
    buffer_load_dwordx4 v163, s[4:7], s62 offen offset:3072 lds
    s_barrier
    s_lshl_b32 s32, s28, 3
    v_lshrrev_b32 v190, 3, v249
    v_add_u32 v190, s32, v190
    v_bfe_u32 v191, v190, 1, 3
    v_and_b32 v192, 7, v249
    v_xor_b32 v191, v191, v192
    v_lshlrev_b32 v191, 4, v191
    v_lshl_add_u32 v173, v190, 7, v191
    v_lshlrev_b32 v189, 4, v192
    v_add_u32 v189, 161952, v189
    v_mov_b32 v188, 0
    s_waitcnt vmcnt(10)
    s_waitcnt vmcnt(7)
    s_barrier
    s_add_u32 s71, s29, 6
    s_and_b32 s71, s71, 7
    s_mul_i32 s71, s71, 196608
    s_add_u32 m0, s70, 143424
    s_add_u32 s71, s71, s38
    buffer_load_dwordx4 v164, s[8:11], s71 offen offset:0 lds
    buffer_load_dwordx4 v165, s[8:11], s71 offen offset:1024 lds
    buffer_load_dwordx4 v166, s[8:11], s71 offen offset:2048 lds
    s_add_u32 s71, s29, 1
    s_and_b32 s71, s71, 7
    s_mul_i32 s71, s71, 176128
    s_add_u32 s71, s71, 88064
    s_add_u32 m0, s70, 155776
    s_add_u32 s71, s71, s39
    buffer_load_dwordx4 v167, s[16:19], s71 offen offset:0 lds
    buffer_load_dwordx4 v168, s[16:19], s71 offen offset:1024 lds
    buffer_load_dwordx4 v169, s[16:19], s71 offen offset:2048 lds
    ds_read_b128 v[0:3], v173 offset:0
    ds_read_b128 v[4:7], v189 offset:0
    s_barrier
    s_waitcnt lgkmcnt(0)
    v_dot2_f32_bf16 v64, v0, v4, 0
    v_dot2_f32_bf16 v65, v1, v5, 0
    s_waitcnt vmcnt(10)
    s_barrier
    v_dot2_f32_bf16 v66, v2, v6, 0
    v_dot2_f32_bf16 v67, v3, v7, 0
    ds_read_b128 v[8:11], v173 offset:16384
    ds_read_b128 v[12:15], v189 offset:128
    s_barrier
    s_add_u32 s62, s29, 7
    s_and_b32 s62, s62, 7
    s_lshl_b32 s62, s62, 7
    s_add_u32 m0, s69, 114688
    s_add_u32 s62, s62, s37
    buffer_load_dwordx4 v160, s[4:7], s62 offen offset:0 lds
    buffer_load_dwordx4 v161, s[4:7], s62 offen offset:1024 lds
    buffer_load_dwordx4 v162, s[4:7], s62 offen offset:2048 lds
    buffer_load_dwordx4 v163, s[4:7], s62 offen offset:3072 lds
    s_waitcnt lgkmcnt(0)
    v_dot2_f32_bf16 v64, v8, v12, v64
    v_dot2_f32_bf16 v65, v9, v13, v65
    s_waitcnt vmcnt(10)
    s_waitcnt vmcnt(7)
    s_barrier
    s_add_u32 s71, s29, 7
    s_and_b32 s71, s71, 7
    s_mul_i32 s71, s71, 196608
    s_add_u32 m0, s70, 6176
    s_add_u32 s71, s71, s38
    buffer_load_dwordx4 v164, s[8:11], s71 offen offset:0 lds
    buffer_load_dwordx4 v165, s[8:11], s71 offen offset:1024 lds
    buffer_load_dwordx4 v166, s[8:11], s71 offen offset:2048 lds
    s_add_u32 s71, s29, 2
    s_and_b32 s71, s71, 7
    s_mul_i32 s71, s71, 176128
    s_add_u32 m0, s70, 137248
    s_add_u32 s71, s71, s39
    buffer_load_dwordx4 v167, s[16:19], s71 offen offset:0 lds
    buffer_load_dwordx4 v168, s[16:19], s71 offen offset:1024 lds
    buffer_load_dwordx4 v169, s[16:19], s71 offen offset:2048 lds
    v_dot2_f32_bf16 v66, v10, v14, v66
    v_dot2_f32_bf16 v67, v11, v15, v67
    ds_read_b128 v[16:19], v173 offset:32768
    ds_read_b128 v[20:23], v189 offset:256
    s_barrier
    s_waitcnt lgkmcnt(0)
    v_dot2_f32_bf16 v64, v16, v20, v64
    v_dot2_f32_bf16 v65, v17, v21, v65
    s_waitcnt vmcnt(10)
    s_barrier
    v_dot2_f32_bf16 v66, v18, v22, v66
    v_dot2_f32_bf16 v67, v19, v23, v67
    ds_read_b128 v[24:27], v173 offset:49152
    ds_read_b128 v[28:31], v189 offset:384
    s_barrier
    s_add_u32 m0, s70, 149600
    s_add_u32 s71, s71, 88064
    buffer_load_dwordx4 v167, s[16:19], s71 offen offset:0 lds
    buffer_load_dwordx4 v168, s[16:19], s71 offen offset:1024 lds
    buffer_load_dwordx4 v169, s[16:19], s71 offen offset:2048 lds
    s_waitcnt lgkmcnt(0)
    v_dot2_f32_bf16 v64, v24, v28, v64
    v_dot2_f32_bf16 v65, v25, v29, v65
    s_waitcnt vmcnt(9)
    s_waitcnt vmcnt(6)
    s_barrier
    s_add_u32 s71, s29, 3
    s_and_b32 s71, s71, 7
    s_mul_i32 s71, s71, 176128
    s_add_u32 m0, s70, 0
    s_add_u32 s71, s71, s39
    buffer_load_dwordx4 v167, s[16:19], s71 offen offset:0 lds
    buffer_load_dwordx4 v168, s[16:19], s71 offen offset:1024 lds
    buffer_load_dwordx4 v169, s[16:19], s71 offen offset:2048 lds
    v_dot2_f32_bf16 v66, v26, v30, v66
    v_dot2_f32_bf16 v67, v27, v31, v67
    v_add_u32 v173, 65536, v173
    ds_read_b128 v[32:35], v173 offset:0
    ds_read_b128 v[36:39], v189 offset:512
    s_barrier
    s_add_u32 m0, s70, 22560
    s_add_u32 s71, s71, 88064
    buffer_load_dwordx4 v167, s[16:19], s71 offen offset:0 lds
    buffer_load_dwordx4 v168, s[16:19], s71 offen offset:1024 lds
    buffer_load_dwordx4 v169, s[16:19], s71 offen offset:2048 lds
    s_waitcnt lgkmcnt(0)
    v_dot2_f32_bf16 v64, v32, v36, v64
    v_dot2_f32_bf16 v65, v33, v37, v65
    s_waitcnt vmcnt(9)
    s_barrier
    v_dot2_f32_bf16 v66, v34, v38, v66
    v_dot2_f32_bf16 v67, v35, v39, v67
    ds_read_b128 v[40:43], v173 offset:16384
    ds_read_b128 v[44:47], v189 offset:640
    s_barrier
    s_add_u32 s71, s29, 4
    s_and_b32 s71, s71, 7
    s_mul_i32 s71, s71, 176128
    s_add_u32 m0, s70, 131072
    s_add_u32 s71, s71, s39
    buffer_load_dwordx4 v167, s[16:19], s71 offen offset:0 lds
    buffer_load_dwordx4 v168, s[16:19], s71 offen offset:1024 lds
    buffer_load_dwordx4 v169, s[16:19], s71 offen offset:2048 lds
    s_waitcnt lgkmcnt(0)
    v_dot2_f32_bf16 v64, v40, v44, v64
    v_dot2_f32_bf16 v65, v41, v45, v65
    s_waitcnt vmcnt(9)
    s_barrier
    s_add_u32 m0, s70, 143424
    s_add_u32 s71, s71, 88064
    buffer_load_dwordx4 v167, s[16:19], s71 offen offset:0 lds
    buffer_load_dwordx4 v168, s[16:19], s71 offen offset:1024 lds
    buffer_load_dwordx4 v169, s[16:19], s71 offen offset:2048 lds
    v_dot2_f32_bf16 v66, v42, v46, v66
    v_dot2_f32_bf16 v67, v43, v47, v67
    ds_read_b128 v[48:51], v173 offset:32768
    ds_read_b128 v[52:55], v189 offset:768
    s_barrier
    s_waitcnt lgkmcnt(0)
    v_dot2_f32_bf16 v64, v48, v52, v64
    v_dot2_f32_bf16 v65, v49, v53, v65
    s_waitcnt vmcnt(9)
    s_barrier
    s_add_u32 s71, s29, 5
    s_and_b32 s71, s71, 7
    s_mul_i32 s71, s71, 176128
    s_add_u32 m0, s70, 155776
    s_add_u32 s71, s71, s39
    buffer_load_dwordx4 v167, s[16:19], s71 offen offset:0 lds
    buffer_load_dwordx4 v168, s[16:19], s71 offen offset:1024 lds
    buffer_load_dwordx4 v169, s[16:19], s71 offen offset:2048 lds
    v_dot2_f32_bf16 v66, v50, v54, v66
    v_dot2_f32_bf16 v67, v51, v55, v67
    ds_read_b128 v[56:59], v173 offset:49152
    ds_read_b128 v[60:63], v189 offset:896
    s_barrier
    s_waitcnt lgkmcnt(0)
    v_dot2_f32_bf16 v64, v56, v60, v64
    v_dot2_f32_bf16 v65, v57, v61, v65
    s_waitcnt vmcnt(9)
    s_barrier
    s_add_u32 m0, s70, 32768
    s_add_u32 s71, s71, 88064
    buffer_load_dwordx4 v167, s[16:19], s71 offen offset:0 lds
    buffer_load_dwordx4 v168, s[16:19], s71 offen offset:1024 lds
    buffer_load_dwordx4 v169, s[16:19], s71 offen offset:2048 lds
    v_dot2_f32_bf16 v66, v58, v62, v66
    v_dot2_f32_bf16 v67, v59, v63, v67
    s_barrier
    v_add_f32 v64, v64, v65
    v_add_f32 v66, v66, v67
    s_nop 0
    v_add_f32 v188, v64, v66
    s_nop 1
    v_add_f32_dpp v188, v188, v188 quad_perm:[1,0,3,2] row_mask:0xf bank_mask:0xf
    s_nop 1
    v_add_f32_dpp v188, v188, v188 quad_perm:[2,3,0,1] row_mask:0xf bank_mask:0xf
    s_nop 1
    v_add_f32_dpp v188, v188, v188 row_half_mirror row_mask:0xf bank_mask:0xf
    s_nop 1
    v_mul_f32 v188, 0xbfb8aa3b, v188
    v_exp_f32 v188, v188
    s_nop 0
    v_add_f32 v188, 1.0, v188
    v_rcp_f32 v188, v188
    v_and_b32 v190, 7, v249
    v_cmp_eq_u32 vcc, 0, v190
    v_lshrrev_b32 v190, 1, v249
    v_mov_b32 v191, 2147483648
    v_cndmask_b32 v189, v191, v190, vcc
    s_waitcnt vmcnt(9)
    s_barrier
    s_add_u32 s71, s29, 6
    s_and_b32 s71, s71, 7
    s_mul_i32 s71, s71, 176128
    s_add_u32 m0, s70, 16384
    s_add_u32 s71, s71, s39
    buffer_load_dwordx4 v167, s[16:19], s71 offen offset:0 lds
    buffer_load_dwordx4 v168, s[16:19], s71 offen offset:1024 lds
    buffer_load_dwordx4 v169, s[16:19], s71 offen offset:2048 lds
    v_mov_b32 v190, 162976
    ds_read_b64 v[236:237], v190
    s_barrier
    s_lshr_b32 s32, s30, 1
    s_add_u32 s33, s32, 16
    s_mul_i32 s33, s33, 43
    s_lshr_b32 s33, s33, 7
    s_add_u32 s34, s32, 32
    s_mul_i32 s34, s34, 43
    s_lshr_b32 s34, s34, 7
    s_mul_i32 s32, s32, 43
    s_lshr_b32 s32, s32, 7
    v_mov_b32 v190, s34
    v_mov_b32 v191, s33
    v_cmp_gt_u32 vcc, 16, v249
    s_nop 1
    v_cndmask_b32 v190, v190, v191, vcc
    s_lshl_b32 s33, s31, 1
    v_and_b32 v191, 1, v249
    v_add_u32 v191, s33, v191
    v_and_b32 v192, 15, v249
    v_mov_b32 v172, s32
    v_cmp_gt_u32 vcc, 32, v249
    s_nop 1
    v_cndmask_b32 v190, v172, v190, vcc
    v_cndmask_b32 v191, v191, v192, vcc
    s_waitcnt vmcnt(9)
    s_barrier
    s_add_u32 m0, s70, 6176
    s_add_u32 s71, s71, 88064
    buffer_load_dwordx4 v167, s[16:19], s71 offen offset:0 lds
    buffer_load_dwordx4 v168, s[16:19], s71 offen offset:1024 lds
    buffer_load_dwordx4 v169, s[16:19], s71 offen offset:2048 lds
    v_lshlrev_b32 v191, 3, v191
    s_lshr_b32 s32, s36, 3
    v_lshl_add_u32 v190, v190, 9, s32
    v_add_u32 v172, v190, v191
    s_barrier
    s_waitcnt lgkmcnt(0)
    s_lshr_b32 s32, s30, 1
    s_lshl_b32 s32, s32, 7
    v_and_b32 v238, 15, v249
    v_lshl_add_u32 v232, v238, 3, s32
    s_lshl_b32 s32, s31, 8
    v_cmp_gt_u32 vcc, 32, v249
    v_and_b32 v238, 31, v249
    v_lshl_add_u32 v238, v238, 3, s32
    v_cndmask_b32 v232, v238, v232, vcc
    s_lshr_b32 s32, s30, 2
    v_cmp_gt_u32 vcc, 32, v249
    v_mov_b32 v238, s32
    v_mov_b32 v239, s31
    v_cndmask_b32 v238, v239, v238, vcc
    v_and_b32 v239, 31, v249
    v_lshl_add_u32 v238, v238, 5, v239
    v_add_u32 v238, 256, v238
    v_lshlrev_b32 v233, 3, v238
    s_lshl_b32 s32, s27, 4
    s_add_u32 s32, s32, s28
    s_lshl_b32 s32, s32, 3
    s_lshl_b32 s33, s31, 5
    s_add_u32 s33, s33, s30
    s_add_u32 s33, s33, 256
    s_lshl_b32 s33, s33, 3
    v_mov_b32 v248, 2147483648
    v_writelane_b32 v248, s32, 0
    v_writelane_b32 v248, s33, 1
    s_waitcnt vmcnt(9)
    s_barrier
    s_add_u32 s71, s29, 7
    s_and_b32 s71, s71, 7
    s_mul_i32 s71, s71, 176128
    s_add_u32 m0, s70, 137248
    s_add_u32 s71, s71, s39
    buffer_load_dwordx4 v167, s[16:19], s71 offen offset:0 lds
    buffer_load_dwordx4 v168, s[16:19], s71 offen offset:1024 lds
    buffer_load_dwordx4 v169, s[16:19], s71 offen offset:2048 lds
    s_lshl_b32 s32, s31, 3
    s_and_b32 s33, s24, 3
    s_add_u32 s32, s32, s33
    s_lshl_b32 s32, s32, 15
    s_lshl_b32 s33, s30, 10
    s_add_u32 s32, s32, s33
    s_add_u32 s54, s32, 16777216
    s_add_u32 s55, s54, 131072
    v_mov_b32 v72, -1
    v_mov_b32 v73, -1
    v_mov_b32 v74, -1
    v_mov_b32 v75, -1
    s_lshl_b32 s32, s30, 2
    s_and_b32 s33, s24, 3
    s_add_u32 s32, s32, s33
    s_cmp_lt_u32 s32, 86
    s_cselect_b32 s44, s52, s44
    s_cselect_b32 s45, s53, s45
    s_mov_b32 s46, 524288
    s_cmov_b32 s46, 1409024
    s_mov_b32 s47, 0x00020000
    s_cselect_b32 s33, 0, 86
    s_mov_b32 s66, 32768
    s_cmov_b32 s66, 88064
    s_mov_b32 s65, 14680064
    s_cmov_b32 s65, 12582912
    s_sub_u32 s33, s32, s33
    s_lshl_b32 s64, s33, 14
    s_lshl_b32 s34, s31, 7
    s_add_u32 s64, s64, s34
    s_lshl_b32 s34, s31, 1
    s_mul_i32 s34, s34, s66
    s_add_u32 s65, s65, s34
    s_lshl_b32 s34, s33, 10
    s_add_u32 s65, s65, s34
    s_cmp_lt_u32 s32, 118
    s_cselect_b32 s64, s64, 0x40000000
    s_cselect_b32 s65, s65, 0x40000000
    s_barrier
    buffer_store_dwordx4 v[72:75], v250, s[12:15], s54 offen sc1
    v_lshrrev_b32 v190, 5, v249
    v_bfe_u32 v191, v249, 2, 2
    v_lshl_add_u32 v170, v190, 2, v191
    v_lshlrev_b32 v170, 10, v170
    v_lshlrev_b32 v171, 9, v190
    v_lshl_add_u32 v171, v191, 6, v171
    v_bfe_u32 v190, v249, 4, 1
    v_lshl_add_u32 v170, v190, 6, v170
    v_lshl_add_u32 v171, v190, 5, v171
    v_and_b32 v190, 3, v249
    v_lshl_add_u32 v170, v190, 4, v170
    v_lshl_add_u32 v171, v190, 3, v171
    s_lshl_b32 s32, s36, 1
    s_add_u32 s32, s32, 131072
    v_add_u32 v171, s32, v171
    s_waitcnt vmcnt(10)
    s_barrier
    s_add_u32 m0, s70, 149600
    s_add_u32 s71, s71, 88064
    buffer_load_dwordx4 v167, s[16:19], s71 offen offset:0 lds
    buffer_load_dwordx4 v168, s[16:19], s71 offen offset:1024 lds
    buffer_load_dwordx4 v169, s[16:19], s71 offen offset:2048 lds
    v_min_u32 v251, 1, v249
    v_lshlrev_b32 v251, 31, v251
    s_mov_b32 s4, 0x0000ffff
    s_mov_b32 s5, 0x0000ffff
    s_lshl_b32 s32, s31, 3
    s_add_u32 s32, s32, s24
    s_lshl_b32 s8, s32, 15
    s_lshl_b32 s33, s30, 10
    s_add_u32 s8, s8, s33
    s_add_u32 s8, s8, 16777216
    s_lshl_b32 s67, s30, 17
    s_add_u32 s67, s67, 2097152
    s_lshr_b32 s11, s24, 1
    s_and_b32 s32, s24, 1
    s_lshl_b32 s33, s30, 1
    s_add_u32 s32, s32, s33
    s_mul_i32 s33, s11, 22528
    s_mul_i32 s7, s32, 88064
    s_add_u32 s7, s7, s33
    s_add_u32 s7, s7, 6291456
    s_mul_i32 s6, s31, 176128
    s_add_u32 s6, s6, s33
    s_add_u32 s6, s6, 12582912
    s_add_u32 s69, s6, 88064
    s_barrier
    s_lshl_b32 s33, s11, 13
    s_lshl_b32 s9, s31, 16
    s_add_u32 s9, s9, s33
    s_add_u32 s9, s9, 14680064
    s_lshl_b32 s10, s32, 15
    s_add_u32 s10, s10, s33
    s_add_u32 s10, s10, 16777216
    s_lshl_b32 s62, s32, 9
    s_add_u32 s62, s62, 20971520
    s_lshl_b32 s63, s32, 15
    s_lshl_b32 s33, s31, 7
    s_add_u32 s63, s63, s33
    s_lshl_b32 s33, s11, 5
    s_add_u32 s63, s63, s33
    s_waitcnt vmcnt(10)
    s_barrier
    buffer_store_dwordx4 v[72:75], v250, s[12:15], s55 offen sc1
    s_barrier
    s_mov_b32 s20, s56
    s_mov_b32 s21, s57
    s_mov_b32 s22, 2097152
    s_mov_b32 s23, 0x00020000
    v_mov_b32 v29, v250
    v_and_b32 v238, 15, v249
    v_lshrrev_b32 v239, 5, v249
    v_lshlrev_b32 v238, 4, v238
    v_lshl_add_u32 v30, v239, 8, v238
    v_and_b32 v238, 31, v249
    v_lshlrev_b32 v239, 4, v239
    v_lshl_add_u32 v235, v238, 10, v239
    v_lshrrev_b32 v239, 3, v238
    v_and_b32 v238, 7, v238
    v_lshlrev_b32 v238, 2, v238
    v_lshl_add_u32 v234, v239, 7, v238
    v_mov_b32 v28, 0xdddd
    v_and_b32 v238, 27, v249
    v_cmp_eq_u32 vcc, 16, v238
    v_mov_b32 v239, 0x3f803f80
    v_mov_b32 v238, 0
    v_cndmask_b32 v16, v238, v239, vcc
    s_waitcnt vmcnt(8)
    s_barrier
    v_mov_b32 v17, v16
    v_mov_b32 v18, v16
    v_mov_b32 v19, v16
    v_mov_b32 v20, v16
    v_mov_b32 v21, v16
    v_mov_b32 v22, v16
    v_mov_b32 v23, v16
    v_mov_b32 v24, v16
    v_mov_b32 v25, v16
    v_mov_b32 v26, v16
    v_mov_b32 v27, v16
    v_mov_b32 v0, 0
    v_mov_b32 v1, 0
    v_mov_b32 v2, 0
    v_mov_b32 v3, 0
    v_mov_b32 v4, 0
    v_mov_b32 v5, 0
    v_mov_b32 v6, 0
    v_mov_b32 v7, 0
    v_mov_b32 v8, 0
    v_mov_b32 v9, 0
    v_mov_b32 v10, 0
    v_mov_b32 v11, 0
    v_mov_b32 v12, 0
    v_mov_b32 v13, 0
    v_mov_b32 v14, 0
    v_mov_b32 v15, 0
    v_mov_b32 v40, 0
    v_mov_b32 v41, 0
    v_mov_b32 v42, 0
    v_mov_b32 v43, 0
    v_mov_b32 v44, 0
    v_mov_b32 v45, 0
    v_mov_b32 v46, 0
    v_mov_b32 v47, 0
    s_mov_b32 s32, 22020096
    buffer_load_dwordx2 v[152:153], v172, s[12:15], s32 offen sc1
    s_barrier
    s_waitcnt vmcnt(6)
    s_barrier
    s_barrier
    s_waitcnt vmcnt(0)
    v_cmp_ne_u64 vcc, v[152:153], v[236:237]
    s_nop 1
    s_cbranch_vccnz LA_N0
    s_barrier
    s_lshl_b32 s32, s30, 16
    s_lshl_b32 s33, s31, 13
    s_add_u32 s32, s32, s33
    s_add_u32 s32, s32, s36
    s_add_u32 m0, s36, 90112
    s_add_u32 s33, s32, 4096
    buffer_load_dwordx4 v250, s[12:15], s32 offen lds
    s_add_u32 m0, s36, 94208
    s_lshl_b32 s32, s30, 17
    buffer_load_dwordx4 v250, s[12:15], s33 offen lds
    s_lshl_b32 s34, s36, 1
    s_add_u32 s32, s32, s34
    s_add_u32 s32, s32, 2097152
    s_add_u32 m0, s34, 0
    s_add_u32 s33, s32, 0
    buffer_load_dwordx4 v250, s[12:15], s33 offen lds
    buffer_load_dwordx4 v250, s[12:15], s33 offen offset:1024 lds
    s_add_u32 m0, s34, 8192
    s_add_u32 s33, s32, 8192
    buffer_load_dwordx4 v250, s[12:15], s33 offen lds
    buffer_load_dwordx4 v250, s[12:15], s33 offen offset:1024 lds
    s_barrier
LA_POST:
    s_add_u32 m0, s34, 16384
    s_add_u32 s33, s32, 16384
    buffer_load_dwordx4 v250, s[12:15], s33 offen lds
    buffer_load_dwordx4 v250, s[12:15], s33 offen offset:1024 lds
    s_add_u32 m0, s34, 24576
    s_add_u32 s33, s32, 24576
    buffer_load_dwordx4 v250, s[12:15], s33 offen lds
    buffer_load_dwordx4 v250, s[12:15], s33 offen offset:1024 lds
    s_add_u32 m0, s34, 32768
    s_add_u32 s33, s32, 32768
    buffer_load_dwordx4 v250, s[12:15], s33 offen lds
    buffer_load_dwordx4 v250, s[12:15], s33 offen offset:1024 lds
    s_add_u32 m0, s34, 40960
    s_add_u32 s33, s32, 40960
    buffer_load_dwordx4 v250, s[12:15], s33 offen lds
    buffer_load_dwordx4 v250, s[12:15], s33 offen offset:1024 lds
    s_lshl_b32 s38, s27, 4
    s_add_u32 s38, s38, s28
    s_lshl_b32 s38, s38, 7
    s_add_u32 s38, s38, 20971520
    s_add_u32 s66, s65, s66
    s_lshl_b32 s32, s24, 10
    s_add_u32 s32, s32, 90112
    s_lshl_b32 s33, s36, 1
    v_add_u32 v238, s32, v250
    v_add_u32 v239, s33, v250
    s_waitcnt vmcnt(8)
    ds_read_b128 v[80:83], v238
    ds_read_b128 v[84:87], v239
    s_waitcnt lgkmcnt(0)
    v_mfma_f32_32x32x16_bf16 v[48:63], v[84:87], v[80:83], 0
    s_nop 11
    v_max3_f32 v31, v48, v49, v50
    v_max3_f32 v31, v31, v51, v52
    v_max3_f32 v31, v31, v53, v54
    v_max3_f32 v31, v31, v55, v56
    v_max3_f32 v31, v31, v57, v58
    v_max3_f32 v31, v31, v59, v60
    v_max3_f32 v31, v31, v61, v62
    v_max_f32 v31, v31, v63
    v_mov_b32 v238, v31
    s_nop 1
    v_permlane32_swap_b32 v238, v31
    s_nop 1
    v_max_f32 v31, v31, v238
    v_sub_f32 v64, 0, v31
    v_sub_f32 v65, 0, v31
    v_sub_f32 v66, 0, v31
    v_sub_f32 v67, 0, v31
    v_sub_f32 v68, 0, v31
    v_sub_f32 v69, 0, v31
    v_sub_f32 v70, 0, v31
    v_sub_f32 v71, 0, v31
    v_sub_f32 v72, 0, v31
    v_sub_f32 v73, 0, v31
    v_sub_f32 v74, 0, v31
    v_sub_f32 v75, 0, v31
    v_sub_f32 v76, 0, v31
    v_sub_f32 v77, 0, v31
    v_sub_f32 v78, 0, v31
    v_sub_f32 v79, 0, v31
    s_waitcnt vmcnt(0)
    s_branch ATT
LA_N0:
    s_mov_b32 s32, 22020096
    buffer_load_dwordx2 v[154:155], v172, s[12:15], s32 offen sc1
    s_barrier
    s_barrier
    s_waitcnt vmcnt(0)
    v_cmp_ne_u64 vcc, v[154:155], v[236:237]
    s_nop 1
    s_cbranch_vccz LA_OK
    s_mov_b32 s68, 20000
    s_mov_b32 s32, 22020096
LA_SPIN:
    buffer_load_dwordx2 v[152:153], v172, s[12:15], s32 offen sc1
    s_waitcnt vmcnt(0)
    v_cmp_ne_u64 vcc, v[152:153], v[236:237]
    s_nop 1
    s_cbranch_vccz LA_OK
    s_sub_u32 s68, s68, 1
    s_cmp_lg_u32 s68, 0
    s_cbranch_scc1 LA_SPIN
LA_OK:
    s_lshl_b32 s32, s30, 16
    s_lshl_b32 s33, s31, 13
    s_add_u32 s32, s32, s33
    s_add_u32 s32, s32, s36
    s_add_u32 m0, s36, 90112
    s_add_u32 s33, s32, 4096
    buffer_load_dwordx4 v250, s[12:15], s32 offen lds
    s_add_u32 m0, s36, 94208
    s_lshl_b32 s32, s30, 17
    buffer_load_dwordx4 v250, s[12:15], s33 offen lds
    s_lshl_b32 s34, s36, 1
    s_add_u32 s32, s32, s34
    s_add_u32 s32, s32, 2097152
    s_add_u32 m0, s34, 0
    s_add_u32 s33, s32, 0
    buffer_load_dwordx4 v250, s[12:15], s33 offen lds
    buffer_load_dwordx4 v250, s[12:15], s33 offen offset:1024 lds
    s_add_u32 m0, s34, 8192
    s_add_u32 s33, s32, 8192
    buffer_load_dwordx4 v250, s[12:15], s33 offen lds
    buffer_load_dwordx4 v250, s[12:15], s33 offen offset:1024 lds
    s_branch LA_POST
K_END0:
    s_endpgm
LB:
    s_add_u32 s71, s29, 1
    s_and_b32 s71, s71, 7
    s_mul_i32 s71, s71, 196608
    s_add_u32 m0, s70, 149600
    s_add_u32 s71, s71, s38
    buffer_load_dwordx4 v164, s[8:11], s71 offen offset:0 lds
    buffer_load_dwordx4 v165, s[8:11], s71 offen offset:1024 lds
    buffer_load_dwordx4 v166, s[8:11], s71 offen offset:2048 lds
    s_waitcnt vmcnt(10)
    s_barrier
    s_add_u32 s62, s29, 2
    s_and_b32 s62, s62, 7
    s_lshl_b32 s62, s62, 7
    s_add_u32 m0, s69, 32768
    s_add_u32 s62, s62, s37
    buffer_load_dwordx4 v160, s[4:7], s62 offen offset:0 lds
    buffer_load_dwordx4 v161, s[4:7], s62 offen offset:1024 lds
    buffer_load_dwordx4 v162, s[4:7], s62 offen offset:2048 lds
    buffer_load_dwordx4 v163, s[4:7], s62 offen offset:3072 lds
    s_waitcnt vmcnt(11)
    s_barrier
    s_add_u32 s71, s29, 2
    s_and_b32 s71, s71, 7
    s_mul_i32 s71, s71, 196608
    s_add_u32 m0, s70, 98304
    s_add_u32 s71, s71, s38
    buffer_load_dwordx4 v164, s[8:11], s71 offen offset:0 lds
    buffer_load_dwordx4 v165, s[8:11], s71 offen offset:1024 lds
    buffer_load_dwordx4 v166, s[8:11], s71 offen offset:2048 lds
    s_waitcnt vmcnt(10)
    s_barrier
    s_add_u32 s62, s29, 3
    s_and_b32 s62, s62, 7
    s_lshl_b32 s62, s62, 7
    s_add_u32 m0, s69, 49152
    s_add_u32 s62, s62, s37
    buffer_load_dwordx4 v160, s[4:7], s62 offen offset:0 lds
    buffer_load_dwordx4 v161, s[4:7], s62 offen offset:1024 lds
    buffer_load_dwordx4 v162, s[4:7], s62 offen offset:2048 lds
    buffer_load_dwordx4 v163, s[4:7], s62 offen offset:3072 lds
    s_waitcnt vmcnt(11)
    s_barrier
    s_add_u32 s71, s29, 3
    s_and_b32 s71, s71, 7
    s_mul_i32 s71, s71, 196608
    s_add_u32 m0, s70, 114688
    s_add_u32 s71, s71, s38
    buffer_load_dwordx4 v164, s[8:11], s71 offen offset:0 lds
    buffer_load_dwordx4 v165, s[8:11], s71 offen offset:1024 lds
    buffer_load_dwordx4 v166, s[8:11], s71 offen offset:2048 lds
    s_waitcnt vmcnt(10)
    s_barrier
    s_add_u32 s71, s29, 0
    s_and_b32 s71, s71, 7
    s_mul_i32 s71, s71, 176128
    s_add_u32 m0, s70, 131072
    s_add_u32 s71, s71, s39
    buffer_load_dwordx4 v167, s[16:19], s71 offen offset:0 lds
    buffer_load_dwordx4 v168, s[16:19], s71 offen offset:1024 lds
    buffer_load_dwordx4 v169, s[16:19], s71 offen offset:2048 lds
    s_waitcnt vmcnt(10)
    s_barrier
    s_add_u32 s62, s29, 4
    s_and_b32 s62, s62, 7
    s_lshl_b32 s62, s62, 7
    s_add_u32 m0, s69, 65536
    s_add_u32 s62, s62, s37
    buffer_load_dwordx4 v160, s[4:7], s62 offen offset:0 lds
    buffer_load_dwordx4 v161, s[4:7], s62 offen offset:1024 lds
    buffer_load_dwordx4 v162, s[4:7], s62 offen offset:2048 lds
    buffer_load_dwordx4 v163, s[4:7], s62 offen offset:3072 lds
    s_waitcnt vmcnt(10)
    s_barrier
    s_add_u32 s71, s29, 4
    s_and_b32 s71, s71, 7
    s_mul_i32 s71, s71, 196608
    s_add_u32 m0, s70, 143424
    s_add_u32 s71, s71, s38
    buffer_load_dwordx4 v164, s[8:11], s71 offen offset:0 lds
    buffer_load_dwordx4 v165, s[8:11], s71 offen offset:1024 lds
    buffer_load_dwordx4 v166, s[8:11], s71 offen offset:2048 lds
    s_waitcnt vmcnt(10)
    s_barrier
    s_add_u32 s71, s29, 0
    s_and_b32 s71, s71, 7
    s_mul_i32 s71, s71, 176128
    s_add_u32 s71, s71, 88064
    s_add_u32 m0, s70, 155776
    s_add_u32 s71, s71, s39
    buffer_load_dwordx4 v167, s[16:19], s71 offen offset:0 lds
    buffer_load_dwordx4 v168, s[16:19], s71 offen offset:1024 lds
    buffer_load_dwordx4 v169, s[16:19], s71 offen offset:2048 lds
    s_barrier
    s_waitcnt vmcnt(10)
    s_barrier
    s_add_u32 s62, s29, 5
    s_and_b32 s62, s62, 7
    s_lshl_b32 s62, s62, 7
    s_add_u32 m0, s69, 81920
    s_add_u32 s62, s62, s37
    buffer_load_dwordx4 v160, s[4:7], s62 offen offset:0 lds
    buffer_load_dwordx4 v161, s[4:7], s62 offen offset:1024 lds
    buffer_load_dwordx4 v162, s[4:7], s62 offen offset:2048 lds
    buffer_load_dwordx4 v163, s[4:7], s62 offen offset:3072 lds
    s_waitcnt vmcnt(10)
    s_barrier
    s_add_u32 s71, s29, 5
    s_and_b32 s71, s71, 7
    s_mul_i32 s71, s71, 196608
    s_add_u32 m0, s70, 120864
    s_add_u32 s71, s71, s38
    buffer_load_dwordx4 v164, s[8:11], s71 offen offset:0 lds
    buffer_load_dwordx4 v165, s[8:11], s71 offen offset:1024 lds
    buffer_load_dwordx4 v166, s[8:11], s71 offen offset:2048 lds
    s_waitcnt vmcnt(10)
    s_barrier
    s_barrier
    s_add_u32 s71, s29, 1
    s_and_b32 s71, s71, 7
    s_mul_i32 s71, s71, 176128
    s_add_u32 m0, s70, 137248
    s_add_u32 s71, s71, s39
    buffer_load_dwordx4 v167, s[16:19], s71 offen offset:0 lds
    buffer_load_dwordx4 v168, s[16:19], s71 offen offset:1024 lds
    buffer_load_dwordx4 v169, s[16:19], s71 offen offset:2048 lds
    s_waitcnt vmcnt(10)
    s_barrier
    s_add_u32 s62, s29, 6
    s_and_b32 s62, s62, 7
    s_lshl_b32 s62, s62, 7
    s_add_u32 m0, s69, 98304
    s_add_u32 s62, s62, s37
    buffer_load_dwordx4 v160, s[4:7], s62 offen offset:0 lds
    buffer_load_dwordx4 v161, s[4:7], s62 offen offset:1024 lds
    buffer_load_dwordx4 v162, s[4:7], s62 offen offset:2048 lds
    buffer_load_dwordx4 v163, s[4:7], s62 offen offset:3072 lds
    s_waitcnt vmcnt(10)
    s_barrier
    s_add_u32 s71, s29, 6
    s_and_b32 s71, s71, 7
    s_mul_i32 s71, s71, 196608
    s_add_u32 m0, s70, 149600
    s_add_u32 s71, s71, s38
    buffer_load_dwordx4 v164, s[8:11], s71 offen offset:0 lds
    buffer_load_dwordx4 v165, s[8:11], s71 offen offset:1024 lds
    buffer_load_dwordx4 v166, s[8:11], s71 offen offset:2048 lds
    s_waitcnt vmcnt(10)
    s_barrier
    s_barrier
    s_add_u32 s71, s29, 1
    s_and_b32 s71, s71, 7
    s_mul_i32 s71, s71, 176128
    s_add_u32 s71, s71, 88064
    s_add_u32 m0, s70, 0
    s_add_u32 s71, s71, s39
    buffer_load_dwordx4 v167, s[16:19], s71 offen offset:0 lds
    buffer_load_dwordx4 v168, s[16:19], s71 offen offset:1024 lds
    buffer_load_dwordx4 v169, s[16:19], s71 offen offset:2048 lds
    s_waitcnt vmcnt(10)
    s_barrier
    s_add_u32 s62, s29, 7
    s_and_b32 s62, s62, 7
    s_lshl_b32 s62, s62, 7
    s_add_u32 m0, s69, 114688
    s_add_u32 s62, s62, s37
    buffer_load_dwordx4 v160, s[4:7], s62 offen offset:0 lds
    buffer_load_dwordx4 v161, s[4:7], s62 offen offset:1024 lds
    buffer_load_dwordx4 v162, s[4:7], s62 offen offset:2048 lds
    buffer_load_dwordx4 v163, s[4:7], s62 offen offset:3072 lds
    s_waitcnt vmcnt(10)
    s_barrier
    s_add_u32 s71, s29, 7
    s_and_b32 s71, s71, 7
    s_mul_i32 s71, s71, 196608
    s_add_u32 m0, s70, 131072
    s_add_u32 s71, s71, s38
    buffer_load_dwordx4 v164, s[8:11], s71 offen offset:0 lds
    buffer_load_dwordx4 v165, s[8:11], s71 offen offset:1024 lds
    buffer_load_dwordx4 v166, s[8:11], s71 offen offset:2048 lds
    s_waitcnt vmcnt(10)
    s_barrier
    s_barrier
    s_add_u32 s71, s29, 2
    s_and_b32 s71, s71, 7
    s_mul_i32 s71, s71, 176128
    s_add_u32 m0, s70, 143424
    s_add_u32 s71, s71, s39
    buffer_load_dwordx4 v167, s[16:19], s71 offen offset:0 lds
    buffer_load_dwordx4 v168, s[16:19], s71 offen offset:1024 lds
    buffer_load_dwordx4 v169, s[16:19], s71 offen offset:2048 lds
    s_waitcnt vmcnt(10)
    s_barrier
    s_add_u32 m0, s70, 155776
    s_add_u32 s71, s71, 88064
    buffer_load_dwordx4 v167, s[16:19], s71 offen offset:0 lds
    buffer_load_dwordx4 v168, s[16:19], s71 offen offset:1024 lds
    buffer_load_dwordx4 v169, s[16:19], s71 offen offset:2048 lds
    s_waitcnt vmcnt(9)
    s_barrier
    s_waitcnt vmcnt(6)
    s_barrier
    s_add_u32 s71, s29, 3
    s_and_b32 s71, s71, 7
    s_mul_i32 s71, s71, 176128
    s_add_u32 m0, s70, 16384
    s_add_u32 s71, s71, s39
    buffer_load_dwordx4 v167, s[16:19], s71 offen offset:0 lds
    buffer_load_dwordx4 v168, s[16:19], s71 offen offset:1024 lds
    buffer_load_dwordx4 v169, s[16:19], s71 offen offset:2048 lds
    s_barrier
    s_add_u32 m0, s70, 6176
    s_add_u32 s71, s71, 88064
    buffer_load_dwordx4 v167, s[16:19], s71 offen offset:0 lds
    buffer_load_dwordx4 v168, s[16:19], s71 offen offset:1024 lds
    buffer_load_dwordx4 v169, s[16:19], s71 offen offset:2048 lds
    s_waitcnt vmcnt(9)
    s_barrier
    s_add_u32 s71, s29, 4
    s_and_b32 s71, s71, 7
    s_mul_i32 s71, s71, 176128
    s_add_u32 m0, s70, 137248
    s_add_u32 s71, s71, s39
    buffer_load_dwordx4 v167, s[16:19], s71 offen offset:0 lds
    buffer_load_dwordx4 v168, s[16:19], s71 offen offset:1024 lds
    buffer_load_dwordx4 v169, s[16:19], s71 offen offset:2048 lds
    s_barrier
    s_waitcnt vmcnt(9)
    s_barrier
    s_add_u32 m0, s70, 149600
    s_add_u32 s71, s71, 88064
    buffer_load_dwordx4 v167, s[16:19], s71 offen offset:0 lds
    buffer_load_dwordx4 v168, s[16:19], s71 offen offset:1024 lds
    buffer_load_dwordx4 v169, s[16:19], s71 offen offset:2048 lds
    s_barrier
    s_waitcnt vmcnt(9)
    s_barrier
    s_add_u32 s71, s29, 5
    s_and_b32 s71, s71, 7
    s_mul_i32 s71, s71, 176128
    s_add_u32 m0, s70, 0
    s_add_u32 s71, s71, s39
    buffer_load_dwordx4 v167, s[16:19], s71 offen offset:0 lds
    buffer_load_dwordx4 v168, s[16:19], s71 offen offset:1024 lds
    buffer_load_dwordx4 v169, s[16:19], s71 offen offset:2048 lds
    s_barrier
    s_waitcnt vmcnt(9)
    s_barrier
    s_add_u32 m0, s70, 38944
    s_add_u32 s71, s71, 88064
    buffer_load_dwordx4 v167, s[16:19], s71 offen offset:0 lds
    buffer_load_dwordx4 v168, s[16:19], s71 offen offset:1024 lds
    buffer_load_dwordx4 v169, s[16:19], s71 offen offset:2048 lds
    s_barrier
    v_mov_b32 v190, 162976
    ds_read_b64 v[236:237], v190
    s_waitcnt vmcnt(9)
    s_barrier
    s_add_u32 s71, s29, 6
    s_and_b32 s71, s71, 7
    s_mul_i32 s71, s71, 176128
    s_add_u32 m0, s70, 22560
    s_add_u32 s71, s71, s39
    buffer_load_dwordx4 v167, s[16:19], s71 offen offset:0 lds
    buffer_load_dwordx4 v168, s[16:19], s71 offen offset:1024 lds
    buffer_load_dwordx4 v169, s[16:19], s71 offen offset:2048 lds
    s_lshr_b32 s32, s30, 1
    s_add_u32 s33, s32, 16
    s_mul_i32 s33, s33, 43
    s_lshr_b32 s33, s33, 7
    s_add_u32 s34, s32, 32
    s_mul_i32 s34, s34, 43
    s_lshr_b32 s34, s34, 7
    s_mul_i32 s32, s32, 43
    s_lshr_b32 s32, s32, 7
    v_mov_b32 v190, s34
    v_mov_b32 v191, s33
    v_cmp_gt_u32 vcc, 16, v249
    s_nop 1
    v_cndmask_b32 v190, v190, v191, vcc
    s_lshl_b32 s33, s31, 1
    v_and_b32 v191, 1, v249
    v_add_u32 v191, s33, v191
    v_and_b32 v192, 15, v249
    v_mov_b32 v172, s32
    v_cmp_gt_u32 vcc, 32, v249
    s_nop 1
    v_cndmask_b32 v190, v172, v190, vcc
    v_cndmask_b32 v191, v191, v192, vcc
    s_barrier
    v_lshlrev_b32 v191, 3, v191
    s_lshr_b32 s32, s36, 3
    v_lshl_add_u32 v190, v190, 9, s32
    v_add_u32 v172, v190, v191
    s_waitcnt vmcnt(9)
    s_barrier
    s_add_u32 m0, s70, 131072
    s_add_u32 s71, s71, 88064
    buffer_load_dwordx4 v167, s[16:19], s71 offen offset:0 lds
    buffer_load_dwordx4 v168, s[16:19], s71 offen offset:1024 lds
    buffer_load_dwordx4 v169, s[16:19], s71 offen offset:2048 lds
    s_waitcnt lgkmcnt(0)
    s_lshr_b32 s32, s30, 1
    s_lshl_b32 s32, s32, 7
    v_and_b32 v238, 15, v249
    v_lshl_add_u32 v232, v238, 3, s32
    s_lshl_b32 s32, s31, 8
    v_cmp_gt_u32 vcc, 32, v249
    v_and_b32 v238, 31, v249
    v_lshl_add_u32 v238, v238, 3, s32
    v_cndmask_b32 v232, v238, v232, vcc
    s_lshr_b32 s32, s30, 2
    v_cmp_gt_u32 vcc, 32, v249
    v_mov_b32 v238, s32
    v_mov_b32 v239, s31
    v_cndmask_b32 v238, v239, v238, vcc
    v_and_b32 v239, 31, v249
    v_lshl_add_u32 v238, v238, 5, v239
    v_add_u32 v238, 256, v238
    v_lshlrev_b32 v233, 3, v238
    s_lshl_b32 s32, s27, 4
    s_add_u32 s32, s32, s28
    s_lshl_b32 s32, s32, 3
    s_lshl_b32 s33, s31, 5
    s_add_u32 s33, s33, s30
    s_add_u32 s33, s33, 256
    s_lshl_b32 s33, s33, 3
    v_mov_b32 v248, 2147483648
    v_writelane_b32 v248, s32, 0
    v_writelane_b32 v248, s33, 1
    s_barrier
    s_lshl_b32 s32, s31, 3
    s_and_b32 s33, s24, 3
    s_add_u32 s32, s32, s33
    s_lshl_b32 s32, s32, 15
    s_lshl_b32 s33, s30, 10
    s_add_u32 s32, s32, s33
    s_add_u32 s54, s32, 16777216
    s_add_u32 s55, s54, 131072
    v_mov_b32 v72, -1
    v_mov_b32 v73, -1
    v_mov_b32 v74, -1
    v_mov_b32 v75, -1
    s_lshl_b32 s32, s30, 2
    s_and_b32 s33, s24, 3
    s_add_u32 s32, s32, s33
    s_cmp_lt_u32 s32, 86
    s_cselect_b32 s44, s52, s44
    s_cselect_b32 s45, s53, s45
    s_mov_b32 s46, 524288
    s_cmov_b32 s46, 1409024
    s_mov_b32 s47, 0x00020000
    s_cselect_b32 s33, 0, 86
    s_mov_b32 s66, 32768
    s_cmov_b32 s66, 88064
    s_mov_b32 s65, 14680064
    s_cmov_b32 s65, 12582912
    s_sub_u32 s33, s32, s33
    s_lshl_b32 s64, s33, 14
    s_lshl_b32 s34, s31, 7
    s_add_u32 s64, s64, s34
    s_lshl_b32 s34, s31, 1
    s_mul_i32 s34, s34, s66
    s_add_u32 s65, s65, s34
    s_lshl_b32 s34, s33, 10
    s_add_u32 s65, s65, s34
    s_cmp_lt_u32 s32, 118
    s_cselect_b32 s64, s64, 0x40000000
    s_cselect_b32 s65, s65, 0x40000000
    s_waitcnt vmcnt(9)
    s_barrier
    s_add_u32 s71, s29, 7
    s_and_b32 s71, s71, 7
    s_mul_i32 s71, s71, 176128
    s_add_u32 m0, s70, 143424
    s_add_u32 s71, s71, s39
    buffer_load_dwordx4 v167, s[16:19], s71 offen offset:0 lds
    buffer_load_dwordx4 v168, s[16:19], s71 offen offset:1024 lds
    buffer_load_dwordx4 v169, s[16:19], s71 offen offset:2048 lds
    buffer_store_dwordx4 v[72:75], v250, s[12:15], s54 offen sc1
    v_lshrrev_b32 v190, 5, v249
    v_bfe_u32 v191, v249, 2, 2
    v_lshl_add_u32 v170, v190, 2, v191
    v_lshlrev_b32 v170, 10, v170
    v_lshlrev_b32 v171, 9, v190
    v_lshl_add_u32 v171, v191, 6, v171
    v_bfe_u32 v190, v249, 4, 1
    v_lshl_add_u32 v170, v190, 6, v170
    v_lshl_add_u32 v171, v190, 5, v171
    v_and_b32 v190, 3, v249
    v_lshl_add_u32 v170, v190, 4, v170
    v_lshl_add_u32 v171, v190, 3, v171
    s_lshl_b32 s32, s36, 1
    s_add_u32 s32, s32, 131072
    v_add_u32 v171, s32, v171
    s_barrier
    v_min_u32 v251, 1, v249
    v_lshlrev_b32 v251, 31, v251
    s_mov_b32 s4, 0x0000ffff
    s_mov_b32 s5, 0x0000ffff
    s_lshl_b32 s32, s31, 3
    s_add_u32 s32, s32, s24
    s_lshl_b32 s8, s32, 15
    s_lshl_b32 s33, s30, 10
    s_add_u32 s8, s8, s33
    s_add_u32 s8, s8, 16777216
    s_lshl_b32 s67, s30, 17
    s_add_u32 s67, s67, 2097152
    s_lshr_b32 s11, s24, 1
    s_and_b32 s32, s24, 1
    s_lshl_b32 s33, s30, 1
    s_add_u32 s32, s32, s33
    s_mul_i32 s33, s11, 22528
    s_mul_i32 s7, s32, 88064
    s_add_u32 s7, s7, s33
    s_add_u32 s7, s7, 6291456
    s_mul_i32 s6, s31, 176128
    s_add_u32 s6, s6, s33
    s_add_u32 s6, s6, 12582912
    s_add_u32 s69, s6, 88064
    s_waitcnt vmcnt(10)
    s_barrier
    s_add_u32 m0, s70, 155776
    s_add_u32 s71, s71, 88064
    buffer_load_dwordx4 v167, s[16:19], s71 offen offset:0 lds
    buffer_load_dwordx4 v168, s[16:19], s71 offen offset:1024 lds
    buffer_load_dwordx4 v169, s[16:19], s71 offen offset:2048 lds
    s_lshl_b32 s33, s11, 13
    s_lshl_b32 s9, s31, 16
    s_add_u32 s9, s9, s33
    s_add_u32 s9, s9, 14680064
    s_lshl_b32 s10, s32, 15
    s_add_u32 s10, s10, s33
    s_add_u32 s10, s10, 16777216
    s_lshl_b32 s62, s32, 9
    s_add_u32 s62, s62, 20971520
    s_lshl_b32 s63, s32, 15
    s_lshl_b32 s33, s31, 7
    s_add_u32 s63, s63, s33
    s_lshl_b32 s33, s11, 5
    s_add_u32 s63, s63, s33
    s_barrier
    buffer_store_dwordx4 v[72:75], v250, s[12:15], s55 offen sc1
    s_waitcnt vmcnt(11)
    s_barrier
    s_mov_b32 s20, s56
    s_mov_b32 s21, s57
    s_mov_b32 s22, 2097152
    s_mov_b32 s23, 0x00020000
    v_mov_b32 v29, v250
    v_and_b32 v238, 15, v249
    v_lshrrev_b32 v239, 5, v249
    v_lshlrev_b32 v238, 4, v238
    v_lshl_add_u32 v30, v239, 8, v238
    v_and_b32 v238, 31, v249
    v_lshlrev_b32 v239, 4, v239
    v_lshl_add_u32 v235, v238, 10, v239
    v_lshrrev_b32 v239, 3, v238
    v_and_b32 v238, 7, v238
    v_lshlrev_b32 v238, 2, v238
    v_lshl_add_u32 v234, v239, 7, v238
    v_mov_b32 v28, 0xdddd
    v_and_b32 v238, 27, v249
    v_cmp_eq_u32 vcc, 16, v238
    v_mov_b32 v239, 0x3f803f80
    v_mov_b32 v238, 0
    v_cndmask_b32 v16, v238, v239, vcc
    s_barrier
    v_mov_b32 v17, v16
    v_mov_b32 v18, v16
    v_mov_b32 v19, v16
    v_mov_b32 v20, v16
    v_mov_b32 v21, v16
    v_mov_b32 v22, v16
    v_mov_b32 v23, v16
    v_mov_b32 v24, v16
    v_mov_b32 v25, v16
    v_mov_b32 v26, v16
    v_mov_b32 v27, v16
    v_mov_b32 v0, 0
    v_mov_b32 v1, 0
    v_mov_b32 v2, 0
    v_mov_b32 v3, 0
    v_mov_b32 v4, 0
    v_mov_b32 v5, 0
    v_mov_b32 v6, 0
    v_mov_b32 v7, 0
    v_mov_b32 v8, 0
    v_mov_b32 v9, 0
    v_mov_b32 v10, 0
    v_mov_b32 v11, 0
    v_mov_b32 v12, 0
    v_mov_b32 v13, 0
    v_mov_b32 v14, 0
    v_mov_b32 v15, 0
    v_mov_b32 v40, 0
    v_mov_b32 v41, 0
    v_mov_b32 v42, 0
    v_mov_b32 v43, 0
    v_mov_b32 v44, 0
    v_mov_b32 v45, 0
    v_mov_b32 v46, 0
    v_mov_b32 v47, 0
    s_mov_b32 s32, 22020096
    buffer_load_dwordx2 v[152:153], v172, s[12:15], s32 offen sc1
    s_waitcnt vmcnt(9)
    s_barrier
    s_barrier
    s_waitcnt vmcnt(6)
    s_barrier
    s_waitcnt vmcnt(0)
    v_cmp_ne_u64 vcc, v[152:153], v[236:237]
    s_nop 1
    s_cbranch_vccnz LB_N0
    s_barrier
    s_lshl_b32 s32, s30, 16
    s_lshl_b32 s33, s31, 13
    s_add_u32 s32, s32, s33
    s_add_u32 s32, s32, s36
    s_add_u32 m0, s36, 90112
    s_add_u32 s33, s32, 4096
    buffer_load_dwordx4 v250, s[12:15], s32 offen lds
    s_add_u32 m0, s36, 94208
    s_lshl_b32 s32, s30, 17
    buffer_load_dwordx4 v250, s[12:15], s33 offen lds
    s_lshl_b32 s34, s36, 1
    s_add_u32 s32, s32, s34
    s_add_u32 s32, s32, 2097152
    s_add_u32 m0, s34, 0
    s_add_u32 s33, s32, 0
    buffer_load_dwordx4 v250, s[12:15], s33 offen lds
    buffer_load_dwordx4 v250, s[12:15], s33 offen offset:1024 lds
    s_add_u32 m0, s34, 8192
    s_add_u32 s33, s32, 8192
    buffer_load_dwordx4 v250, s[12:15], s33 offen lds
    buffer_load_dwordx4 v250, s[12:15], s33 offen offset:1024 lds
    s_barrier
LB_POST:
    s_add_u32 m0, s34, 16384
    s_add_u32 s33, s32, 16384
    buffer_load_dwordx4 v250, s[12:15], s33 offen lds
    buffer_load_dwordx4 v250, s[12:15], s33 offen offset:1024 lds
    s_add_u32 m0, s34, 24576
    s_add_u32 s33, s32, 24576
    buffer_load_dwordx4 v250, s[12:15], s33 offen lds
    buffer_load_dwordx4 v250, s[12:15], s33 offen offset:1024 lds
    s_add_u32 m0, s34, 32768
    s_add_u32 s33, s32, 32768
    buffer_load_dwordx4 v250, s[12:15], s33 offen lds
    buffer_load_dwordx4 v250, s[12:15], s33 offen offset:1024 lds
    s_add_u32 m0, s34, 40960
    s_add_u32 s33, s32, 40960
    buffer_load_dwordx4 v250, s[12:15], s33 offen lds
    buffer_load_dwordx4 v250, s[12:15], s33 offen offset:1024 lds
    v_mov_b32 v189, 2147483648
    s_mov_b32 s38, 0
    s_add_u32 s66, s65, s66
    s_lshl_b32 s32, s24, 10
    s_add_u32 s32, s32, 90112
    s_lshl_b32 s33, s36, 1
    v_add_u32 v238, s32, v250
    v_add_u32 v239, s33, v250
    s_waitcnt vmcnt(8)
    ds_read_b128 v[80:83], v238
    ds_read_b128 v[84:87], v239
    s_waitcnt lgkmcnt(0)
    v_mfma_f32_32x32x16_bf16 v[48:63], v[84:87], v[80:83], 0
    s_nop 11
    v_max3_f32 v31, v48, v49, v50
    v_max3_f32 v31, v31, v51, v52
    v_max3_f32 v31, v31, v53, v54
    v_max3_f32 v31, v31, v55, v56
    v_max3_f32 v31, v31, v57, v58
    v_max3_f32 v31, v31, v59, v60
    v_max3_f32 v31, v31, v61, v62
    v_max_f32 v31, v31, v63
    v_mov_b32 v238, v31
    s_nop 1
    v_permlane32_swap_b32 v238, v31
    s_nop 1
    v_max_f32 v31, v31, v238
    v_sub_f32 v64, 0, v31
    v_sub_f32 v65, 0, v31
    v_sub_f32 v66, 0, v31
    v_sub_f32 v67, 0, v31
    v_sub_f32 v68, 0, v31
    v_sub_f32 v69, 0, v31
    v_sub_f32 v70, 0, v31
    v_sub_f32 v71, 0, v31
    v_sub_f32 v72, 0, v31
    v_sub_f32 v73, 0, v31
    v_sub_f32 v74, 0, v31
    v_sub_f32 v75, 0, v31
    v_sub_f32 v76, 0, v31
    v_sub_f32 v77, 0, v31
    v_sub_f32 v78, 0, v31
    v_sub_f32 v79, 0, v31
    s_waitcnt vmcnt(0)
    s_branch ATT
LB_N0:
    s_mov_b32 s32, 22020096
    buffer_load_dwordx2 v[154:155], v172, s[12:15], s32 offen sc1
    s_barrier
    s_barrier
    s_waitcnt vmcnt(0)
    v_cmp_ne_u64 vcc, v[154:155], v[236:237]
    s_nop 1
    s_cbranch_vccz LB_OK
    s_mov_b32 s68, 20000
    s_mov_b32 s32, 22020096
LB_SPIN:
    buffer_load_dwordx2 v[152:153], v172, s[12:15], s32 offen sc1
    s_waitcnt vmcnt(0)
    v_cmp_ne_u64 vcc, v[152:153], v[236:237]
    s_nop 1
    s_cbranch_vccz LB_OK
    s_sub_u32 s68, s68, 1
    s_cmp_lg_u32 s68, 0
    s_cbranch_scc1 LB_SPIN
LB_OK:
    s_lshl_b32 s32, s30, 16
    s_lshl_b32 s33, s31, 13
    s_add_u32 s32, s32, s33
    s_add_u32 s32, s32, s36
    s_add_u32 m0, s36, 90112
    s_add_u32 s33, s32, 4096
    buffer_load_dwordx4 v250, s[12:15], s32 offen lds
    s_add_u32 m0, s36, 94208
    s_lshl_b32 s32, s30, 17
    buffer_load_dwordx4 v250, s[12:15], s33 offen lds
    s_lshl_b32 s34, s36, 1
    s_add_u32 s32, s32, s34
    s_add_u32 s32, s32, 2097152
    s_add_u32 m0, s34, 0
    s_add_u32 s33, s32, 0
    buffer_load_dwordx4 v250, s[12:15], s33 offen lds
    buffer_load_dwordx4 v250, s[12:15], s33 offen offset:1024 lds
    s_add_u32 m0, s34, 8192
    s_add_u32 s33, s32, 8192
    buffer_load_dwordx4 v250, s[12:15], s33 offen lds
    buffer_load_dwordx4 v250, s[12:15], s33 offen offset:1024 lds
    s_branch LB_POST
COMP:
    s_and_b32 s35, s24, 1
    s_lshr_b32 s36, s24, 1
    v_and_b32 v147, 31, v249
    v_lshrrev_b32 v148, 5, v249
    v_bfe_u32 v145, v147, 1, 3
    v_xor_b32 v145, v145, v148
    v_lshlrev_b32 v144, 7, v147
    s_lshl_b32 s32, s24, 12
    s_lshl_b32 s33, s35, 13
    v_xor_b32 v146, 0, v145
    v_lshl_add_u32 v146, v146, 4, v144
    v_add_u32 v232, s32, v146
    v_add_u32 v224, s33, v146
    v_add_u32 v236, 65536, v232
    v_add_u32 v228, 65536, v224
    v_xor_b32 v146, 2, v145
    v_lshl_add_u32 v146, v146, 4, v144
    v_add_u32 v233, s32, v146
    v_add_u32 v225, s33, v146
    v_add_u32 v237, 65536, v233
    v_add_u32 v229, 65536, v225
    v_xor_b32 v146, 4, v145
    v_lshl_add_u32 v146, v146, 4, v144
    v_add_u32 v234, s32, v146
    v_add_u32 v226, s33, v146
    v_add_u32 v238, 65536, v234
    v_add_u32 v230, 65536, v226
    v_xor_b32 v146, 6, v145
    v_lshl_add_u32 v146, v146, 4, v144
    v_add_u32 v235, s32, v146
    v_add_u32 v227, s33, v146
    v_add_u32 v239, 65536, v235
    v_add_u32 v231, 65536, v227
    v_bfe_u32 v144, v249, 2, 2
    v_lshl_add_u32 v144, v148, 3, v144
    v_mul_u32_u24 v144, 192, v144
    v_and_b32 v145, 3, v249
    v_lshl_add_u32 v144, v145, 3, v144
    v_add_u32 v144, 98304, v144
    v_bfe_u32 v145, v249, 4, 1
    v_lshl_add_u32 v248, v145, 5, v144
    s_mul_i32 s32, s36, 96
    v_mul_u32_u24 v145, 3104, v145
    v_add3_u32 v252, v144, v145, s32
    v_subrev_u32 v216, 98304, v248
    v_subrev_u32 v217, 98304, v252
    v_and_b32 v144, 0x33, v249
    v_bfe_u32 v146, v249, 2, 1
    v_lshl_add_u32 v144, v146, 3, v144
    v_bfe_u32 v146, v249, 3, 1
    v_lshl_add_u32 v144, v146, 2, v144
    v_lshlrev_b32 v144, 4, v144
    v_and_b32 v145, 15, v249
    v_lshlrev_b32 v145, 4, v145
    v_lshl_add_u32 v145, v148, 8, v145
    v_bfe_u32 v146, v249, 4, 1
    v_lshl_add_u32 v145, v146, 17, v145
    s_lshl_b32 s34, s27, 2
    s_add_u32 s34, s34, s24
    s_mul_i32 s32, s28, 3
    s_add_u32 s32, s32, 0
    s_and_b32 s33, s32, 15
    s_lshl_b32 s37, s33, 18
    s_lshl_b32 s62, s34, 11
    s_add_u32 s37, s37, s62
    s_add_u32 s37, s37, 2097152
    s_cmp_lt_u32 s32, 32
    s_cselect_b32 s62, 0, 1024
    s_add_u32 s37, s37, s62
    s_cmp_lt_u32 s32, 32
    s_mov_b32 s62, 512
    s_cmov_b32 s62, 131072
    s_cselect_b64 vcc, -1, 0
    v_cndmask_b32 v253, v145, v144, vcc
    s_lshl_b32 s33, s33, 17
    s_lshl_b32 s65, s34, 10
    s_add_u32 s33, s33, s65
    s_cmp_lt_u32 s32, 16
    s_cselect_b32 s37, s33, s37
    s_cselect_b32 s62, 65536, s62
    s_cselect_b32 s65, 1052289595, 1.0
    s_cselect_b64 vcc, -1, 0
    v_cndmask_b32 v253, v253, v250, vcc
    s_add_u32 s62, s62, s37
    s_mul_i32 s32, s28, 3
    s_add_u32 s32, s32, 1
    s_and_b32 s33, s32, 15
    s_lshl_b32 s38, s33, 18
    s_lshl_b32 s63, s34, 11
    s_add_u32 s38, s38, s63
    s_add_u32 s38, s38, 2097152
    s_cmp_lt_u32 s32, 32
    s_cselect_b32 s63, 0, 1024
    s_add_u32 s38, s38, s63
    s_cmp_lt_u32 s32, 32
    s_mov_b32 s63, 512
    s_cmov_b32 s63, 131072
    s_cselect_b64 vcc, -1, 0
    v_cndmask_b32 v254, v145, v144, vcc
    s_lshl_b32 s33, s33, 17
    s_lshl_b32 s66, s34, 10
    s_add_u32 s33, s33, s66
    s_cmp_lt_u32 s32, 16
    s_cselect_b32 s38, s33, s38
    s_cselect_b32 s63, 65536, s63
    s_cselect_b32 s66, 1052289595, 1.0
    s_cselect_b64 vcc, -1, 0
    v_cndmask_b32 v254, v254, v250, vcc
    s_add_u32 s63, s63, s38
    s_mul_i32 s32, s28, 3
    s_add_u32 s32, s32, 2
    s_and_b32 s33, s32, 15
    s_lshl_b32 s39, s33, 18
    s_lshl_b32 s64, s34, 11
    s_add_u32 s39, s39, s64
    s_add_u32 s39, s39, 2097152
    s_cmp_lt_u32 s32, 32
    s_cselect_b32 s64, 0, 1024
    s_add_u32 s39, s39, s64
    s_cmp_lt_u32 s32, 32
    s_mov_b32 s64, 512
    s_cmov_b32 s64, 131072
    s_cselect_b64 vcc, -1, 0
    v_cndmask_b32 v255, v145, v144, vcc
    s_lshl_b32 s33, s33, 17
    s_lshl_b32 s67, s34, 10
    s_add_u32 s33, s33, s67
    s_cmp_lt_u32 s32, 16
    s_cselect_b32 s39, s33, s39
    s_cselect_b32 s64, 65536, s64
    s_cselect_b32 s67, 1052289595, 1.0
    s_cselect_b64 vcc, -1, 0
    v_cndmask_b32 v255, v255, v250, vcc
    s_add_u32 s64, s64, s39
    v_min_u32 v251, 1, v249
    v_lshlrev_b32 v251, 31, v251
    s_waitcnt lgkmcnt(0)
    s_mov_b32 s12, s60
    s_mov_b32 s13, s61
    s_mov_b32 s14, 25165824
    s_mov_b32 s15, 0x00020000
    s_mov_b32 s16, s58
    s_mov_b32 s17, s59
    s_mov_b32 s18, 256
    s_mov_b32 s19, 0x00020000
    s_mov_b32 s46, 524288
    s_mov_b32 s47, 0x00020000
    s_lshl_b32 s32, s31, 3
    s_add_u32 s32, s32, s24
    s_lshl_b32 s32, s32, 15
    s_lshl_b32 s33, s30, 10
    s_add_u32 s32, s32, s33
    s_lshl_b32 s42, s28, 2
    s_add_u32 s42, s42, s24
    s_lshl_b32 s42, s42, 4
    s_add_u32 s42, s42, s27
    s_lshl_b32 s42, s42, 3
    s_add_u32 s42, s42, 22020096
    s_add_u32 s52, s32, 16777216
    s_add_u32 s53, s52, 131072
    s_or_b32 s32, s2, s24
    s_cmp_lg_u32 s32, 0
    s_cbranch_scc1 C_NOAT
    s_memrealtime s[98:99]
    s_waitcnt lgkmcnt(0)
    s_or_b32 s98, s98, 1
    v_mov_b32 v240, s98
    v_mov_b32 v241, s99
    buffer_store_dwordx2 v[240:241], v251, s[16:19], 0 offen sc0 sc1
    s_waitcnt vmcnt(0)
C_NOAT:
    s_mul_i32 s40, s28, 5
    s_min_u32 s32, s28, 6
    s_add_u32 s40, s40, s32
    s_mul_i32 s32, s36, 3
    s_add_u32 s40, s40, s32
    s_lshl_b32 s32, s27, 2
    s_lshl_b32 s33, s35, 1
    s_add_u32 s32, s32, s33
    s_mul_i32 s32, s32, 86
    s_add_u32 s40, s40, s32
    s_lshl_b32 s40, s40, 10
    s_add_u32 s40, s40, 6291456
    s_add_u32 s41, s40, 88064
    s_cmp_ge_u32 s28, 6
    s_cselect_b32 s43, s36, 0
    s_cmp_eq_u32 s28, 10
    s_cbranch_scc1 C_NNS
    s_cmp_gt_u32 s28, 10
    s_cbranch_scc1 C_SSS
    s_barrier
    ds_read_b128 v[144:147], v232 offset:0
    ds_read_b64_tr_b16 v[152:153], v248 offset:32768
    ds_read_b64_tr_b16 v[154:155], v248 offset:33536
    ds_read_b64_tr_b16 v[156:157], v248 offset:32832
    ds_read_b64_tr_b16 v[158:159], v248 offset:33600
    ds_read_b64_tr_b16 v[160:161], v248 offset:32896
    ds_read_b64_tr_b16 v[162:163], v248 offset:33664
    ds_read_b128 v[148:151], v233 offset:0
    ds_read_b64_tr_b16 v[164:165], v248 offset:35872
    ds_read_b64_tr_b16 v[166:167], v248 offset:36640
    s_waitcnt lgkmcnt(7)
    v_mfma_f32_32x32x16_bf16 v[0:15], v[152:155], v[144:147], 0
    ds_read_b64_tr_b16 v[168:169], v248 offset:35936
    ds_read_b64_tr_b16 v[170:171], v248 offset:36704
    s_waitcnt lgkmcnt(7)
    v_mfma_f32_32x32x16_bf16 v[16:31], v[156:159], v[144:147], 0
    ds_read_b64_tr_b16 v[172:173], v248 offset:36000
    ds_read_b64_tr_b16 v[174:175], v248 offset:36768
    s_waitcnt lgkmcnt(7)
    v_mfma_f32_32x32x16_bf16 v[32:47], v[160:163], v[144:147], 0
    s_barrier
    ds_read_b128 v[144:147], v234 offset:0
    ds_read_b64_tr_b16 v[152:153], v248 offset:38944
    ds_read_b64_tr_b16 v[154:155], v248 offset:39712
    s_waitcnt lgkmcnt(7)
    v_mfma_f32_32x32x16_bf16 v[0:15], v[164:167], v[148:151], v[0:15]
    ds_read_b64_tr_b16 v[156:157], v248 offset:39008
    ds_read_b64_tr_b16 v[158:159], v248 offset:39776
    s_waitcnt lgkmcnt(7)
    v_mfma_f32_32x32x16_bf16 v[16:31], v[168:171], v[148:151], v[16:31]
    ds_read_b64_tr_b16 v[160:161], v248 offset:39072
    ds_read_b64_tr_b16 v[162:163], v248 offset:39840
    s_waitcnt lgkmcnt(7)
    v_mfma_f32_32x32x16_bf16 v[32:47], v[172:175], v[148:151], v[32:47]
    ds_read_b128 v[148:151], v235 offset:0
    ds_read_b64_tr_b16 v[164:165], v248 offset:42048
    ds_read_b64_tr_b16 v[166:167], v248 offset:42816
    s_waitcnt lgkmcnt(7)
    v_mfma_f32_32x32x16_bf16 v[0:15], v[152:155], v[144:147], v[0:15]
    ds_read_b64_tr_b16 v[168:169], v248 offset:42112
    ds_read_b64_tr_b16 v[170:171], v248 offset:42880
    s_waitcnt lgkmcnt(7)
    v_mfma_f32_32x32x16_bf16 v[16:31], v[156:159], v[144:147], v[16:31]
    ds_read_b64_tr_b16 v[172:173], v248 offset:42176
    ds_read_b64_tr_b16 v[174:175], v248 offset:42944
    s_waitcnt lgkmcnt(7)
    v_mfma_f32_32x32x16_bf16 v[32:47], v[160:163], v[144:147], v[32:47]
    s_barrier
    ds_read_b128 v[144:147], v232 offset:16384
    ds_read_b64_tr_b16 v[152:153], v248 offset:45120
    ds_read_b64_tr_b16 v[154:155], v248 offset:45888
    s_waitcnt lgkmcnt(7)
    v_mfma_f32_32x32x16_bf16 v[0:15], v[164:167], v[148:151], v[0:15]
    ds_read_b64_tr_b16 v[156:157], v248 offset:45184
    ds_read_b64_tr_b16 v[158:159], v248 offset:45952
    s_waitcnt lgkmcnt(7)
    v_mfma_f32_32x32x16_bf16 v[16:31], v[168:171], v[148:151], v[16:31]
    ds_read_b64_tr_b16 v[160:161], v248 offset:45248
    ds_read_b64_tr_b16 v[162:163], v248 offset:46016
    s_waitcnt lgkmcnt(7)
    v_mfma_f32_32x32x16_bf16 v[32:47], v[172:175], v[148:151], v[32:47]
    ds_read_b128 v[148:151], v233 offset:16384
    ds_read_b64_tr_b16 v[164:165], v248 offset:48224
    ds_read_b64_tr_b16 v[166:167], v248 offset:48992
    s_waitcnt lgkmcnt(7)
    v_mfma_f32_32x32x16_bf16 v[0:15], v[152:155], v[144:147], v[0:15]
    ds_read_b64_tr_b16 v[168:169], v248 offset:48288
    ds_read_b64_tr_b16 v[170:171], v248 offset:49056
    s_waitcnt lgkmcnt(7)
    v_mfma_f32_32x32x16_bf16 v[16:31], v[156:159], v[144:147], v[16:31]
    ds_read_b64_tr_b16 v[172:173], v248 offset:48352
    ds_read_b64_tr_b16 v[174:175], v248 offset:49120
    s_waitcnt lgkmcnt(7)
    v_mfma_f32_32x32x16_bf16 v[32:47], v[160:163], v[144:147], v[32:47]
    s_barrier
    ds_read_b128 v[144:147], v234 offset:16384
    ds_read_b64_tr_b16 v[152:153], v248 offset:51296
    ds_read_b64_tr_b16 v[154:155], v248 offset:52064
    s_waitcnt lgkmcnt(7)
    v_mfma_f32_32x32x16_bf16 v[0:15], v[164:167], v[148:151], v[0:15]
    ds_read_b64_tr_b16 v[156:157], v248 offset:51360
    ds_read_b64_tr_b16 v[158:159], v248 offset:52128
    s_waitcnt lgkmcnt(7)
    v_mfma_f32_32x32x16_bf16 v[16:31], v[168:171], v[148:151], v[16:31]
    ds_read_b64_tr_b16 v[160:161], v248 offset:51424
    ds_read_b64_tr_b16 v[162:163], v248 offset:52192
    s_waitcnt lgkmcnt(7)
    v_mfma_f32_32x32x16_bf16 v[32:47], v[172:175], v[148:151], v[32:47]
    ds_read_b128 v[148:151], v235 offset:16384
    ds_read_b64_tr_b16 v[164:165], v248 offset:54400
    ds_read_b64_tr_b16 v[166:167], v248 offset:55168
    s_waitcnt lgkmcnt(7)
    v_mfma_f32_32x32x16_bf16 v[0:15], v[152:155], v[144:147], v[0:15]
    ds_read_b64_tr_b16 v[168:169], v248 offset:54464
    ds_read_b64_tr_b16 v[170:171], v248 offset:55232
    s_waitcnt lgkmcnt(7)
    v_mfma_f32_32x32x16_bf16 v[16:31], v[156:159], v[144:147], v[16:31]
    ds_read_b64_tr_b16 v[172:173], v248 offset:54528
    ds_read_b64_tr_b16 v[174:175], v248 offset:55296
    s_waitcnt lgkmcnt(7)
    v_mfma_f32_32x32x16_bf16 v[32:47], v[160:163], v[144:147], v[32:47]
    s_barrier
    ds_read_b128 v[144:147], v232 offset:32768
    ds_read_b64_tr_b16 v[152:153], v248 offset:57472
    ds_read_b64_tr_b16 v[154:155], v248 offset:58240
    s_waitcnt lgkmcnt(7)
    v_mfma_f32_32x32x16_bf16 v[0:15], v[164:167], v[148:151], v[0:15]
    ds_read_b64_tr_b16 v[156:157], v248 offset:57536
    ds_read_b64_tr_b16 v[158:159], v248 offset:58304
    s_waitcnt lgkmcnt(7)
    v_mfma_f32_32x32x16_bf16 v[16:31], v[168:171], v[148:151], v[16:31]
    ds_read_b64_tr_b16 v[160:161], v248 offset:57600
    ds_read_b64_tr_b16 v[162:163], v248 offset:58368
    s_waitcnt lgkmcnt(7)
    v_mfma_f32_32x32x16_bf16 v[32:47], v[172:175], v[148:151], v[32:47]
    ds_read_b128 v[148:151], v233 offset:32768
    ds_read_b64_tr_b16 v[164:165], v248 offset:60576
    ds_read_b64_tr_b16 v[166:167], v248 offset:61344
    s_waitcnt lgkmcnt(7)
    v_mfma_f32_32x32x16_bf16 v[0:15], v[152:155], v[144:147], v[0:15]
    ds_read_b64_tr_b16 v[168:169], v248 offset:60640
    ds_read_b64_tr_b16 v[170:171], v248 offset:61408
    s_waitcnt lgkmcnt(7)
    v_mfma_f32_32x32x16_bf16 v[16:31], v[156:159], v[144:147], v[16:31]
    s_cmp_lg_u32 s24, 0
    s_cbranch_scc1 C_NOL_nnn
    buffer_load_dwordx2 v[240:241], v251, s[16:19], 0 offen
C_NOL_nnn:
    ds_read_b64_tr_b16 v[172:173], v248 offset:60704
    ds_read_b64_tr_b16 v[174:175], v248 offset:61472
    s_waitcnt lgkmcnt(7)
    v_mfma_f32_32x32x16_bf16 v[32:47], v[160:163], v[144:147], v[32:47]
    s_barrier
    ds_read_b128 v[144:147], v234 offset:32768
    ds_read_b64_tr_b16 v[152:153], v248 offset:0
    ds_read_b64_tr_b16 v[154:155], v248 offset:768
    s_waitcnt lgkmcnt(7)
    v_mfma_f32_32x32x16_bf16 v[0:15], v[164:167], v[148:151], v[0:15]
    ds_read_b64_tr_b16 v[156:157], v248 offset:64
    ds_read_b64_tr_b16 v[158:159], v248 offset:832
    s_waitcnt lgkmcnt(7)
    v_mfma_f32_32x32x16_bf16 v[16:31], v[168:171], v[148:151], v[16:31]
    ds_read_b64_tr_b16 v[160:161], v248 offset:128
    ds_read_b64_tr_b16 v[162:163], v248 offset:896
    s_waitcnt lgkmcnt(7)
    v_mfma_f32_32x32x16_bf16 v[32:47], v[172:175], v[148:151], v[32:47]
    ds_read_b128 v[148:151], v235 offset:32768
    ds_read_b64_tr_b16 v[164:165], v248 offset:3104
    ds_read_b64_tr_b16 v[166:167], v248 offset:3872
    s_waitcnt lgkmcnt(7)
    v_mfma_f32_32x32x16_bf16 v[0:15], v[152:155], v[144:147], v[0:15]
    ds_read_b64_tr_b16 v[168:169], v248 offset:3168
    ds_read_b64_tr_b16 v[170:171], v248 offset:3936
    s_waitcnt lgkmcnt(7)
    v_mfma_f32_32x32x16_bf16 v[16:31], v[156:159], v[144:147], v[16:31]
    ds_read_b64_tr_b16 v[172:173], v248 offset:3232
    ds_read_b64_tr_b16 v[174:175], v248 offset:4000
    s_waitcnt lgkmcnt(7)
    v_mfma_f32_32x32x16_bf16 v[32:47], v[160:163], v[144:147], v[32:47]
    s_barrier
    ds_read_b128 v[144:147], v232 offset:49152
    ds_read_b64_tr_b16 v[152:153], v248 offset:6176
    ds_read_b64_tr_b16 v[154:155], v248 offset:6944
    s_waitcnt lgkmcnt(7)
    v_mfma_f32_32x32x16_bf16 v[0:15], v[164:167], v[148:151], v[0:15]
    ds_read_b64_tr_b16 v[156:157], v248 offset:6240
    ds_read_b64_tr_b16 v[158:159], v248 offset:7008
    s_waitcnt lgkmcnt(7)
    v_mfma_f32_32x32x16_bf16 v[16:31], v[168:171], v[148:151], v[16:31]
    ds_read_b64_tr_b16 v[160:161], v248 offset:6304
    ds_read_b64_tr_b16 v[162:163], v248 offset:7072
    s_waitcnt lgkmcnt(7)
    v_mfma_f32_32x32x16_bf16 v[32:47], v[172:175], v[148:151], v[32:47]
    ds_read_b128 v[148:151], v233 offset:49152
    ds_read_b64_tr_b16 v[164:165], v248 offset:9280
    ds_read_b64_tr_b16 v[166:167], v248 offset:10048
    s_waitcnt lgkmcnt(7)
    v_mfma_f32_32x32x16_bf16 v[0:15], v[152:155], v[144:147], v[0:15]
    ds_read_b64_tr_b16 v[168:169], v248 offset:9344
    ds_read_b64_tr_b16 v[170:171], v248 offset:10112
    s_waitcnt lgkmcnt(7)
    v_mfma_f32_32x32x16_bf16 v[16:31], v[156:159], v[144:147], v[16:31]
    ds_read_b64_tr_b16 v[172:173], v248 offset:9408
    ds_read_b64_tr_b16 v[174:175], v248 offset:10176
    s_waitcnt lgkmcnt(7)
    v_mfma_f32_32x32x16_bf16 v[32:47], v[160:163], v[144:147], v[32:47]
    s_barrier
    ds_read_b128 v[144:147], v234 offset:49152
    ds_read_b64_tr_b16 v[152:153], v248 offset:16384
    ds_read_b64_tr_b16 v[154:155], v248 offset:17152
    s_waitcnt lgkmcnt(7)
    v_mfma_f32_32x32x16_bf16 v[0:15], v[164:167], v[148:151], v[0:15]
    ds_read_b64_tr_b16 v[156:157], v248 offset:16448
    ds_read_b64_tr_b16 v[158:159], v248 offset:17216
    s_waitcnt lgkmcnt(7)
    v_mfma_f32_32x32x16_bf16 v[16:31], v[168:171], v[148:151], v[16:31]
    ds_read_b64_tr_b16 v[160:161], v248 offset:16512
    ds_read_b64_tr_b16 v[162:163], v248 offset:17280
    s_waitcnt lgkmcnt(7)
    v_mfma_f32_32x32x16_bf16 v[32:47], v[172:175], v[148:151], v[32:47]
    ds_read_b128 v[148:151], v235 offset:49152
    ds_read_b64_tr_b16 v[164:165], v248 offset:19488
    ds_read_b64_tr_b16 v[166:167], v248 offset:20256
    s_waitcnt lgkmcnt(7)
    v_mfma_f32_32x32x16_bf16 v[0:15], v[152:155], v[144:147], v[0:15]
    ds_read_b64_tr_b16 v[168:169], v248 offset:19552
    ds_read_b64_tr_b16 v[170:171], v248 offset:20320
    s_waitcnt lgkmcnt(7)
    v_mfma_f32_32x32x16_bf16 v[16:31], v[156:159], v[144:147], v[16:31]
    ds_read_b64_tr_b16 v[172:173], v248 offset:19616
    ds_read_b64_tr_b16 v[174:175], v248 offset:20384
    s_waitcnt lgkmcnt(7)
    v_mfma_f32_32x32x16_bf16 v[32:47], v[160:163], v[144:147], v[32:47]
    s_barrier
    ds_read_b64_tr_b16 v[192:193], v252 offset:22560
    ds_read_b64_tr_b16 v[194:195], v252 offset:23328
    ds_read_b128 v[176:179], v224 offset:0
    s_waitcnt lgkmcnt(7)
    v_mfma_f32_32x32x16_bf16 v[0:15], v[164:167], v[148:151], v[0:15]
    ds_read_b128 v[180:183], v224 offset:4096
    ds_read_b64_tr_b16 v[196:197], v252 offset:22592
    ds_read_b64_tr_b16 v[198:199], v252 offset:23360
    s_waitcnt lgkmcnt(8)
    v_mfma_f32_32x32x16_bf16 v[16:31], v[168:171], v[148:151], v[16:31]
    ds_read_b64_tr_b16 v[200:201], v252 offset:22624
    ds_read_b64_tr_b16 v[202:203], v252 offset:23392
    s_waitcnt lgkmcnt(8)
    v_mfma_f32_32x32x16_bf16 v[32:47], v[172:175], v[148:151], v[32:47]
    s_waitcnt lgkmcnt(5)
    v_mfma_f32_32x32x16_bf16 v[48:63], v[192:195], v[176:179], 0
    s_waitcnt lgkmcnt(4)
    v_mfma_f32_32x32x16_bf16 v[64:79], v[192:195], v[180:183], 0
    s_waitcnt lgkmcnt(0)
    s_barrier
    ds_read_b64_tr_b16 v[204:205], v252 offset:32768
    ds_read_b64_tr_b16 v[206:207], v252 offset:33536
    ds_read_b128 v[184:187], v225 offset:0
    v_mfma_f32_32x32x16_bf16 v[80:95], v[196:199], v[176:179], 0
    ds_read_b128 v[188:191], v225 offset:4096
    ds_read_b64_tr_b16 v[208:209], v252 offset:32800
    ds_read_b64_tr_b16 v[210:211], v252 offset:33568
    v_mfma_f32_32x32x16_bf16 v[96:111], v[196:199], v[180:183], 0
    ds_read_b64_tr_b16 v[212:213], v252 offset:32832
    ds_read_b64_tr_b16 v[214:215], v252 offset:33600
    v_mfma_f32_32x32x16_bf16 v[112:127], v[200:203], v[176:179], 0
    v_mfma_f32_32x32x16_bf16 v[128:143], v[200:203], v[180:183], 0
    s_waitcnt lgkmcnt(5)
    v_mfma_f32_32x32x16_bf16 v[48:63], v[204:207], v[184:187], v[48:63]
    s_waitcnt lgkmcnt(4)
    v_mfma_f32_32x32x16_bf16 v[64:79], v[204:207], v[188:191], v[64:79]
    s_waitcnt lgkmcnt(0)
    s_barrier
    ds_read_b128 v[144:147], v236 offset:0
    ds_read_b64_tr_b16 v[152:153], v248 offset:38944
    ds_read_b64_tr_b16 v[154:155], v248 offset:39712
    v_mfma_f32_32x32x16_bf16 v[80:95], v[208:211], v[184:187], v[80:95]
    ds_read_b64_tr_b16 v[156:157], v248 offset:39008
    ds_read_b64_tr_b16 v[158:159], v248 offset:39776
    v_mfma_f32_32x32x16_bf16 v[96:111], v[208:211], v[188:191], v[96:111]
    ds_read_b64_tr_b16 v[160:161], v248 offset:39072
    ds_read_b64_tr_b16 v[162:163], v248 offset:39840
    v_mfma_f32_32x32x16_bf16 v[112:127], v[212:215], v[184:187], v[112:127]
    v_mfma_f32_32x32x16_bf16 v[128:143], v[212:215], v[188:191], v[128:143]
    ds_read_b128 v[148:151], v237 offset:0
    ds_read_b64_tr_b16 v[164:165], v248 offset:42048
    ds_read_b64_tr_b16 v[166:167], v248 offset:42816
    s_waitcnt lgkmcnt(7)
    v_mfma_f32_32x32x16_bf16 v[0:15], v[152:155], v[144:147], v[0:15]
    ds_read_b64_tr_b16 v[168:169], v248 offset:42112
    ds_read_b64_tr_b16 v[170:171], v248 offset:42880
    s_waitcnt lgkmcnt(7)
    v_mfma_f32_32x32x16_bf16 v[16:31], v[156:159], v[144:147], v[16:31]
    ds_read_b64_tr_b16 v[172:173], v248 offset:42176
    ds_read_b64_tr_b16 v[174:175], v248 offset:42944
    s_waitcnt lgkmcnt(7)
    v_mfma_f32_32x32x16_bf16 v[32:47], v[160:163], v[144:147], v[32:47]
    s_cmp_lg_u32 s24, 0
    s_cbranch_scc1 C_NON_nnn
    s_mov_b64 exec, 1
    v_mov_b32 v242, 162976
C_NOR_nnn:
    s_waitcnt vmcnt(0)
    v_cmp_ne_u32 vcc, 0, v240
    s_nop 1
    s_cbranch_vccnz C_NOK_nnn
    buffer_load_dwordx2 v[240:241], v251, s[16:19], 0 offen sc0 sc1
    s_branch C_NOR_nnn
C_NOK_nnn:
    ds_write_b64 v242, v[240:241]
    s_mov_b64 exec, -1
C_NON_nnn:
    s_waitcnt vmcnt(0)
    s_barrier
    ds_read_b128 v[144:147], v238 offset:0
    ds_read_b64_tr_b16 v[152:153], v248 offset:45120
    ds_read_b64_tr_b16 v[154:155], v248 offset:45888
    s_waitcnt lgkmcnt(7)
    v_mfma_f32_32x32x16_bf16 v[0:15], v[164:167], v[148:151], v[0:15]
    ds_read_b64_tr_b16 v[156:157], v248 offset:45184
    ds_read_b64_tr_b16 v[158:159], v248 offset:45952
    s_waitcnt lgkmcnt(7)
    v_mfma_f32_32x32x16_bf16 v[16:31], v[168:171], v[148:151], v[16:31]
    ds_read_b64_tr_b16 v[160:161], v248 offset:45248
    ds_read_b64_tr_b16 v[162:163], v248 offset:46016
    s_waitcnt lgkmcnt(7)
    v_mfma_f32_32x32x16_bf16 v[32:47], v[172:175], v[148:151], v[32:47]
    ds_read_b128 v[148:151], v239 offset:0
    ds_read_b64_tr_b16 v[164:165], v248 offset:48224
    ds_read_b64_tr_b16 v[166:167], v248 offset:48992
    s_waitcnt lgkmcnt(7)
    v_mfma_f32_32x32x16_bf16 v[0:15], v[152:155], v[144:147], v[0:15]
    ds_read_b64_tr_b16 v[168:169], v248 offset:48288
    ds_read_b64_tr_b16 v[170:171], v248 offset:49056
    s_waitcnt lgkmcnt(7)
    v_mfma_f32_32x32x16_bf16 v[16:31], v[156:159], v[144:147], v[16:31]
    ds_read_b64_tr_b16 v[172:173], v248 offset:48352
    ds_read_b64_tr_b16 v[174:175], v248 offset:49120
    s_waitcnt lgkmcnt(7)
    v_mfma_f32_32x32x16_bf16 v[32:47], v[160:163], v[144:147], v[32:47]
    s_barrier
    ds_read_b64_tr_b16 v[192:193], v252 offset:51296
    ds_read_b64_tr_b16 v[194:195], v252 offset:52064
    ds_read_b128 v[176:179], v226 offset:0
    s_waitcnt lgkmcnt(7)
    v_mfma_f32_32x32x16_bf16 v[0:15], v[164:167], v[148:151], v[0:15]
    ds_read_b128 v[180:183], v226 offset:4096
    ds_read_b64_tr_b16 v[196:197], v252 offset:51328
    ds_read_b64_tr_b16 v[198:199], v252 offset:52096
    s_waitcnt lgkmcnt(8)
    v_mfma_f32_32x32x16_bf16 v[16:31], v[168:171], v[148:151], v[16:31]
    ds_read_b64_tr_b16 v[200:201], v252 offset:51360
    ds_read_b64_tr_b16 v[202:203], v252 offset:52128
    s_waitcnt lgkmcnt(8)
    v_mfma_f32_32x32x16_bf16 v[32:47], v[172:175], v[148:151], v[32:47]
    s_waitcnt lgkmcnt(5)
    v_mfma_f32_32x32x16_bf16 v[48:63], v[192:195], v[176:179], v[48:63]
    s_waitcnt lgkmcnt(4)
    v_mfma_f32_32x32x16_bf16 v[64:79], v[192:195], v[180:183], v[64:79]
    s_waitcnt lgkmcnt(0)
    s_barrier
    ds_read_b64_tr_b16 v[204:205], v252 offset:57472
    ds_read_b64_tr_b16 v[206:207], v252 offset:58240
    ds_read_b128 v[184:187], v227 offset:0
    v_mfma_f32_32x32x16_bf16 v[80:95], v[196:199], v[176:179], v[80:95]
    ds_read_b128 v[188:191], v227 offset:4096
    ds_read_b64_tr_b16 v[208:209], v252 offset:57504
    ds_read_b64_tr_b16 v[210:211], v252 offset:58272
    v_mfma_f32_32x32x16_bf16 v[96:111], v[196:199], v[180:183], v[96:111]
    ds_read_b64_tr_b16 v[212:213], v252 offset:57536
    ds_read_b64_tr_b16 v[214:215], v252 offset:58304
    v_mfma_f32_32x32x16_bf16 v[112:127], v[200:203], v[176:179], v[112:127]
    v_mfma_f32_32x32x16_bf16 v[128:143], v[200:203], v[180:183], v[128:143]
    s_waitcnt lgkmcnt(5)
    v_mfma_f32_32x32x16_bf16 v[48:63], v[204:207], v[184:187], v[48:63]
    s_waitcnt lgkmcnt(4)
    v_mfma_f32_32x32x16_bf16 v[64:79], v[204:207], v[188:191], v[64:79]
    s_waitcnt lgkmcnt(0)
    s_barrier
    ds_read_b128 v[144:147], v236 offset:16384
    ds_read_b64_tr_b16 v[152:153], v248 offset:16384
    ds_read_b64_tr_b16 v[154:155], v248 offset:17152
    v_mfma_f32_32x32x16_bf16 v[80:95], v[208:211], v[184:187], v[80:95]
    ds_read_b64_tr_b16 v[156:157], v248 offset:16448
    ds_read_b64_tr_b16 v[158:159], v248 offset:17216
    v_mfma_f32_32x32x16_bf16 v[96:111], v[208:211], v[188:191], v[96:111]
    ds_read_b64_tr_b16 v[160:161], v248 offset:16512
    ds_read_b64_tr_b16 v[162:163], v248 offset:17280
    v_mfma_f32_32x32x16_bf16 v[112:127], v[212:215], v[184:187], v[112:127]
    v_mfma_f32_32x32x16_bf16 v[128:143], v[212:215], v[188:191], v[128:143]
    ds_read_b128 v[148:151], v237 offset:16384
    ds_read_b64_tr_b16 v[164:165], v248 offset:19488
    ds_read_b64_tr_b16 v[166:167], v248 offset:20256
    s_waitcnt lgkmcnt(7)
    v_mfma_f32_32x32x16_bf16 v[0:15], v[152:155], v[144:147], v[0:15]
    ds_read_b64_tr_b16 v[168:169], v248 offset:19552
    ds_read_b64_tr_b16 v[170:171], v248 offset:20320
    s_waitcnt lgkmcnt(7)
    v_mfma_f32_32x32x16_bf16 v[16:31], v[156:159], v[144:147], v[16:31]
    ds_read_b64_tr_b16 v[172:173], v248 offset:19616
    ds_read_b64_tr_b16 v[174:175], v248 offset:20384
    s_waitcnt lgkmcnt(7)
    v_mfma_f32_32x32x16_bf16 v[32:47], v[160:163], v[144:147], v[32:47]
    s_barrier
    ds_read_b128 v[144:147], v238 offset:16384
    ds_read_b64_tr_b16 v[152:153], v248 offset:22560
    ds_read_b64_tr_b16 v[154:155], v248 offset:23328
    s_waitcnt lgkmcnt(7)
    v_mfma_f32_32x32x16_bf16 v[0:15], v[164:167], v[148:151], v[0:15]
    ds_read_b64_tr_b16 v[156:157], v248 offset:22624
    ds_read_b64_tr_b16 v[158:159], v248 offset:23392
    s_waitcnt lgkmcnt(7)
    v_mfma_f32_32x32x16_bf16 v[16:31], v[168:171], v[148:151], v[16:31]
    ds_read_b64_tr_b16 v[160:161], v248 offset:22688
    ds_read_b64_tr_b16 v[162:163], v248 offset:23456
    s_waitcnt lgkmcnt(7)
    v_mfma_f32_32x32x16_bf16 v[32:47], v[172:175], v[148:151], v[32:47]
    ds_read_b128 v[148:151], v239 offset:16384
    ds_read_b64_tr_b16 v[164:165], v248 offset:25664
    ds_read_b64_tr_b16 v[166:167], v248 offset:26432
    s_waitcnt lgkmcnt(7)
    v_mfma_f32_32x32x16_bf16 v[0:15], v[152:155], v[144:147], v[0:15]
    ds_read_b64_tr_b16 v[168:169], v248 offset:25728
    ds_read_b64_tr_b16 v[170:171], v248 offset:26496
    s_waitcnt lgkmcnt(7)
    v_mfma_f32_32x32x16_bf16 v[16:31], v[156:159], v[144:147], v[16:31]
    ds_read_b64_tr_b16 v[172:173], v248 offset:25792
    ds_read_b64_tr_b16 v[174:175], v248 offset:26560
    s_waitcnt lgkmcnt(7)
    v_mfma_f32_32x32x16_bf16 v[32:47], v[160:163], v[144:147], v[32:47]
    s_barrier
    ds_read_b64_tr_b16 v[192:193], v252 offset:32768
    ds_read_b64_tr_b16 v[194:195], v252 offset:33536
    ds_read_b128 v[176:179], v224 offset:16384
    s_waitcnt lgkmcnt(7)
    v_mfma_f32_32x32x16_bf16 v[0:15], v[164:167], v[148:151], v[0:15]
    ds_read_b128 v[180:183], v224 offset:20480
    ds_read_b64_tr_b16 v[196:197], v252 offset:32800
    ds_read_b64_tr_b16 v[198:199], v252 offset:33568
    s_waitcnt lgkmcnt(8)
    v_mfma_f32_32x32x16_bf16 v[16:31], v[168:171], v[148:151], v[16:31]
    ds_read_b64_tr_b16 v[200:201], v252 offset:32832
    ds_read_b64_tr_b16 v[202:203], v252 offset:33600
    s_waitcnt lgkmcnt(8)
    v_mfma_f32_32x32x16_bf16 v[32:47], v[172:175], v[148:151], v[32:47]
    s_waitcnt lgkmcnt(5)
    v_mfma_f32_32x32x16_bf16 v[48:63], v[192:195], v[176:179], v[48:63]
    s_waitcnt lgkmcnt(4)
    v_mfma_f32_32x32x16_bf16 v[64:79], v[192:195], v[180:183], v[64:79]
    s_waitcnt lgkmcnt(0)
    s_barrier
    ds_read_b64_tr_b16 v[204:205], v252 offset:38944
    ds_read_b64_tr_b16 v[206:207], v252 offset:39712
    ds_read_b128 v[184:187], v225 offset:16384
    v_mfma_f32_32x32x16_bf16 v[80:95], v[196:199], v[176:179], v[80:95]
    ds_read_b128 v[188:191], v225 offset:20480
    ds_read_b64_tr_b16 v[208:209], v252 offset:38976
    ds_read_b64_tr_b16 v[210:211], v252 offset:39744
    v_mfma_f32_32x32x16_bf16 v[96:111], v[196:199], v[180:183], v[96:111]
    ds_read_b64_tr_b16 v[212:213], v252 offset:39008
    ds_read_b64_tr_b16 v[214:215], v252 offset:39776
    v_mfma_f32_32x32x16_bf16 v[112:127], v[200:203], v[176:179], v[112:127]
    v_mfma_f32_32x32x16_bf16 v[128:143], v[200:203], v[180:183], v[128:143]
    s_waitcnt lgkmcnt(5)
    v_mfma_f32_32x32x16_bf16 v[48:63], v[204:207], v[184:187], v[48:63]
    s_waitcnt lgkmcnt(4)
    v_mfma_f32_32x32x16_bf16 v[64:79], v[204:207], v[188:191], v[64:79]
    s_waitcnt lgkmcnt(0)
    s_barrier
    ds_read_b128 v[144:147], v236 offset:32768
    ds_read_b64_tr_b16 v[152:153], v248 offset:45120
    ds_read_b64_tr_b16 v[154:155], v248 offset:45888
    v_mfma_f32_32x32x16_bf16 v[80:95], v[208:211], v[184:187], v[80:95]
    ds_read_b64_tr_b16 v[156:157], v248 offset:45184
    ds_read_b64_tr_b16 v[158:159], v248 offset:45952
    v_mfma_f32_32x32x16_bf16 v[96:111], v[208:211], v[188:191], v[96:111]
    ds_read_b64_tr_b16 v[160:161], v248 offset:45248
    ds_read_b64_tr_b16 v[162:163], v248 offset:46016
    v_mfma_f32_32x32x16_bf16 v[112:127], v[212:215], v[184:187], v[112:127]
    v_mfma_f32_32x32x16_bf16 v[128:143], v[212:215], v[188:191], v[128:143]
    ds_read_b128 v[148:151], v237 offset:32768
    ds_read_b64_tr_b16 v[164:165], v248 offset:48224
    ds_read_b64_tr_b16 v[166:167], v248 offset:48992
    s_waitcnt lgkmcnt(7)
    v_mfma_f32_32x32x16_bf16 v[0:15], v[152:155], v[144:147], v[0:15]
    ds_read_b64_tr_b16 v[168:169], v248 offset:48288
    ds_read_b64_tr_b16 v[170:171], v248 offset:49056
    s_waitcnt lgkmcnt(7)
    v_mfma_f32_32x32x16_bf16 v[16:31], v[156:159], v[144:147], v[16:31]
    ds_read_b64_tr_b16 v[172:173], v248 offset:48352
    ds_read_b64_tr_b16 v[174:175], v248 offset:49120
    s_waitcnt lgkmcnt(7)
    v_mfma_f32_32x32x16_bf16 v[32:47], v[160:163], v[144:147], v[32:47]
    s_barrier
    ds_read_b128 v[144:147], v238 offset:32768
    ds_read_b64_tr_b16 v[152:153], v248 offset:51296
    ds_read_b64_tr_b16 v[154:155], v248 offset:52064
    s_waitcnt lgkmcnt(7)
    v_mfma_f32_32x32x16_bf16 v[0:15], v[164:167], v[148:151], v[0:15]
    ds_read_b64_tr_b16 v[156:157], v248 offset:51360
    ds_read_b64_tr_b16 v[158:159], v248 offset:52128
    s_waitcnt lgkmcnt(7)
    v_mfma_f32_32x32x16_bf16 v[16:31], v[168:171], v[148:151], v[16:31]
    ds_read_b64_tr_b16 v[160:161], v248 offset:51424
    ds_read_b64_tr_b16 v[162:163], v248 offset:52192
    s_waitcnt lgkmcnt(7)
    v_mfma_f32_32x32x16_bf16 v[32:47], v[172:175], v[148:151], v[32:47]
    ds_read_b128 v[148:151], v239 offset:32768
    ds_read_b64_tr_b16 v[164:165], v248 offset:54400
    ds_read_b64_tr_b16 v[166:167], v248 offset:55168
    s_waitcnt lgkmcnt(7)
    v_mfma_f32_32x32x16_bf16 v[0:15], v[152:155], v[144:147], v[0:15]
    ds_read_b64_tr_b16 v[168:169], v248 offset:54464
    ds_read_b64_tr_b16 v[170:171], v248 offset:55232
    s_waitcnt lgkmcnt(7)
    v_mfma_f32_32x32x16_bf16 v[16:31], v[156:159], v[144:147], v[16:31]
    ds_read_b64_tr_b16 v[172:173], v248 offset:54528
    ds_read_b64_tr_b16 v[174:175], v248 offset:55296
    s_waitcnt lgkmcnt(7)
    v_mfma_f32_32x32x16_bf16 v[32:47], v[160:163], v[144:147], v[32:47]
    s_barrier
    ds_read_b64_tr_b16 v[192:193], v252 offset:57472
    ds_read_b64_tr_b16 v[194:195], v252 offset:58240
    ds_read_b128 v[176:179], v226 offset:16384
    s_waitcnt lgkmcnt(7)
    v_mfma_f32_32x32x16_bf16 v[0:15], v[164:167], v[148:151], v[0:15]
    ds_read_b128 v[180:183], v226 offset:20480
    ds_read_b64_tr_b16 v[196:197], v252 offset:57504
    ds_read_b64_tr_b16 v[198:199], v252 offset:58272
    s_waitcnt lgkmcnt(8)
    v_mfma_f32_32x32x16_bf16 v[16:31], v[168:171], v[148:151], v[16:31]
    ds_read_b64_tr_b16 v[200:201], v252 offset:57536
    ds_read_b64_tr_b16 v[202:203], v252 offset:58304
    s_waitcnt lgkmcnt(8)
    v_mfma_f32_32x32x16_bf16 v[32:47], v[172:175], v[148:151], v[32:47]
    s_waitcnt lgkmcnt(5)
    v_mfma_f32_32x32x16_bf16 v[48:63], v[192:195], v[176:179], v[48:63]
    s_waitcnt lgkmcnt(4)
    v_mfma_f32_32x32x16_bf16 v[64:79], v[192:195], v[180:183], v[64:79]
    s_waitcnt lgkmcnt(0)
    s_barrier
    ds_read_b64_tr_b16 v[204:205], v217 offset:0
    ds_read_b64_tr_b16 v[206:207], v217 offset:768
    ds_read_b128 v[184:187], v227 offset:16384
    v_mfma_f32_32x32x16_bf16 v[80:95], v[196:199], v[176:179], v[80:95]
    ds_read_b128 v[188:191], v227 offset:20480
    ds_read_b64_tr_b16 v[208:209], v217 offset:32
    ds_read_b64_tr_b16 v[210:211], v217 offset:800
    v_mfma_f32_32x32x16_bf16 v[96:111], v[196:199], v[180:183], v[96:111]
    ds_read_b64_tr_b16 v[212:213], v217 offset:64
    ds_read_b64_tr_b16 v[214:215], v217 offset:832
    v_mfma_f32_32x32x16_bf16 v[112:127], v[200:203], v[176:179], v[112:127]
    v_mfma_f32_32x32x16_bf16 v[128:143], v[200:203], v[180:183], v[128:143]
    s_waitcnt lgkmcnt(5)
    v_mfma_f32_32x32x16_bf16 v[48:63], v[204:207], v[184:187], v[48:63]
    s_waitcnt lgkmcnt(4)
    v_mfma_f32_32x32x16_bf16 v[64:79], v[204:207], v[188:191], v[64:79]
    s_waitcnt lgkmcnt(0)
    s_barrier
    ds_read_b128 v[144:147], v236 offset:49152
    ds_read_b64_tr_b16 v[152:153], v216 offset:6176
    ds_read_b64_tr_b16 v[154:155], v216 offset:6944
    v_mfma_f32_32x32x16_bf16 v[80:95], v[208:211], v[184:187], v[80:95]
    ds_read_b64_tr_b16 v[156:157], v216 offset:6240
    ds_read_b64_tr_b16 v[158:159], v216 offset:7008
    v_mfma_f32_32x32x16_bf16 v[96:111], v[208:211], v[188:191], v[96:111]
    ds_read_b64_tr_b16 v[160:161], v216 offset:6304
    ds_read_b64_tr_b16 v[162:163], v216 offset:7072
    v_mfma_f32_32x32x16_bf16 v[112:127], v[212:215], v[184:187], v[112:127]
    v_mfma_f32_32x32x16_bf16 v[128:143], v[212:215], v[188:191], v[128:143]
    ds_read_b128 v[148:151], v237 offset:49152
    ds_read_b64_tr_b16 v[164:165], v216 offset:9280
    ds_read_b64_tr_b16 v[166:167], v216 offset:10048
    s_waitcnt lgkmcnt(7)
    v_mfma_f32_32x32x16_bf16 v[0:15], v[152:155], v[144:147], v[0:15]
    ds_read_b64_tr_b16 v[168:169], v216 offset:9344
    ds_read_b64_tr_b16 v[170:171], v216 offset:10112
    s_waitcnt lgkmcnt(7)
    v_mfma_f32_32x32x16_bf16 v[16:31], v[156:159], v[144:147], v[16:31]
    ds_read_b64_tr_b16 v[172:173], v216 offset:9408
    ds_read_b64_tr_b16 v[174:175], v216 offset:10176
    s_waitcnt lgkmcnt(7)
    v_mfma_f32_32x32x16_bf16 v[32:47], v[160:163], v[144:147], v[32:47]
    s_barrier
    ds_read_b128 v[144:147], v238 offset:49152
    ds_read_b64_tr_b16 v[152:153], v248 offset:32768
    ds_read_b64_tr_b16 v[154:155], v248 offset:33536
    s_waitcnt lgkmcnt(7)
    v_mfma_f32_32x32x16_bf16 v[0:15], v[164:167], v[148:151], v[0:15]
    ds_read_b64_tr_b16 v[156:157], v248 offset:32832
    ds_read_b64_tr_b16 v[158:159], v248 offset:33600
    s_waitcnt lgkmcnt(7)
    v_mfma_f32_32x32x16_bf16 v[16:31], v[168:171], v[148:151], v[16:31]
    ds_read_b64_tr_b16 v[160:161], v248 offset:32896
    ds_read_b64_tr_b16 v[162:163], v248 offset:33664
    s_waitcnt lgkmcnt(7)
    v_mfma_f32_32x32x16_bf16 v[32:47], v[172:175], v[148:151], v[32:47]
    ds_read_b128 v[148:151], v239 offset:49152
    ds_read_b64_tr_b16 v[164:165], v248 offset:35872
    ds_read_b64_tr_b16 v[166:167], v248 offset:36640
    s_waitcnt lgkmcnt(7)
    v_mfma_f32_32x32x16_bf16 v[0:15], v[152:155], v[144:147], v[0:15]
    ds_read_b64_tr_b16 v[168:169], v248 offset:35936
    ds_read_b64_tr_b16 v[170:171], v248 offset:36704
    s_waitcnt lgkmcnt(7)
    v_mfma_f32_32x32x16_bf16 v[16:31], v[156:159], v[144:147], v[16:31]
    ds_read_b64_tr_b16 v[172:173], v248 offset:36000
    ds_read_b64_tr_b16 v[174:175], v248 offset:36768
    s_waitcnt lgkmcnt(7)
    v_mfma_f32_32x32x16_bf16 v[32:47], v[160:163], v[144:147], v[32:47]
    s_barrier
    ds_read_b64_tr_b16 v[192:193], v252 offset:38944
    ds_read_b64_tr_b16 v[194:195], v252 offset:39712
    ds_read_b128 v[176:179], v224 offset:32768
    s_waitcnt lgkmcnt(7)
    v_mfma_f32_32x32x16_bf16 v[0:15], v[164:167], v[148:151], v[0:15]
    ds_read_b128 v[180:183], v224 offset:36864
    ds_read_b64_tr_b16 v[196:197], v252 offset:38976
    ds_read_b64_tr_b16 v[198:199], v252 offset:39744
    s_waitcnt lgkmcnt(8)
    v_mfma_f32_32x32x16_bf16 v[16:31], v[168:171], v[148:151], v[16:31]
    ds_read_b64_tr_b16 v[200:201], v252 offset:39008
    ds_read_b64_tr_b16 v[202:203], v252 offset:39776
    s_waitcnt lgkmcnt(8)
    v_mfma_f32_32x32x16_bf16 v[32:47], v[172:175], v[148:151], v[32:47]
    s_branch C_P2
C_NNS:
    s_barrier
    ds_read_b128 v[144:147], v232 offset:0
    ds_read_b64_tr_b16 v[152:153], v248 offset:32768
    ds_read_b64_tr_b16 v[154:155], v248 offset:33536
    ds_read_b64_tr_b16 v[156:157], v248 offset:32832
    ds_read_b64_tr_b16 v[158:159], v248 offset:33600
    ds_read_b64_tr_b16 v[160:161], v248 offset:32896
    ds_read_b64_tr_b16 v[162:163], v248 offset:33664
    ds_read_b128 v[148:151], v233 offset:0
    ds_read_b64_tr_b16 v[164:165], v248 offset:35872
    ds_read_b64_tr_b16 v[166:167], v248 offset:36640
    s_waitcnt lgkmcnt(7)
    v_mfma_f32_32x32x16_bf16 v[0:15], v[152:155], v[144:147], 0
    ds_read_b64_tr_b16 v[168:169], v248 offset:35936
    ds_read_b64_tr_b16 v[170:171], v248 offset:36704
    s_waitcnt lgkmcnt(7)
    v_mfma_f32_32x32x16_bf16 v[16:31], v[156:159], v[144:147], 0
    ds_read_b64_tr_b16 v[172:173], v248 offset:36000
    ds_read_b64_tr_b16 v[174:175], v248 offset:36768
    s_waitcnt lgkmcnt(7)
    v_mfma_f32_32x32x16_bf16 v[32:47], v[144:147], v[160:163], 0
    s_barrier
    ds_read_b128 v[144:147], v234 offset:0
    ds_read_b64_tr_b16 v[152:153], v248 offset:38944
    ds_read_b64_tr_b16 v[154:155], v248 offset:39712
    s_waitcnt lgkmcnt(7)
    v_mfma_f32_32x32x16_bf16 v[0:15], v[164:167], v[148:151], v[0:15]
    ds_read_b64_tr_b16 v[156:157], v248 offset:39008
    ds_read_b64_tr_b16 v[158:159], v248 offset:39776
    s_waitcnt lgkmcnt(7)
    v_mfma_f32_32x32x16_bf16 v[16:31], v[168:171], v[148:151], v[16:31]
    ds_read_b64_tr_b16 v[160:161], v248 offset:39072
    ds_read_b64_tr_b16 v[162:163], v248 offset:39840
    s_waitcnt lgkmcnt(7)
    v_mfma_f32_32x32x16_bf16 v[32:47], v[148:151], v[172:175], v[32:47]
    ds_read_b128 v[148:151], v235 offset:0
    ds_read_b64_tr_b16 v[164:165], v248 offset:42048
    ds_read_b64_tr_b16 v[166:167], v248 offset:42816
    s_waitcnt lgkmcnt(7)
    v_mfma_f32_32x32x16_bf16 v[0:15], v[152:155], v[144:147], v[0:15]
    ds_read_b64_tr_b16 v[168:169], v248 offset:42112
    ds_read_b64_tr_b16 v[170:171], v248 offset:42880
    s_waitcnt lgkmcnt(7)
    v_mfma_f32_32x32x16_bf16 v[16:31], v[156:159], v[144:147], v[16:31]
    ds_read_b64_tr_b16 v[172:173], v248 offset:42176
    ds_read_b64_tr_b16 v[174:175], v248 offset:42944
    s_waitcnt lgkmcnt(7)
    v_mfma_f32_32x32x16_bf16 v[32:47], v[144:147], v[160:163], v[32:47]
    s_barrier
    ds_read_b128 v[144:147], v232 offset:16384
    ds_read_b64_tr_b16 v[152:153], v248 offset:45120
    ds_read_b64_tr_b16 v[154:155], v248 offset:45888
    s_waitcnt lgkmcnt(7)
    v_mfma_f32_32x32x16_bf16 v[0:15], v[164:167], v[148:151], v[0:15]
    ds_read_b64_tr_b16 v[156:157], v248 offset:45184
    ds_read_b64_tr_b16 v[158:159], v248 offset:45952
    s_waitcnt lgkmcnt(7)
    v_mfma_f32_32x32x16_bf16 v[16:31], v[168:171], v[148:151], v[16:31]
    ds_read_b64_tr_b16 v[160:161], v248 offset:45248
    ds_read_b64_tr_b16 v[162:163], v248 offset:46016
    s_waitcnt lgkmcnt(7)
    v_mfma_f32_32x32x16_bf16 v[32:47], v[148:151], v[172:175], v[32:47]
    ds_read_b128 v[148:151], v233 offset:16384
    ds_read_b64_tr_b16 v[164:165], v248 offset:48224
    ds_read_b64_tr_b16 v[166:167], v248 offset:48992
    s_waitcnt lgkmcnt(7)
    v_mfma_f32_32x32x16_bf16 v[0:15], v[152:155], v[144:147], v[0:15]
    ds_read_b64_tr_b16 v[168:169], v248 offset:48288
    ds_read_b64_tr_b16 v[170:171], v248 offset:49056
    s_waitcnt lgkmcnt(7)
    v_mfma_f32_32x32x16_bf16 v[16:31], v[156:159], v[144:147], v[16:31]
    ds_read_b64_tr_b16 v[172:173], v248 offset:48352
    ds_read_b64_tr_b16 v[174:175], v248 offset:49120
    s_waitcnt lgkmcnt(7)
    v_mfma_f32_32x32x16_bf16 v[32:47], v[144:147], v[160:163], v[32:47]
    s_barrier
    ds_read_b128 v[144:147], v234 offset:16384
    ds_read_b64_tr_b16 v[152:153], v248 offset:51296
    ds_read_b64_tr_b16 v[154:155], v248 offset:52064
    s_waitcnt lgkmcnt(7)
    v_mfma_f32_32x32x16_bf16 v[0:15], v[164:167], v[148:151], v[0:15]
    ds_read_b64_tr_b16 v[156:157], v248 offset:51360
    ds_read_b64_tr_b16 v[158:159], v248 offset:52128
    s_waitcnt lgkmcnt(7)
    v_mfma_f32_32x32x16_bf16 v[16:31], v[168:171], v[148:151], v[16:31]
    ds_read_b64_tr_b16 v[160:161], v248 offset:51424
    ds_read_b64_tr_b16 v[162:163], v248 offset:52192
    s_waitcnt lgkmcnt(7)
    v_mfma_f32_32x32x16_bf16 v[32:47], v[148:151], v[172:175], v[32:47]
    ds_read_b128 v[148:151], v235 offset:16384
    ds_read_b64_tr_b16 v[164:165], v248 offset:54400
    ds_read_b64_tr_b16 v[166:167], v248 offset:55168
    s_waitcnt lgkmcnt(7)
    v_mfma_f32_32x32x16_bf16 v[0:15], v[152:155], v[144:147], v[0:15]
    ds_read_b64_tr_b16 v[168:169], v248 offset:54464
    ds_read_b64_tr_b16 v[170:171], v248 offset:55232
    s_waitcnt lgkmcnt(7)
    v_mfma_f32_32x32x16_bf16 v[16:31], v[156:159], v[144:147], v[16:31]
    ds_read_b64_tr_b16 v[172:173], v248 offset:54528
    ds_read_b64_tr_b16 v[174:175], v248 offset:55296
    s_waitcnt lgkmcnt(7)
    v_mfma_f32_32x32x16_bf16 v[32:47], v[144:147], v[160:163], v[32:47]
    s_barrier
    ds_read_b128 v[144:147], v232 offset:32768
    ds_read_b64_tr_b16 v[152:153], v248 offset:57472
    ds_read_b64_tr_b16 v[154:155], v248 offset:58240
    s_waitcnt lgkmcnt(7)
    v_mfma_f32_32x32x16_bf16 v[0:15], v[164:167], v[148:151], v[0:15]
    ds_read_b64_tr_b16 v[156:157], v248 offset:57536
    ds_read_b64_tr_b16 v[158:159], v248 offset:58304
    s_waitcnt lgkmcnt(7)
    v_mfma_f32_32x32x16_bf16 v[16:31], v[168:171], v[148:151], v[16:31]
    ds_read_b64_tr_b16 v[160:161], v248 offset:57600
    ds_read_b64_tr_b16 v[162:163], v248 offset:58368
    s_waitcnt lgkmcnt(7)
    v_mfma_f32_32x32x16_bf16 v[32:47], v[148:151], v[172:175], v[32:47]
    ds_read_b128 v[148:151], v233 offset:32768
    ds_read_b64_tr_b16 v[164:165], v248 offset:60576
    ds_read_b64_tr_b16 v[166:167], v248 offset:61344
    s_waitcnt lgkmcnt(7)
    v_mfma_f32_32x32x16_bf16 v[0:15], v[152:155], v[144:147], v[0:15]
    ds_read_b64_tr_b16 v[168:169], v248 offset:60640
    ds_read_b64_tr_b16 v[170:171], v248 offset:61408
    s_waitcnt lgkmcnt(7)
    v_mfma_f32_32x32x16_bf16 v[16:31], v[156:159], v[144:147], v[16:31]
    s_cmp_lg_u32 s24, 0
    s_cbranch_scc1 C_NOL_nns
    buffer_load_dwordx2 v[240:241], v251, s[16:19], 0 offen
C_NOL_nns:
    ds_read_b64_tr_b16 v[172:173], v248 offset:60704
    ds_read_b64_tr_b16 v[174:175], v248 offset:61472
    s_waitcnt lgkmcnt(7)
    v_mfma_f32_32x32x16_bf16 v[32:47], v[144:147], v[160:163], v[32:47]
    s_barrier
    ds_read_b128 v[144:147], v234 offset:32768
    ds_read_b64_tr_b16 v[152:153], v248 offset:0
    ds_read_b64_tr_b16 v[154:155], v248 offset:768
    s_waitcnt lgkmcnt(7)
    v_mfma_f32_32x32x16_bf16 v[0:15], v[164:167], v[148:151], v[0:15]
    ds_read_b64_tr_b16 v[156:157], v248 offset:64
    ds_read_b64_tr_b16 v[158:159], v248 offset:832
    s_waitcnt lgkmcnt(7)
    v_mfma_f32_32x32x16_bf16 v[16:31], v[168:171], v[148:151], v[16:31]
    ds_read_b64_tr_b16 v[160:161], v248 offset:128
    ds_read_b64_tr_b16 v[162:163], v248 offset:896
    s_waitcnt lgkmcnt(7)
    v_mfma_f32_32x32x16_bf16 v[32:47], v[148:151], v[172:175], v[32:47]
    ds_read_b128 v[148:151], v235 offset:32768
    ds_read_b64_tr_b16 v[164:165], v248 offset:3104
    ds_read_b64_tr_b16 v[166:167], v248 offset:3872
    s_waitcnt lgkmcnt(7)
    v_mfma_f32_32x32x16_bf16 v[0:15], v[152:155], v[144:147], v[0:15]
    ds_read_b64_tr_b16 v[168:169], v248 offset:3168
    ds_read_b64_tr_b16 v[170:171], v248 offset:3936
    s_waitcnt lgkmcnt(7)
    v_mfma_f32_32x32x16_bf16 v[16:31], v[156:159], v[144:147], v[16:31]
    ds_read_b64_tr_b16 v[172:173], v248 offset:3232
    ds_read_b64_tr_b16 v[174:175], v248 offset:4000
    s_waitcnt lgkmcnt(7)
    v_mfma_f32_32x32x16_bf16 v[32:47], v[144:147], v[160:163], v[32:47]
    s_barrier
    ds_read_b128 v[144:147], v232 offset:49152
    ds_read_b64_tr_b16 v[152:153], v248 offset:6176
    ds_read_b64_tr_b16 v[154:155], v248 offset:6944
    s_waitcnt lgkmcnt(7)
    v_mfma_f32_32x32x16_bf16 v[0:15], v[164:167], v[148:151], v[0:15]
    ds_read_b64_tr_b16 v[156:157], v248 offset:6240
    ds_read_b64_tr_b16 v[158:159], v248 offset:7008
    s_waitcnt lgkmcnt(7)
    v_mfma_f32_32x32x16_bf16 v[16:31], v[168:171], v[148:151], v[16:31]
    ds_read_b64_tr_b16 v[160:161], v248 offset:6304
    ds_read_b64_tr_b16 v[162:163], v248 offset:7072
    s_waitcnt lgkmcnt(7)
    v_mfma_f32_32x32x16_bf16 v[32:47], v[148:151], v[172:175], v[32:47]
    ds_read_b128 v[148:151], v233 offset:49152
    ds_read_b64_tr_b16 v[164:165], v248 offset:9280
    ds_read_b64_tr_b16 v[166:167], v248 offset:10048
    s_waitcnt lgkmcnt(7)
    v_mfma_f32_32x32x16_bf16 v[0:15], v[152:155], v[144:147], v[0:15]
    ds_read_b64_tr_b16 v[168:169], v248 offset:9344
    ds_read_b64_tr_b16 v[170:171], v248 offset:10112
    s_waitcnt lgkmcnt(7)
    v_mfma_f32_32x32x16_bf16 v[16:31], v[156:159], v[144:147], v[16:31]
    ds_read_b64_tr_b16 v[172:173], v248 offset:9408
    ds_read_b64_tr_b16 v[174:175], v248 offset:10176
    s_waitcnt lgkmcnt(7)
    v_mfma_f32_32x32x16_bf16 v[32:47], v[144:147], v[160:163], v[32:47]
    s_barrier
    ds_read_b128 v[144:147], v234 offset:49152
    ds_read_b64_tr_b16 v[152:153], v248 offset:16384
    ds_read_b64_tr_b16 v[154:155], v248 offset:17152
    s_waitcnt lgkmcnt(7)
    v_mfma_f32_32x32x16_bf16 v[0:15], v[164:167], v[148:151], v[0:15]
    ds_read_b64_tr_b16 v[156:157], v248 offset:16448
    ds_read_b64_tr_b16 v[158:159], v248 offset:17216
    s_waitcnt lgkmcnt(7)
    v_mfma_f32_32x32x16_bf16 v[16:31], v[168:171], v[148:151], v[16:31]
    ds_read_b64_tr_b16 v[160:161], v248 offset:16512
    ds_read_b64_tr_b16 v[162:163], v248 offset:17280
    s_waitcnt lgkmcnt(7)
    v_mfma_f32_32x32x16_bf16 v[32:47], v[148:151], v[172:175], v[32:47]
    ds_read_b128 v[148:151], v235 offset:49152
    ds_read_b64_tr_b16 v[164:165], v248 offset:19488
    ds_read_b64_tr_b16 v[166:167], v248 offset:20256
    s_waitcnt lgkmcnt(7)
    v_mfma_f32_32x32x16_bf16 v[0:15], v[152:155], v[144:147], v[0:15]
    ds_read_b64_tr_b16 v[168:169], v248 offset:19552
    ds_read_b64_tr_b16 v[170:171], v248 offset:20320
    s_waitcnt lgkmcnt(7)
    v_mfma_f32_32x32x16_bf16 v[16:31], v[156:159], v[144:147], v[16:31]
    ds_read_b64_tr_b16 v[172:173], v248 offset:19616
    ds_read_b64_tr_b16 v[174:175], v248 offset:20384
    s_waitcnt lgkmcnt(7)
    v_mfma_f32_32x32x16_bf16 v[32:47], v[144:147], v[160:163], v[32:47]
    s_barrier
    ds_read_b64_tr_b16 v[192:193], v252 offset:22560
    ds_read_b64_tr_b16 v[194:195], v252 offset:23328
    ds_read_b128 v[176:179], v224 offset:0
    s_waitcnt lgkmcnt(7)
    v_mfma_f32_32x32x16_bf16 v[0:15], v[164:167], v[148:151], v[0:15]
    ds_read_b128 v[180:183], v224 offset:4096
    ds_read_b64_tr_b16 v[196:197], v252 offset:22592
    ds_read_b64_tr_b16 v[198:199], v252 offset:23360
    s_waitcnt lgkmcnt(8)
    v_mfma_f32_32x32x16_bf16 v[16:31], v[168:171], v[148:151], v[16:31]
    ds_read_b64_tr_b16 v[200:201], v252 offset:22624
    ds_read_b64_tr_b16 v[202:203], v252 offset:23392
    s_waitcnt lgkmcnt(8)
    v_mfma_f32_32x32x16_bf16 v[32:47], v[148:151], v[172:175], v[32:47]
    s_waitcnt lgkmcnt(5)
    v_mfma_f32_32x32x16_bf16 v[48:63], v[192:195], v[176:179], 0
    s_waitcnt lgkmcnt(4)
    v_mfma_f32_32x32x16_bf16 v[64:79], v[192:195], v[180:183], 0
    s_waitcnt lgkmcnt(0)
    s_barrier
    ds_read_b64_tr_b16 v[204:205], v252 offset:32768
    ds_read_b64_tr_b16 v[206:207], v252 offset:33536
    ds_read_b128 v[184:187], v225 offset:0
    v_mfma_f32_32x32x16_bf16 v[80:95], v[196:199], v[176:179], 0
    ds_read_b128 v[188:191], v225 offset:4096
    ds_read_b64_tr_b16 v[208:209], v252 offset:32800
    ds_read_b64_tr_b16 v[210:211], v252 offset:33568
    v_mfma_f32_32x32x16_bf16 v[96:111], v[196:199], v[180:183], 0
    ds_read_b64_tr_b16 v[212:213], v252 offset:32832
    ds_read_b64_tr_b16 v[214:215], v252 offset:33600
    v_mfma_f32_32x32x16_bf16 v[112:127], v[200:203], v[176:179], 0
    v_mfma_f32_32x32x16_bf16 v[128:143], v[200:203], v[180:183], 0
    s_waitcnt lgkmcnt(5)
    v_mfma_f32_32x32x16_bf16 v[48:63], v[204:207], v[184:187], v[48:63]
    s_waitcnt lgkmcnt(4)
    v_mfma_f32_32x32x16_bf16 v[64:79], v[204:207], v[188:191], v[64:79]
    s_waitcnt lgkmcnt(0)
    s_barrier
    ds_read_b128 v[144:147], v236 offset:0
    ds_read_b64_tr_b16 v[152:153], v248 offset:38944
    ds_read_b64_tr_b16 v[154:155], v248 offset:39712
    v_mfma_f32_32x32x16_bf16 v[80:95], v[208:211], v[184:187], v[80:95]
    ds_read_b64_tr_b16 v[156:157], v248 offset:39008
    ds_read_b64_tr_b16 v[158:159], v248 offset:39776
    v_mfma_f32_32x32x16_bf16 v[96:111], v[208:211], v[188:191], v[96:111]
    ds_read_b64_tr_b16 v[160:161], v248 offset:39072
    ds_read_b64_tr_b16 v[162:163], v248 offset:39840
    v_mfma_f32_32x32x16_bf16 v[112:127], v[212:215], v[184:187], v[112:127]
    v_mfma_f32_32x32x16_bf16 v[128:143], v[212:215], v[188:191], v[128:143]
    ds_read_b128 v[148:151], v237 offset:0
    ds_read_b64_tr_b16 v[164:165], v248 offset:42048
    ds_read_b64_tr_b16 v[166:167], v248 offset:42816
    s_waitcnt lgkmcnt(7)
    v_mfma_f32_32x32x16_bf16 v[0:15], v[152:155], v[144:147], v[0:15]
    ds_read_b64_tr_b16 v[168:169], v248 offset:42112
    ds_read_b64_tr_b16 v[170:171], v248 offset:42880
    s_waitcnt lgkmcnt(7)
    v_mfma_f32_32x32x16_bf16 v[16:31], v[156:159], v[144:147], v[16:31]
    ds_read_b64_tr_b16 v[172:173], v248 offset:42176
    ds_read_b64_tr_b16 v[174:175], v248 offset:42944
    s_waitcnt lgkmcnt(7)
    v_mfma_f32_32x32x16_bf16 v[32:47], v[144:147], v[160:163], v[32:47]
    s_cmp_lg_u32 s24, 0
    s_cbranch_scc1 C_NON_nns
    s_mov_b64 exec, 1
    v_mov_b32 v242, 162976
C_NOR_nns:
    s_waitcnt vmcnt(0)
    v_cmp_ne_u32 vcc, 0, v240
    s_nop 1
    s_cbranch_vccnz C_NOK_nns
    buffer_load_dwordx2 v[240:241], v251, s[16:19], 0 offen sc0 sc1
    s_branch C_NOR_nns
C_NOK_nns:
    ds_write_b64 v242, v[240:241]
    s_mov_b64 exec, -1
C_NON_nns:
    s_waitcnt vmcnt(0)
    s_barrier
    ds_read_b128 v[144:147], v238 offset:0
    ds_read_b64_tr_b16 v[152:153], v248 offset:45120
    ds_read_b64_tr_b16 v[154:155], v248 offset:45888
    s_waitcnt lgkmcnt(7)
    v_mfma_f32_32x32x16_bf16 v[0:15], v[164:167], v[148:151], v[0:15]
    ds_read_b64_tr_b16 v[156:157], v248 offset:45184
    ds_read_b64_tr_b16 v[158:159], v248 offset:45952
    s_waitcnt lgkmcnt(7)
    v_mfma_f32_32x32x16_bf16 v[16:31], v[168:171], v[148:151], v[16:31]
    ds_read_b64_tr_b16 v[160:161], v248 offset:45248
    ds_read_b64_tr_b16 v[162:163], v248 offset:46016
    s_waitcnt lgkmcnt(7)
    v_mfma_f32_32x32x16_bf16 v[32:47], v[148:151], v[172:175], v[32:47]
    ds_read_b128 v[148:151], v239 offset:0
    ds_read_b64_tr_b16 v[164:165], v248 offset:48224
    ds_read_b64_tr_b16 v[166:167], v248 offset:48992
    s_waitcnt lgkmcnt(7)
    v_mfma_f32_32x32x16_bf16 v[0:15], v[152:155], v[144:147], v[0:15]
    ds_read_b64_tr_b16 v[168:169], v248 offset:48288
    ds_read_b64_tr_b16 v[170:171], v248 offset:49056
    s_waitcnt lgkmcnt(7)
    v_mfma_f32_32x32x16_bf16 v[16:31], v[156:159], v[144:147], v[16:31]
    ds_read_b64_tr_b16 v[172:173], v248 offset:48352
    ds_read_b64_tr_b16 v[174:175], v248 offset:49120
    s_waitcnt lgkmcnt(7)
    v_mfma_f32_32x32x16_bf16 v[32:47], v[144:147], v[160:163], v[32:47]
    s_barrier
    ds_read_b64_tr_b16 v[192:193], v252 offset:51296
    ds_read_b64_tr_b16 v[194:195], v252 offset:52064
    ds_read_b128 v[176:179], v226 offset:0
    s_waitcnt lgkmcnt(7)
    v_mfma_f32_32x32x16_bf16 v[0:15], v[164:167], v[148:151], v[0:15]
    ds_read_b128 v[180:183], v226 offset:4096
    ds_read_b64_tr_b16 v[196:197], v252 offset:51328
    ds_read_b64_tr_b16 v[198:199], v252 offset:52096
    s_waitcnt lgkmcnt(8)
    v_mfma_f32_32x32x16_bf16 v[16:31], v[168:171], v[148:151], v[16:31]
    ds_read_b64_tr_b16 v[200:201], v252 offset:51360
    ds_read_b64_tr_b16 v[202:203], v252 offset:52128
    s_waitcnt lgkmcnt(8)
    v_mfma_f32_32x32x16_bf16 v[32:47], v[148:151], v[172:175], v[32:47]
    s_waitcnt lgkmcnt(5)
    v_mfma_f32_32x32x16_bf16 v[48:63], v[192:195], v[176:179], v[48:63]
    s_waitcnt lgkmcnt(4)
    v_mfma_f32_32x32x16_bf16 v[64:79], v[192:195], v[180:183], v[64:79]
    s_waitcnt lgkmcnt(0)
    s_barrier
    ds_read_b64_tr_b16 v[204:205], v252 offset:57472
    ds_read_b64_tr_b16 v[206:207], v252 offset:58240
    ds_read_b128 v[184:187], v227 offset:0
    v_mfma_f32_32x32x16_bf16 v[80:95], v[196:199], v[176:179], v[80:95]
    ds_read_b128 v[188:191], v227 offset:4096
    ds_read_b64_tr_b16 v[208:209], v252 offset:57504
    ds_read_b64_tr_b16 v[210:211], v252 offset:58272
    v_mfma_f32_32x32x16_bf16 v[96:111], v[196:199], v[180:183], v[96:111]
    ds_read_b64_tr_b16 v[212:213], v252 offset:57536
    ds_read_b64_tr_b16 v[214:215], v252 offset:58304
    v_mfma_f32_32x32x16_bf16 v[112:127], v[200:203], v[176:179], v[112:127]
    v_mfma_f32_32x32x16_bf16 v[128:143], v[200:203], v[180:183], v[128:143]
    s_waitcnt lgkmcnt(5)
    v_mfma_f32_32x32x16_bf16 v[48:63], v[204:207], v[184:187], v[48:63]
    s_waitcnt lgkmcnt(4)
    v_mfma_f32_32x32x16_bf16 v[64:79], v[204:207], v[188:191], v[64:79]
    s_waitcnt lgkmcnt(0)
    s_barrier
    ds_read_b128 v[144:147], v236 offset:16384
    ds_read_b64_tr_b16 v[152:153], v248 offset:16384
    ds_read_b64_tr_b16 v[154:155], v248 offset:17152
    v_mfma_f32_32x32x16_bf16 v[80:95], v[208:211], v[184:187], v[80:95]
    ds_read_b64_tr_b16 v[156:157], v248 offset:16448
    ds_read_b64_tr_b16 v[158:159], v248 offset:17216
    v_mfma_f32_32x32x16_bf16 v[96:111], v[208:211], v[188:191], v[96:111]
    ds_read_b64_tr_b16 v[160:161], v248 offset:16512
    ds_read_b64_tr_b16 v[162:163], v248 offset:17280
    v_mfma_f32_32x32x16_bf16 v[112:127], v[212:215], v[184:187], v[112:127]
    v_mfma_f32_32x32x16_bf16 v[128:143], v[212:215], v[188:191], v[128:143]
    ds_read_b128 v[148:151], v237 offset:16384
    ds_read_b64_tr_b16 v[164:165], v248 offset:19488
    ds_read_b64_tr_b16 v[166:167], v248 offset:20256
    s_waitcnt lgkmcnt(7)
    v_mfma_f32_32x32x16_bf16 v[0:15], v[152:155], v[144:147], v[0:15]
    ds_read_b64_tr_b16 v[168:169], v248 offset:19552
    ds_read_b64_tr_b16 v[170:171], v248 offset:20320
    s_waitcnt lgkmcnt(7)
    v_mfma_f32_32x32x16_bf16 v[16:31], v[156:159], v[144:147], v[16:31]
    ds_read_b64_tr_b16 v[172:173], v248 offset:19616
    ds_read_b64_tr_b16 v[174:175], v248 offset:20384
    s_waitcnt lgkmcnt(7)
    v_mfma_f32_32x32x16_bf16 v[32:47], v[144:147], v[160:163], v[32:47]
    s_barrier
    ds_read_b128 v[144:147], v238 offset:16384
    ds_read_b64_tr_b16 v[152:153], v248 offset:22560
    ds_read_b64_tr_b16 v[154:155], v248 offset:23328
    s_waitcnt lgkmcnt(7)
    v_mfma_f32_32x32x16_bf16 v[0:15], v[164:167], v[148:151], v[0:15]
    ds_read_b64_tr_b16 v[156:157], v248 offset:22624
    ds_read_b64_tr_b16 v[158:159], v248 offset:23392
    s_waitcnt lgkmcnt(7)
    v_mfma_f32_32x32x16_bf16 v[16:31], v[168:171], v[148:151], v[16:31]
    ds_read_b64_tr_b16 v[160:161], v248 offset:22688
    ds_read_b64_tr_b16 v[162:163], v248 offset:23456
    s_waitcnt lgkmcnt(7)
    v_mfma_f32_32x32x16_bf16 v[32:47], v[148:151], v[172:175], v[32:47]
    ds_read_b128 v[148:151], v239 offset:16384
    ds_read_b64_tr_b16 v[164:165], v248 offset:25664
    ds_read_b64_tr_b16 v[166:167], v248 offset:26432
    s_waitcnt lgkmcnt(7)
    v_mfma_f32_32x32x16_bf16 v[0:15], v[152:155], v[144:147], v[0:15]
    ds_read_b64_tr_b16 v[168:169], v248 offset:25728
    ds_read_b64_tr_b16 v[170:171], v248 offset:26496
    s_waitcnt lgkmcnt(7)
    v_mfma_f32_32x32x16_bf16 v[16:31], v[156:159], v[144:147], v[16:31]
    ds_read_b64_tr_b16 v[172:173], v248 offset:25792
    ds_read_b64_tr_b16 v[174:175], v248 offset:26560
    s_waitcnt lgkmcnt(7)
    v_mfma_f32_32x32x16_bf16 v[32:47], v[144:147], v[160:163], v[32:47]
    s_barrier
    ds_read_b64_tr_b16 v[192:193], v252 offset:32768
    ds_read_b64_tr_b16 v[194:195], v252 offset:33536
    ds_read_b128 v[176:179], v224 offset:16384
    s_waitcnt lgkmcnt(7)
    v_mfma_f32_32x32x16_bf16 v[0:15], v[164:167], v[148:151], v[0:15]
    ds_read_b128 v[180:183], v224 offset:20480
    ds_read_b64_tr_b16 v[196:197], v252 offset:32800
    ds_read_b64_tr_b16 v[198:199], v252 offset:33568
    s_waitcnt lgkmcnt(8)
    v_mfma_f32_32x32x16_bf16 v[16:31], v[168:171], v[148:151], v[16:31]
    ds_read_b64_tr_b16 v[200:201], v252 offset:32832
    ds_read_b64_tr_b16 v[202:203], v252 offset:33600
    s_waitcnt lgkmcnt(8)
    v_mfma_f32_32x32x16_bf16 v[32:47], v[148:151], v[172:175], v[32:47]
    s_waitcnt lgkmcnt(5)
    v_mfma_f32_32x32x16_bf16 v[48:63], v[192:195], v[176:179], v[48:63]
    s_waitcnt lgkmcnt(4)
    v_mfma_f32_32x32x16_bf16 v[64:79], v[192:195], v[180:183], v[64:79]
    s_waitcnt lgkmcnt(0)
    s_barrier
    ds_read_b64_tr_b16 v[204:205], v252 offset:38944
    ds_read_b64_tr_b16 v[206:207], v252 offset:39712
    ds_read_b128 v[184:187], v225 offset:16384
    v_mfma_f32_32x32x16_bf16 v[80:95], v[196:199], v[176:179], v[80:95]
    ds_read_b128 v[188:191], v225 offset:20480
    ds_read_b64_tr_b16 v[208:209], v252 offset:38976
    ds_read_b64_tr_b16 v[210:211], v252 offset:39744
    v_mfma_f32_32x32x16_bf16 v[96:111], v[196:199], v[180:183], v[96:111]
    ds_read_b64_tr_b16 v[212:213], v252 offset:39008
    ds_read_b64_tr_b16 v[214:215], v252 offset:39776
    v_mfma_f32_32x32x16_bf16 v[112:127], v[200:203], v[176:179], v[112:127]
    v_mfma_f32_32x32x16_bf16 v[128:143], v[200:203], v[180:183], v[128:143]
    s_waitcnt lgkmcnt(5)
    v_mfma_f32_32x32x16_bf16 v[48:63], v[204:207], v[184:187], v[48:63]
    s_waitcnt lgkmcnt(4)
    v_mfma_f32_32x32x16_bf16 v[64:79], v[204:207], v[188:191], v[64:79]
    s_waitcnt lgkmcnt(0)
    s_barrier
    ds_read_b128 v[144:147], v236 offset:32768
    ds_read_b64_tr_b16 v[152:153], v248 offset:45120
    ds_read_b64_tr_b16 v[154:155], v248 offset:45888
    v_mfma_f32_32x32x16_bf16 v[80:95], v[208:211], v[184:187], v[80:95]
    ds_read_b64_tr_b16 v[156:157], v248 offset:45184
    ds_read_b64_tr_b16 v[158:159], v248 offset:45952
    v_mfma_f32_32x32x16_bf16 v[96:111], v[208:211], v[188:191], v[96:111]
    ds_read_b64_tr_b16 v[160:161], v248 offset:45248
    ds_read_b64_tr_b16 v[162:163], v248 offset:46016
    v_mfma_f32_32x32x16_bf16 v[112:127], v[212:215], v[184:187], v[112:127]
    v_mfma_f32_32x32x16_bf16 v[128:143], v[212:215], v[188:191], v[128:143]
    ds_read_b128 v[148:151], v237 offset:32768
    ds_read_b64_tr_b16 v[164:165], v248 offset:48224
    ds_read_b64_tr_b16 v[166:167], v248 offset:48992
    s_waitcnt lgkmcnt(7)
    v_mfma_f32_32x32x16_bf16 v[0:15], v[152:155], v[144:147], v[0:15]
    ds_read_b64_tr_b16 v[168:169], v248 offset:48288
    ds_read_b64_tr_b16 v[170:171], v248 offset:49056
    s_waitcnt lgkmcnt(7)
    v_mfma_f32_32x32x16_bf16 v[16:31], v[156:159], v[144:147], v[16:31]
    ds_read_b64_tr_b16 v[172:173], v248 offset:48352
    ds_read_b64_tr_b16 v[174:175], v248 offset:49120
    s_waitcnt lgkmcnt(7)
    v_mfma_f32_32x32x16_bf16 v[32:47], v[144:147], v[160:163], v[32:47]
    s_barrier
    ds_read_b128 v[144:147], v238 offset:32768
    ds_read_b64_tr_b16 v[152:153], v248 offset:51296
    ds_read_b64_tr_b16 v[154:155], v248 offset:52064
    s_waitcnt lgkmcnt(7)
    v_mfma_f32_32x32x16_bf16 v[0:15], v[164:167], v[148:151], v[0:15]
    ds_read_b64_tr_b16 v[156:157], v248 offset:51360
    ds_read_b64_tr_b16 v[158:159], v248 offset:52128
    s_waitcnt lgkmcnt(7)
    v_mfma_f32_32x32x16_bf16 v[16:31], v[168:171], v[148:151], v[16:31]
    ds_read_b64_tr_b16 v[160:161], v248 offset:51424
    ds_read_b64_tr_b16 v[162:163], v248 offset:52192
    s_waitcnt lgkmcnt(7)
    v_mfma_f32_32x32x16_bf16 v[32:47], v[148:151], v[172:175], v[32:47]
    ds_read_b128 v[148:151], v239 offset:32768
    ds_read_b64_tr_b16 v[164:165], v248 offset:54400
    ds_read_b64_tr_b16 v[166:167], v248 offset:55168
    s_waitcnt lgkmcnt(7)
    v_mfma_f32_32x32x16_bf16 v[0:15], v[152:155], v[144:147], v[0:15]
    ds_read_b64_tr_b16 v[168:169], v248 offset:54464
    ds_read_b64_tr_b16 v[170:171], v248 offset:55232
    s_waitcnt lgkmcnt(7)
    v_mfma_f32_32x32x16_bf16 v[16:31], v[156:159], v[144:147], v[16:31]
    ds_read_b64_tr_b16 v[172:173], v248 offset:54528
    ds_read_b64_tr_b16 v[174:175], v248 offset:55296
    s_waitcnt lgkmcnt(7)
    v_mfma_f32_32x32x16_bf16 v[32:47], v[144:147], v[160:163], v[32:47]
    s_barrier
    ds_read_b64_tr_b16 v[192:193], v252 offset:57472
    ds_read_b64_tr_b16 v[194:195], v252 offset:58240
    ds_read_b128 v[176:179], v226 offset:16384
    s_waitcnt lgkmcnt(7)
    v_mfma_f32_32x32x16_bf16 v[0:15], v[164:167], v[148:151], v[0:15]
    ds_read_b128 v[180:183], v226 offset:20480
    ds_read_b64_tr_b16 v[196:197], v252 offset:57504
    ds_read_b64_tr_b16 v[198:199], v252 offset:58272
    s_waitcnt lgkmcnt(8)
    v_mfma_f32_32x32x16_bf16 v[16:31], v[168:171], v[148:151], v[16:31]
    ds_read_b64_tr_b16 v[200:201], v252 offset:57536
    ds_read_b64_tr_b16 v[202:203], v252 offset:58304
    s_waitcnt lgkmcnt(8)
    v_mfma_f32_32x32x16_bf16 v[32:47], v[148:151], v[172:175], v[32:47]
    s_waitcnt lgkmcnt(5)
    v_mfma_f32_32x32x16_bf16 v[48:63], v[192:195], v[176:179], v[48:63]
    s_waitcnt lgkmcnt(4)
    v_mfma_f32_32x32x16_bf16 v[64:79], v[192:195], v[180:183], v[64:79]
    s_waitcnt lgkmcnt(0)
    s_barrier
    ds_read_b64_tr_b16 v[204:205], v217 offset:0
    ds_read_b64_tr_b16 v[206:207], v217 offset:768
    ds_read_b128 v[184:187], v227 offset:16384
    v_mfma_f32_32x32x16_bf16 v[80:95], v[196:199], v[176:179], v[80:95]
    ds_read_b128 v[188:191], v227 offset:20480
    ds_read_b64_tr_b16 v[208:209], v217 offset:32
    ds_read_b64_tr_b16 v[210:211], v217 offset:800
    v_mfma_f32_32x32x16_bf16 v[96:111], v[196:199], v[180:183], v[96:111]
    ds_read_b64_tr_b16 v[212:213], v217 offset:64
    ds_read_b64_tr_b16 v[214:215], v217 offset:832
    v_mfma_f32_32x32x16_bf16 v[112:127], v[200:203], v[176:179], v[112:127]
    v_mfma_f32_32x32x16_bf16 v[128:143], v[200:203], v[180:183], v[128:143]
    s_waitcnt lgkmcnt(5)
    v_mfma_f32_32x32x16_bf16 v[48:63], v[204:207], v[184:187], v[48:63]
    s_waitcnt lgkmcnt(4)
    v_mfma_f32_32x32x16_bf16 v[64:79], v[204:207], v[188:191], v[64:79]
    s_waitcnt lgkmcnt(0)
    s_barrier
    ds_read_b128 v[144:147], v236 offset:49152
    ds_read_b64_tr_b16 v[152:153], v216 offset:6176
    ds_read_b64_tr_b16 v[154:155], v216 offset:6944
    v_mfma_f32_32x32x16_bf16 v[80:95], v[208:211], v[184:187], v[80:95]
    ds_read_b64_tr_b16 v[156:157], v216 offset:6240
    ds_read_b64_tr_b16 v[158:159], v216 offset:7008
    v_mfma_f32_32x32x16_bf16 v[96:111], v[208:211], v[188:191], v[96:111]
    ds_read_b64_tr_b16 v[160:161], v216 offset:6304
    ds_read_b64_tr_b16 v[162:163], v216 offset:7072
    v_mfma_f32_32x32x16_bf16 v[112:127], v[212:215], v[184:187], v[112:127]
    v_mfma_f32_32x32x16_bf16 v[128:143], v[212:215], v[188:191], v[128:143]
    ds_read_b128 v[148:151], v237 offset:49152
    ds_read_b64_tr_b16 v[164:165], v216 offset:9280
    ds_read_b64_tr_b16 v[166:167], v216 offset:10048
    s_waitcnt lgkmcnt(7)
    v_mfma_f32_32x32x16_bf16 v[0:15], v[152:155], v[144:147], v[0:15]
    ds_read_b64_tr_b16 v[168:169], v216 offset:9344
    ds_read_b64_tr_b16 v[170:171], v216 offset:10112
    s_waitcnt lgkmcnt(7)
    v_mfma_f32_32x32x16_bf16 v[16:31], v[156:159], v[144:147], v[16:31]
    ds_read_b64_tr_b16 v[172:173], v216 offset:9408
    ds_read_b64_tr_b16 v[174:175], v216 offset:10176
    s_waitcnt lgkmcnt(7)
    v_mfma_f32_32x32x16_bf16 v[32:47], v[144:147], v[160:163], v[32:47]
    s_barrier
    ds_read_b128 v[144:147], v238 offset:49152
    ds_read_b64_tr_b16 v[152:153], v248 offset:32768
    ds_read_b64_tr_b16 v[154:155], v248 offset:33536
    s_waitcnt lgkmcnt(7)
    v_mfma_f32_32x32x16_bf16 v[0:15], v[164:167], v[148:151], v[0:15]
    ds_read_b64_tr_b16 v[156:157], v248 offset:32832
    ds_read_b64_tr_b16 v[158:159], v248 offset:33600
    s_waitcnt lgkmcnt(7)
    v_mfma_f32_32x32x16_bf16 v[16:31], v[168:171], v[148:151], v[16:31]
    ds_read_b64_tr_b16 v[160:161], v248 offset:32896
    ds_read_b64_tr_b16 v[162:163], v248 offset:33664
    s_waitcnt lgkmcnt(7)
    v_mfma_f32_32x32x16_bf16 v[32:47], v[148:151], v[172:175], v[32:47]
    ds_read_b128 v[148:151], v239 offset:49152
    ds_read_b64_tr_b16 v[164:165], v248 offset:35872
    ds_read_b64_tr_b16 v[166:167], v248 offset:36640
    s_waitcnt lgkmcnt(7)
    v_mfma_f32_32x32x16_bf16 v[0:15], v[152:155], v[144:147], v[0:15]
    ds_read_b64_tr_b16 v[168:169], v248 offset:35936
    ds_read_b64_tr_b16 v[170:171], v248 offset:36704
    s_waitcnt lgkmcnt(7)
    v_mfma_f32_32x32x16_bf16 v[16:31], v[156:159], v[144:147], v[16:31]
    ds_read_b64_tr_b16 v[172:173], v248 offset:36000
    ds_read_b64_tr_b16 v[174:175], v248 offset:36768
    s_waitcnt lgkmcnt(7)
    v_mfma_f32_32x32x16_bf16 v[32:47], v[144:147], v[160:163], v[32:47]
    s_barrier
    ds_read_b64_tr_b16 v[192:193], v252 offset:38944
    ds_read_b64_tr_b16 v[194:195], v252 offset:39712
    ds_read_b128 v[176:179], v224 offset:32768
    s_waitcnt lgkmcnt(7)
    v_mfma_f32_32x32x16_bf16 v[0:15], v[164:167], v[148:151], v[0:15]
    ds_read_b128 v[180:183], v224 offset:36864
    ds_read_b64_tr_b16 v[196:197], v252 offset:38976
    ds_read_b64_tr_b16 v[198:199], v252 offset:39744
    s_waitcnt lgkmcnt(8)
    v_mfma_f32_32x32x16_bf16 v[16:31], v[168:171], v[148:151], v[16:31]
    ds_read_b64_tr_b16 v[200:201], v252 offset:39008
    ds_read_b64_tr_b16 v[202:203], v252 offset:39776
    s_waitcnt lgkmcnt(8)
    v_mfma_f32_32x32x16_bf16 v[32:47], v[148:151], v[172:175], v[32:47]
    s_branch C_P2
C_SSS:
    s_barrier
    ds_read_b128 v[144:147], v232 offset:0
    ds_read_b64_tr_b16 v[152:153], v248 offset:32768
    ds_read_b64_tr_b16 v[154:155], v248 offset:33536
    ds_read_b64_tr_b16 v[156:157], v248 offset:32832
    ds_read_b64_tr_b16 v[158:159], v248 offset:33600
    ds_read_b64_tr_b16 v[160:161], v248 offset:32896
    ds_read_b64_tr_b16 v[162:163], v248 offset:33664
    ds_read_b128 v[148:151], v233 offset:0
    ds_read_b64_tr_b16 v[164:165], v248 offset:35872
    ds_read_b64_tr_b16 v[166:167], v248 offset:36640
    s_waitcnt lgkmcnt(7)
    v_mfma_f32_32x32x16_bf16 v[0:15], v[144:147], v[152:155], 0
    ds_read_b64_tr_b16 v[168:169], v248 offset:35936
    ds_read_b64_tr_b16 v[170:171], v248 offset:36704
    s_waitcnt lgkmcnt(7)
    v_mfma_f32_32x32x16_bf16 v[16:31], v[144:147], v[156:159], 0
    ds_read_b64_tr_b16 v[172:173], v248 offset:36000
    ds_read_b64_tr_b16 v[174:175], v248 offset:36768
    s_waitcnt lgkmcnt(7)
    v_mfma_f32_32x32x16_bf16 v[32:47], v[144:147], v[160:163], 0
    s_barrier
    ds_read_b128 v[144:147], v234 offset:0
    ds_read_b64_tr_b16 v[152:153], v248 offset:38944
    ds_read_b64_tr_b16 v[154:155], v248 offset:39712
    s_waitcnt lgkmcnt(7)
    v_mfma_f32_32x32x16_bf16 v[0:15], v[148:151], v[164:167], v[0:15]
    ds_read_b64_tr_b16 v[156:157], v248 offset:39008
    ds_read_b64_tr_b16 v[158:159], v248 offset:39776
    s_waitcnt lgkmcnt(7)
    v_mfma_f32_32x32x16_bf16 v[16:31], v[148:151], v[168:171], v[16:31]
    ds_read_b64_tr_b16 v[160:161], v248 offset:39072
    ds_read_b64_tr_b16 v[162:163], v248 offset:39840
    s_waitcnt lgkmcnt(7)
    v_mfma_f32_32x32x16_bf16 v[32:47], v[148:151], v[172:175], v[32:47]
    ds_read_b128 v[148:151], v235 offset:0
    ds_read_b64_tr_b16 v[164:165], v248 offset:42048
    ds_read_b64_tr_b16 v[166:167], v248 offset:42816
    s_waitcnt lgkmcnt(7)
    v_mfma_f32_32x32x16_bf16 v[0:15], v[144:147], v[152:155], v[0:15]
    ds_read_b64_tr_b16 v[168:169], v248 offset:42112
    ds_read_b64_tr_b16 v[170:171], v248 offset:42880
    s_waitcnt lgkmcnt(7)
    v_mfma_f32_32x32x16_bf16 v[16:31], v[144:147], v[156:159], v[16:31]
    ds_read_b64_tr_b16 v[172:173], v248 offset:42176
    ds_read_b64_tr_b16 v[174:175], v248 offset:42944
    s_waitcnt lgkmcnt(7)
    v_mfma_f32_32x32x16_bf16 v[32:47], v[144:147], v[160:163], v[32:47]
    s_barrier
    ds_read_b128 v[144:147], v232 offset:16384
    ds_read_b64_tr_b16 v[152:153], v248 offset:45120
    ds_read_b64_tr_b16 v[154:155], v248 offset:45888
    s_waitcnt lgkmcnt(7)
    v_mfma_f32_32x32x16_bf16 v[0:15], v[148:151], v[164:167], v[0:15]
    ds_read_b64_tr_b16 v[156:157], v248 offset:45184
    ds_read_b64_tr_b16 v[158:159], v248 offset:45952
    s_waitcnt lgkmcnt(7)
    v_mfma_f32_32x32x16_bf16 v[16:31], v[148:151], v[168:171], v[16:31]
    ds_read_b64_tr_b16 v[160:161], v248 offset:45248
    ds_read_b64_tr_b16 v[162:163], v248 offset:46016
    s_waitcnt lgkmcnt(7)
    v_mfma_f32_32x32x16_bf16 v[32:47], v[148:151], v[172:175], v[32:47]
    ds_read_b128 v[148:151], v233 offset:16384
    ds_read_b64_tr_b16 v[164:165], v248 offset:48224
    ds_read_b64_tr_b16 v[166:167], v248 offset:48992
    s_waitcnt lgkmcnt(7)
    v_mfma_f32_32x32x16_bf16 v[0:15], v[144:147], v[152:155], v[0:15]
    ds_read_b64_tr_b16 v[168:169], v248 offset:48288
    ds_read_b64_tr_b16 v[170:171], v248 offset:49056
    s_waitcnt lgkmcnt(7)
    v_mfma_f32_32x32x16_bf16 v[16:31], v[144:147], v[156:159], v[16:31]
    ds_read_b64_tr_b16 v[172:173], v248 offset:48352
    ds_read_b64_tr_b16 v[174:175], v248 offset:49120
    s_waitcnt lgkmcnt(7)
    v_mfma_f32_32x32x16_bf16 v[32:47], v[144:147], v[160:163], v[32:47]
    s_barrier
    ds_read_b128 v[144:147], v234 offset:16384
    ds_read_b64_tr_b16 v[152:153], v248 offset:51296
    ds_read_b64_tr_b16 v[154:155], v248 offset:52064
    s_waitcnt lgkmcnt(7)
    v_mfma_f32_32x32x16_bf16 v[0:15], v[148:151], v[164:167], v[0:15]
    ds_read_b64_tr_b16 v[156:157], v248 offset:51360
    ds_read_b64_tr_b16 v[158:159], v248 offset:52128
    s_waitcnt lgkmcnt(7)
    v_mfma_f32_32x32x16_bf16 v[16:31], v[148:151], v[168:171], v[16:31]
    ds_read_b64_tr_b16 v[160:161], v248 offset:51424
    ds_read_b64_tr_b16 v[162:163], v248 offset:52192
    s_waitcnt lgkmcnt(7)
    v_mfma_f32_32x32x16_bf16 v[32:47], v[148:151], v[172:175], v[32:47]
    ds_read_b128 v[148:151], v235 offset:16384
    ds_read_b64_tr_b16 v[164:165], v248 offset:54400
    ds_read_b64_tr_b16 v[166:167], v248 offset:55168
    s_waitcnt lgkmcnt(7)
    v_mfma_f32_32x32x16_bf16 v[0:15], v[144:147], v[152:155], v[0:15]
    ds_read_b64_tr_b16 v[168:169], v248 offset:54464
    ds_read_b64_tr_b16 v[170:171], v248 offset:55232
    s_waitcnt lgkmcnt(7)
    v_mfma_f32_32x32x16_bf16 v[16:31], v[144:147], v[156:159], v[16:31]
    ds_read_b64_tr_b16 v[172:173], v248 offset:54528
    ds_read_b64_tr_b16 v[174:175], v248 offset:55296
    s_waitcnt lgkmcnt(7)
    v_mfma_f32_32x32x16_bf16 v[32:47], v[144:147], v[160:163], v[32:47]
    s_barrier
    ds_read_b128 v[144:147], v232 offset:32768
    ds_read_b64_tr_b16 v[152:153], v248 offset:57472
    ds_read_b64_tr_b16 v[154:155], v248 offset:58240
    s_waitcnt lgkmcnt(7)
    v_mfma_f32_32x32x16_bf16 v[0:15], v[148:151], v[164:167], v[0:15]
    ds_read_b64_tr_b16 v[156:157], v248 offset:57536
    ds_read_b64_tr_b16 v[158:159], v248 offset:58304
    s_waitcnt lgkmcnt(7)
    v_mfma_f32_32x32x16_bf16 v[16:31], v[148:151], v[168:171], v[16:31]
    ds_read_b64_tr_b16 v[160:161], v248 offset:57600
    ds_read_b64_tr_b16 v[162:163], v248 offset:58368
    s_waitcnt lgkmcnt(7)
    v_mfma_f32_32x32x16_bf16 v[32:47], v[148:151], v[172:175], v[32:47]
    ds_read_b128 v[148:151], v233 offset:32768
    ds_read_b64_tr_b16 v[164:165], v248 offset:60576
    ds_read_b64_tr_b16 v[166:167], v248 offset:61344
    s_waitcnt lgkmcnt(7)
    v_mfma_f32_32x32x16_bf16 v[0:15], v[144:147], v[152:155], v[0:15]
    ds_read_b64_tr_b16 v[168:169], v248 offset:60640
    ds_read_b64_tr_b16 v[170:171], v248 offset:61408
    s_waitcnt lgkmcnt(7)
    v_mfma_f32_32x32x16_bf16 v[16:31], v[144:147], v[156:159], v[16:31]
    s_cmp_lg_u32 s24, 0
    s_cbranch_scc1 C_NOL_sss
    buffer_load_dwordx2 v[240:241], v251, s[16:19], 0 offen
C_NOL_sss:
    ds_read_b64_tr_b16 v[172:173], v248 offset:60704
    ds_read_b64_tr_b16 v[174:175], v248 offset:61472
    s_waitcnt lgkmcnt(7)
    v_mfma_f32_32x32x16_bf16 v[32:47], v[144:147], v[160:163], v[32:47]
    s_barrier
    ds_read_b128 v[144:147], v234 offset:32768
    ds_read_b64_tr_b16 v[152:153], v248 offset:0
    ds_read_b64_tr_b16 v[154:155], v248 offset:768
    s_waitcnt lgkmcnt(7)
    v_mfma_f32_32x32x16_bf16 v[0:15], v[148:151], v[164:167], v[0:15]
    ds_read_b64_tr_b16 v[156:157], v248 offset:64
    ds_read_b64_tr_b16 v[158:159], v248 offset:832
    s_waitcnt lgkmcnt(7)
    v_mfma_f32_32x32x16_bf16 v[16:31], v[148:151], v[168:171], v[16:31]
    ds_read_b64_tr_b16 v[160:161], v248 offset:128
    ds_read_b64_tr_b16 v[162:163], v248 offset:896
    s_waitcnt lgkmcnt(7)
    v_mfma_f32_32x32x16_bf16 v[32:47], v[148:151], v[172:175], v[32:47]
    ds_read_b128 v[148:151], v235 offset:32768
    ds_read_b64_tr_b16 v[164:165], v248 offset:3104
    ds_read_b64_tr_b16 v[166:167], v248 offset:3872
    s_waitcnt lgkmcnt(7)
    v_mfma_f32_32x32x16_bf16 v[0:15], v[144:147], v[152:155], v[0:15]
    ds_read_b64_tr_b16 v[168:169], v248 offset:3168
    ds_read_b64_tr_b16 v[170:171], v248 offset:3936
    s_waitcnt lgkmcnt(7)
    v_mfma_f32_32x32x16_bf16 v[16:31], v[144:147], v[156:159], v[16:31]
    ds_read_b64_tr_b16 v[172:173], v248 offset:3232
    ds_read_b64_tr_b16 v[174:175], v248 offset:4000
    s_waitcnt lgkmcnt(7)
    v_mfma_f32_32x32x16_bf16 v[32:47], v[144:147], v[160:163], v[32:47]
    s_barrier
    ds_read_b128 v[144:147], v232 offset:49152
    ds_read_b64_tr_b16 v[152:153], v248 offset:6176
    ds_read_b64_tr_b16 v[154:155], v248 offset:6944
    s_waitcnt lgkmcnt(7)
    v_mfma_f32_32x32x16_bf16 v[0:15], v[148:151], v[164:167], v[0:15]
    ds_read_b64_tr_b16 v[156:157], v248 offset:6240
    ds_read_b64_tr_b16 v[158:159], v248 offset:7008
    s_waitcnt lgkmcnt(7)
    v_mfma_f32_32x32x16_bf16 v[16:31], v[148:151], v[168:171], v[16:31]
    ds_read_b64_tr_b16 v[160:161], v248 offset:6304
    ds_read_b64_tr_b16 v[162:163], v248 offset:7072
    s_waitcnt lgkmcnt(7)
    v_mfma_f32_32x32x16_bf16 v[32:47], v[148:151], v[172:175], v[32:47]
    ds_read_b128 v[148:151], v233 offset:49152
    ds_read_b64_tr_b16 v[164:165], v248 offset:9280
    ds_read_b64_tr_b16 v[166:167], v248 offset:10048
    s_waitcnt lgkmcnt(7)
    v_mfma_f32_32x32x16_bf16 v[0:15], v[144:147], v[152:155], v[0:15]
    ds_read_b64_tr_b16 v[168:169], v248 offset:9344
    ds_read_b64_tr_b16 v[170:171], v248 offset:10112
    s_waitcnt lgkmcnt(7)
    v_mfma_f32_32x32x16_bf16 v[16:31], v[144:147], v[156:159], v[16:31]
    ds_read_b64_tr_b16 v[172:173], v248 offset:9408
    ds_read_b64_tr_b16 v[174:175], v248 offset:10176
    s_waitcnt lgkmcnt(7)
    v_mfma_f32_32x32x16_bf16 v[32:47], v[144:147], v[160:163], v[32:47]
    s_barrier
    ds_read_b128 v[144:147], v234 offset:49152
    ds_read_b64_tr_b16 v[152:153], v248 offset:16384
    ds_read_b64_tr_b16 v[154:155], v248 offset:17152
    s_waitcnt lgkmcnt(7)
    v_mfma_f32_32x32x16_bf16 v[0:15], v[148:151], v[164:167], v[0:15]
    ds_read_b64_tr_b16 v[156:157], v248 offset:16448
    ds_read_b64_tr_b16 v[158:159], v248 offset:17216
    s_waitcnt lgkmcnt(7)
    v_mfma_f32_32x32x16_bf16 v[16:31], v[148:151], v[168:171], v[16:31]
    ds_read_b64_tr_b16 v[160:161], v248 offset:16512
    ds_read_b64_tr_b16 v[162:163], v248 offset:17280
    s_waitcnt lgkmcnt(7)
    v_mfma_f32_32x32x16_bf16 v[32:47], v[148:151], v[172:175], v[32:47]
    ds_read_b128 v[148:151], v235 offset:49152
    ds_read_b64_tr_b16 v[164:165], v248 offset:19488
    ds_read_b64_tr_b16 v[166:167], v248 offset:20256
    s_waitcnt lgkmcnt(7)
    v_mfma_f32_32x32x16_bf16 v[0:15], v[144:147], v[152:155], v[0:15]
    ds_read_b64_tr_b16 v[168:169], v248 offset:19552
    ds_read_b64_tr_b16 v[170:171], v248 offset:20320
    s_waitcnt lgkmcnt(7)
    v_mfma_f32_32x32x16_bf16 v[16:31], v[144:147], v[156:159], v[16:31]
    ds_read_b64_tr_b16 v[172:173], v248 offset:19616
    ds_read_b64_tr_b16 v[174:175], v248 offset:20384
    s_waitcnt lgkmcnt(7)
    v_mfma_f32_32x32x16_bf16 v[32:47], v[144:147], v[160:163], v[32:47]
    s_barrier
    ds_read_b64_tr_b16 v[192:193], v252 offset:22560
    ds_read_b64_tr_b16 v[194:195], v252 offset:23328
    ds_read_b128 v[176:179], v224 offset:0
    s_waitcnt lgkmcnt(7)
    v_mfma_f32_32x32x16_bf16 v[0:15], v[148:151], v[164:167], v[0:15]
    ds_read_b128 v[180:183], v224 offset:4096
    ds_read_b64_tr_b16 v[196:197], v252 offset:22592
    ds_read_b64_tr_b16 v[198:199], v252 offset:23360
    s_waitcnt lgkmcnt(8)
    v_mfma_f32_32x32x16_bf16 v[16:31], v[148:151], v[168:171], v[16:31]
    ds_read_b64_tr_b16 v[200:201], v252 offset:22624
    ds_read_b64_tr_b16 v[202:203], v252 offset:23392
    s_waitcnt lgkmcnt(8)
    v_mfma_f32_32x32x16_bf16 v[32:47], v[148:151], v[172:175], v[32:47]
    s_waitcnt lgkmcnt(5)
    v_mfma_f32_32x32x16_bf16 v[48:63], v[192:195], v[176:179], 0
    s_waitcnt lgkmcnt(4)
    v_mfma_f32_32x32x16_bf16 v[64:79], v[192:195], v[180:183], 0
    s_waitcnt lgkmcnt(0)
    s_barrier
    ds_read_b64_tr_b16 v[204:205], v252 offset:32768
    ds_read_b64_tr_b16 v[206:207], v252 offset:33536
    ds_read_b128 v[184:187], v225 offset:0
    v_mfma_f32_32x32x16_bf16 v[80:95], v[196:199], v[176:179], 0
    ds_read_b128 v[188:191], v225 offset:4096
    ds_read_b64_tr_b16 v[208:209], v252 offset:32800
    ds_read_b64_tr_b16 v[210:211], v252 offset:33568
    v_mfma_f32_32x32x16_bf16 v[96:111], v[196:199], v[180:183], 0
    ds_read_b64_tr_b16 v[212:213], v252 offset:32832
    ds_read_b64_tr_b16 v[214:215], v252 offset:33600
    v_mfma_f32_32x32x16_bf16 v[112:127], v[200:203], v[176:179], 0
    v_mfma_f32_32x32x16_bf16 v[128:143], v[200:203], v[180:183], 0
    s_waitcnt lgkmcnt(5)
    v_mfma_f32_32x32x16_bf16 v[48:63], v[204:207], v[184:187], v[48:63]
    s_waitcnt lgkmcnt(4)
    v_mfma_f32_32x32x16_bf16 v[64:79], v[204:207], v[188:191], v[64:79]
    s_waitcnt lgkmcnt(0)
    s_barrier
    ds_read_b128 v[144:147], v236 offset:0
    ds_read_b64_tr_b16 v[152:153], v248 offset:38944
    ds_read_b64_tr_b16 v[154:155], v248 offset:39712
    v_mfma_f32_32x32x16_bf16 v[80:95], v[208:211], v[184:187], v[80:95]
    ds_read_b64_tr_b16 v[156:157], v248 offset:39008
    ds_read_b64_tr_b16 v[158:159], v248 offset:39776
    v_mfma_f32_32x32x16_bf16 v[96:111], v[208:211], v[188:191], v[96:111]
    ds_read_b64_tr_b16 v[160:161], v248 offset:39072
    ds_read_b64_tr_b16 v[162:163], v248 offset:39840
    v_mfma_f32_32x32x16_bf16 v[112:127], v[212:215], v[184:187], v[112:127]
    v_mfma_f32_32x32x16_bf16 v[128:143], v[212:215], v[188:191], v[128:143]
    ds_read_b128 v[148:151], v237 offset:0
    ds_read_b64_tr_b16 v[164:165], v248 offset:42048
    ds_read_b64_tr_b16 v[166:167], v248 offset:42816
    s_waitcnt lgkmcnt(7)
    v_mfma_f32_32x32x16_bf16 v[0:15], v[144:147], v[152:155], v[0:15]
    ds_read_b64_tr_b16 v[168:169], v248 offset:42112
    ds_read_b64_tr_b16 v[170:171], v248 offset:42880
    s_waitcnt lgkmcnt(7)
    v_mfma_f32_32x32x16_bf16 v[16:31], v[144:147], v[156:159], v[16:31]
    ds_read_b64_tr_b16 v[172:173], v248 offset:42176
    ds_read_b64_tr_b16 v[174:175], v248 offset:42944
    s_waitcnt lgkmcnt(7)
    v_mfma_f32_32x32x16_bf16 v[32:47], v[144:147], v[160:163], v[32:47]
    s_cmp_lg_u32 s24, 0
    s_cbranch_scc1 C_NON_sss
    s_mov_b64 exec, 1
    v_mov_b32 v242, 162976
C_NOR_sss:
    s_waitcnt vmcnt(0)
    v_cmp_ne_u32 vcc, 0, v240
    s_nop 1
    s_cbranch_vccnz C_NOK_sss
    buffer_load_dwordx2 v[240:241], v251, s[16:19], 0 offen sc0 sc1
    s_branch C_NOR_sss
C_NOK_sss:
    ds_write_b64 v242, v[240:241]
    s_mov_b64 exec, -1
C_NON_sss:
    s_waitcnt vmcnt(0)
    s_barrier
    ds_read_b128 v[144:147], v238 offset:0
    ds_read_b64_tr_b16 v[152:153], v248 offset:45120
    ds_read_b64_tr_b16 v[154:155], v248 offset:45888
    s_waitcnt lgkmcnt(7)
    v_mfma_f32_32x32x16_bf16 v[0:15], v[148:151], v[164:167], v[0:15]
    ds_read_b64_tr_b16 v[156:157], v248 offset:45184
    ds_read_b64_tr_b16 v[158:159], v248 offset:45952
    s_waitcnt lgkmcnt(7)
    v_mfma_f32_32x32x16_bf16 v[16:31], v[148:151], v[168:171], v[16:31]
    ds_read_b64_tr_b16 v[160:161], v248 offset:45248
    ds_read_b64_tr_b16 v[162:163], v248 offset:46016
    s_waitcnt lgkmcnt(7)
    v_mfma_f32_32x32x16_bf16 v[32:47], v[148:151], v[172:175], v[32:47]
    ds_read_b128 v[148:151], v239 offset:0
    ds_read_b64_tr_b16 v[164:165], v248 offset:48224
    ds_read_b64_tr_b16 v[166:167], v248 offset:48992
    s_waitcnt lgkmcnt(7)
    v_mfma_f32_32x32x16_bf16 v[0:15], v[144:147], v[152:155], v[0:15]
    ds_read_b64_tr_b16 v[168:169], v248 offset:48288
    ds_read_b64_tr_b16 v[170:171], v248 offset:49056
    s_waitcnt lgkmcnt(7)
    v_mfma_f32_32x32x16_bf16 v[16:31], v[144:147], v[156:159], v[16:31]
    ds_read_b64_tr_b16 v[172:173], v248 offset:48352
    ds_read_b64_tr_b16 v[174:175], v248 offset:49120
    s_waitcnt lgkmcnt(7)
    v_mfma_f32_32x32x16_bf16 v[32:47], v[144:147], v[160:163], v[32:47]
    s_barrier
    ds_read_b64_tr_b16 v[192:193], v252 offset:51296
    ds_read_b64_tr_b16 v[194:195], v252 offset:52064
    ds_read_b128 v[176:179], v226 offset:0
    s_waitcnt lgkmcnt(7)
    v_mfma_f32_32x32x16_bf16 v[0:15], v[148:151], v[164:167], v[0:15]
    ds_read_b128 v[180:183], v226 offset:4096
    ds_read_b64_tr_b16 v[196:197], v252 offset:51328
    ds_read_b64_tr_b16 v[198:199], v252 offset:52096
    s_waitcnt lgkmcnt(8)
    v_mfma_f32_32x32x16_bf16 v[16:31], v[148:151], v[168:171], v[16:31]
    ds_read_b64_tr_b16 v[200:201], v252 offset:51360
    ds_read_b64_tr_b16 v[202:203], v252 offset:52128
    s_waitcnt lgkmcnt(8)
    v_mfma_f32_32x32x16_bf16 v[32:47], v[148:151], v[172:175], v[32:47]
    s_waitcnt lgkmcnt(5)
    v_mfma_f32_32x32x16_bf16 v[48:63], v[192:195], v[176:179], v[48:63]
    s_waitcnt lgkmcnt(4)
    v_mfma_f32_32x32x16_bf16 v[64:79], v[192:195], v[180:183], v[64:79]
    s_waitcnt lgkmcnt(0)
    s_barrier
    ds_read_b64_tr_b16 v[204:205], v252 offset:57472
    ds_read_b64_tr_b16 v[206:207], v252 offset:58240
    ds_read_b128 v[184:187], v227 offset:0
    v_mfma_f32_32x32x16_bf16 v[80:95], v[196:199], v[176:179], v[80:95]
    ds_read_b128 v[188:191], v227 offset:4096
    ds_read_b64_tr_b16 v[208:209], v252 offset:57504
    ds_read_b64_tr_b16 v[210:211], v252 offset:58272
    v_mfma_f32_32x32x16_bf16 v[96:111], v[196:199], v[180:183], v[96:111]
    ds_read_b64_tr_b16 v[212:213], v252 offset:57536
    ds_read_b64_tr_b16 v[214:215], v252 offset:58304
    v_mfma_f32_32x32x16_bf16 v[112:127], v[200:203], v[176:179], v[112:127]
    v_mfma_f32_32x32x16_bf16 v[128:143], v[200:203], v[180:183], v[128:143]
    s_waitcnt lgkmcnt(5)
    v_mfma_f32_32x32x16_bf16 v[48:63], v[204:207], v[184:187], v[48:63]
    s_waitcnt lgkmcnt(4)
    v_mfma_f32_32x32x16_bf16 v[64:79], v[204:207], v[188:191], v[64:79]
    s_waitcnt lgkmcnt(0)
    s_barrier
    ds_read_b128 v[144:147], v236 offset:16384
    ds_read_b64_tr_b16 v[152:153], v248 offset:16384
    ds_read_b64_tr_b16 v[154:155], v248 offset:17152
    v_mfma_f32_32x32x16_bf16 v[80:95], v[208:211], v[184:187], v[80:95]
    ds_read_b64_tr_b16 v[156:157], v248 offset:16448
    ds_read_b64_tr_b16 v[158:159], v248 offset:17216
    v_mfma_f32_32x32x16_bf16 v[96:111], v[208:211], v[188:191], v[96:111]
    ds_read_b64_tr_b16 v[160:161], v248 offset:16512
    ds_read_b64_tr_b16 v[162:163], v248 offset:17280
    v_mfma_f32_32x32x16_bf16 v[112:127], v[212:215], v[184:187], v[112:127]
    v_mfma_f32_32x32x16_bf16 v[128:143], v[212:215], v[188:191], v[128:143]
    ds_read_b128 v[148:151], v237 offset:16384
    ds_read_b64_tr_b16 v[164:165], v248 offset:19488
    ds_read_b64_tr_b16 v[166:167], v248 offset:20256
    s_waitcnt lgkmcnt(7)
    v_mfma_f32_32x32x16_bf16 v[0:15], v[144:147], v[152:155], v[0:15]
    ds_read_b64_tr_b16 v[168:169], v248 offset:19552
    ds_read_b64_tr_b16 v[170:171], v248 offset:20320
    s_waitcnt lgkmcnt(7)
    v_mfma_f32_32x32x16_bf16 v[16:31], v[144:147], v[156:159], v[16:31]
    ds_read_b64_tr_b16 v[172:173], v248 offset:19616
    ds_read_b64_tr_b16 v[174:175], v248 offset:20384
    s_waitcnt lgkmcnt(7)
    v_mfma_f32_32x32x16_bf16 v[32:47], v[144:147], v[160:163], v[32:47]
    s_barrier
    ds_read_b128 v[144:147], v238 offset:16384
    ds_read_b64_tr_b16 v[152:153], v248 offset:22560
    ds_read_b64_tr_b16 v[154:155], v248 offset:23328
    s_waitcnt lgkmcnt(7)
    v_mfma_f32_32x32x16_bf16 v[0:15], v[148:151], v[164:167], v[0:15]
    ds_read_b64_tr_b16 v[156:157], v248 offset:22624
    ds_read_b64_tr_b16 v[158:159], v248 offset:23392
    s_waitcnt lgkmcnt(7)
    v_mfma_f32_32x32x16_bf16 v[16:31], v[148:151], v[168:171], v[16:31]
    ds_read_b64_tr_b16 v[160:161], v248 offset:22688
    ds_read_b64_tr_b16 v[162:163], v248 offset:23456
    s_waitcnt lgkmcnt(7)
    v_mfma_f32_32x32x16_bf16 v[32:47], v[148:151], v[172:175], v[32:47]
    ds_read_b128 v[148:151], v239 offset:16384
    ds_read_b64_tr_b16 v[164:165], v248 offset:25664
    ds_read_b64_tr_b16 v[166:167], v248 offset:26432
    s_waitcnt lgkmcnt(7)
    v_mfma_f32_32x32x16_bf16 v[0:15], v[144:147], v[152:155], v[0:15]
    ds_read_b64_tr_b16 v[168:169], v248 offset:25728
    ds_read_b64_tr_b16 v[170:171], v248 offset:26496
    s_waitcnt lgkmcnt(7)
    v_mfma_f32_32x32x16_bf16 v[16:31], v[144:147], v[156:159], v[16:31]
    ds_read_b64_tr_b16 v[172:173], v248 offset:25792
    ds_read_b64_tr_b16 v[174:175], v248 offset:26560
    s_waitcnt lgkmcnt(7)
    v_mfma_f32_32x32x16_bf16 v[32:47], v[144:147], v[160:163], v[32:47]
    s_barrier
    ds_read_b64_tr_b16 v[192:193], v252 offset:32768
    ds_read_b64_tr_b16 v[194:195], v252 offset:33536
    ds_read_b128 v[176:179], v224 offset:16384
    s_waitcnt lgkmcnt(7)
    v_mfma_f32_32x32x16_bf16 v[0:15], v[148:151], v[164:167], v[0:15]
    ds_read_b128 v[180:183], v224 offset:20480
    ds_read_b64_tr_b16 v[196:197], v252 offset:32800
    ds_read_b64_tr_b16 v[198:199], v252 offset:33568
    s_waitcnt lgkmcnt(8)
    v_mfma_f32_32x32x16_bf16 v[16:31], v[148:151], v[168:171], v[16:31]
    ds_read_b64_tr_b16 v[200:201], v252 offset:32832
    ds_read_b64_tr_b16 v[202:203], v252 offset:33600
    s_waitcnt lgkmcnt(8)
    v_mfma_f32_32x32x16_bf16 v[32:47], v[148:151], v[172:175], v[32:47]
    s_waitcnt lgkmcnt(5)
    v_mfma_f32_32x32x16_bf16 v[48:63], v[192:195], v[176:179], v[48:63]
    s_waitcnt lgkmcnt(4)
    v_mfma_f32_32x32x16_bf16 v[64:79], v[192:195], v[180:183], v[64:79]
    s_waitcnt lgkmcnt(0)
    s_barrier
    ds_read_b64_tr_b16 v[204:205], v252 offset:38944
    ds_read_b64_tr_b16 v[206:207], v252 offset:39712
    ds_read_b128 v[184:187], v225 offset:16384
    v_mfma_f32_32x32x16_bf16 v[80:95], v[196:199], v[176:179], v[80:95]
    ds_read_b128 v[188:191], v225 offset:20480
    ds_read_b64_tr_b16 v[208:209], v252 offset:38976
    ds_read_b64_tr_b16 v[210:211], v252 offset:39744
    v_mfma_f32_32x32x16_bf16 v[96:111], v[196:199], v[180:183], v[96:111]
    ds_read_b64_tr_b16 v[212:213], v252 offset:39008
    ds_read_b64_tr_b16 v[214:215], v252 offset:39776
    v_mfma_f32_32x32x16_bf16 v[112:127], v[200:203], v[176:179], v[112:127]
    v_mfma_f32_32x32x16_bf16 v[128:143], v[200:203], v[180:183], v[128:143]
    s_waitcnt lgkmcnt(5)
    v_mfma_f32_32x32x16_bf16 v[48:63], v[204:207], v[184:187], v[48:63]
    s_waitcnt lgkmcnt(4)
    v_mfma_f32_32x32x16_bf16 v[64:79], v[204:207], v[188:191], v[64:79]
    s_waitcnt lgkmcnt(0)
    s_barrier
    ds_read_b128 v[144:147], v236 offset:32768
    ds_read_b64_tr_b16 v[152:153], v248 offset:45120
    ds_read_b64_tr_b16 v[154:155], v248 offset:45888
    v_mfma_f32_32x32x16_bf16 v[80:95], v[208:211], v[184:187], v[80:95]
    ds_read_b64_tr_b16 v[156:157], v248 offset:45184
    ds_read_b64_tr_b16 v[158:159], v248 offset:45952
    v_mfma_f32_32x32x16_bf16 v[96:111], v[208:211], v[188:191], v[96:111]
    ds_read_b64_tr_b16 v[160:161], v248 offset:45248
    ds_read_b64_tr_b16 v[162:163], v248 offset:46016
    v_mfma_f32_32x32x16_bf16 v[112:127], v[212:215], v[184:187], v[112:127]
    v_mfma_f32_32x32x16_bf16 v[128:143], v[212:215], v[188:191], v[128:143]
    ds_read_b128 v[148:151], v237 offset:32768
    ds_read_b64_tr_b16 v[164:165], v248 offset:48224
    ds_read_b64_tr_b16 v[166:167], v248 offset:48992
    s_waitcnt lgkmcnt(7)
    v_mfma_f32_32x32x16_bf16 v[0:15], v[144:147], v[152:155], v[0:15]
    ds_read_b64_tr_b16 v[168:169], v248 offset:48288
    ds_read_b64_tr_b16 v[170:171], v248 offset:49056
    s_waitcnt lgkmcnt(7)
    v_mfma_f32_32x32x16_bf16 v[16:31], v[144:147], v[156:159], v[16:31]
    ds_read_b64_tr_b16 v[172:173], v248 offset:48352
    ds_read_b64_tr_b16 v[174:175], v248 offset:49120
    s_waitcnt lgkmcnt(7)
    v_mfma_f32_32x32x16_bf16 v[32:47], v[144:147], v[160:163], v[32:47]
    s_barrier
    ds_read_b128 v[144:147], v238 offset:32768
    ds_read_b64_tr_b16 v[152:153], v248 offset:51296
    ds_read_b64_tr_b16 v[154:155], v248 offset:52064
    s_waitcnt lgkmcnt(7)
    v_mfma_f32_32x32x16_bf16 v[0:15], v[148:151], v[164:167], v[0:15]
    ds_read_b64_tr_b16 v[156:157], v248 offset:51360
    ds_read_b64_tr_b16 v[158:159], v248 offset:52128
    s_waitcnt lgkmcnt(7)
    v_mfma_f32_32x32x16_bf16 v[16:31], v[148:151], v[168:171], v[16:31]
    ds_read_b64_tr_b16 v[160:161], v248 offset:51424
    ds_read_b64_tr_b16 v[162:163], v248 offset:52192
    s_waitcnt lgkmcnt(7)
    v_mfma_f32_32x32x16_bf16 v[32:47], v[148:151], v[172:175], v[32:47]
    ds_read_b128 v[148:151], v239 offset:32768
    ds_read_b64_tr_b16 v[164:165], v248 offset:54400
    ds_read_b64_tr_b16 v[166:167], v248 offset:55168
    s_waitcnt lgkmcnt(7)
    v_mfma_f32_32x32x16_bf16 v[0:15], v[144:147], v[152:155], v[0:15]
    ds_read_b64_tr_b16 v[168:169], v248 offset:54464
    ds_read_b64_tr_b16 v[170:171], v248 offset:55232
    s_waitcnt lgkmcnt(7)
    v_mfma_f32_32x32x16_bf16 v[16:31], v[144:147], v[156:159], v[16:31]
    ds_read_b64_tr_b16 v[172:173], v248 offset:54528
    ds_read_b64_tr_b16 v[174:175], v248 offset:55296
    s_waitcnt lgkmcnt(7)
    v_mfma_f32_32x32x16_bf16 v[32:47], v[144:147], v[160:163], v[32:47]
    s_barrier
    ds_read_b64_tr_b16 v[192:193], v252 offset:57472
    ds_read_b64_tr_b16 v[194:195], v252 offset:58240
    ds_read_b128 v[176:179], v226 offset:16384
    s_waitcnt lgkmcnt(7)
    v_mfma_f32_32x32x16_bf16 v[0:15], v[148:151], v[164:167], v[0:15]
    ds_read_b128 v[180:183], v226 offset:20480
    ds_read_b64_tr_b16 v[196:197], v252 offset:57504
    ds_read_b64_tr_b16 v[198:199], v252 offset:58272
    s_waitcnt lgkmcnt(8)
    v_mfma_f32_32x32x16_bf16 v[16:31], v[148:151], v[168:171], v[16:31]
    ds_read_b64_tr_b16 v[200:201], v252 offset:57536
    ds_read_b64_tr_b16 v[202:203], v252 offset:58304
    s_waitcnt lgkmcnt(8)
    v_mfma_f32_32x32x16_bf16 v[32:47], v[148:151], v[172:175], v[32:47]
    s_waitcnt lgkmcnt(5)
    v_mfma_f32_32x32x16_bf16 v[48:63], v[192:195], v[176:179], v[48:63]
    s_waitcnt lgkmcnt(4)
    v_mfma_f32_32x32x16_bf16 v[64:79], v[192:195], v[180:183], v[64:79]
    s_waitcnt lgkmcnt(0)
    s_barrier
    ds_read_b64_tr_b16 v[204:205], v217 offset:0
    ds_read_b64_tr_b16 v[206:207], v217 offset:768
    ds_read_b128 v[184:187], v227 offset:16384
    v_mfma_f32_32x32x16_bf16 v[80:95], v[196:199], v[176:179], v[80:95]
    ds_read_b128 v[188:191], v227 offset:20480
    ds_read_b64_tr_b16 v[208:209], v217 offset:32
    ds_read_b64_tr_b16 v[210:211], v217 offset:800
    v_mfma_f32_32x32x16_bf16 v[96:111], v[196:199], v[180:183], v[96:111]
    ds_read_b64_tr_b16 v[212:213], v217 offset:64
    ds_read_b64_tr_b16 v[214:215], v217 offset:832
    v_mfma_f32_32x32x16_bf16 v[112:127], v[200:203], v[176:179], v[112:127]
    v_mfma_f32_32x32x16_bf16 v[128:143], v[200:203], v[180:183], v[128:143]
    s_waitcnt lgkmcnt(5)
    v_mfma_f32_32x32x16_bf16 v[48:63], v[204:207], v[184:187], v[48:63]
    s_waitcnt lgkmcnt(4)
    v_mfma_f32_32x32x16_bf16 v[64:79], v[204:207], v[188:191], v[64:79]
    s_waitcnt lgkmcnt(0)
    s_barrier
    ds_read_b128 v[144:147], v236 offset:49152
    ds_read_b64_tr_b16 v[152:153], v216 offset:6176
    ds_read_b64_tr_b16 v[154:155], v216 offset:6944
    v_mfma_f32_32x32x16_bf16 v[80:95], v[208:211], v[184:187], v[80:95]
    ds_read_b64_tr_b16 v[156:157], v216 offset:6240
    ds_read_b64_tr_b16 v[158:159], v216 offset:7008
    v_mfma_f32_32x32x16_bf16 v[96:111], v[208:211], v[188:191], v[96:111]
    ds_read_b64_tr_b16 v[160:161], v216 offset:6304
    ds_read_b64_tr_b16 v[162:163], v216 offset:7072
    v_mfma_f32_32x32x16_bf16 v[112:127], v[212:215], v[184:187], v[112:127]
    v_mfma_f32_32x32x16_bf16 v[128:143], v[212:215], v[188:191], v[128:143]
    ds_read_b128 v[148:151], v237 offset:49152
    ds_read_b64_tr_b16 v[164:165], v216 offset:9280
    ds_read_b64_tr_b16 v[166:167], v216 offset:10048
    s_waitcnt lgkmcnt(7)
    v_mfma_f32_32x32x16_bf16 v[0:15], v[144:147], v[152:155], v[0:15]
    ds_read_b64_tr_b16 v[168:169], v216 offset:9344
    ds_read_b64_tr_b16 v[170:171], v216 offset:10112
    s_waitcnt lgkmcnt(7)
    v_mfma_f32_32x32x16_bf16 v[16:31], v[144:147], v[156:159], v[16:31]
    ds_read_b64_tr_b16 v[172:173], v216 offset:9408
    ds_read_b64_tr_b16 v[174:175], v216 offset:10176
    s_waitcnt lgkmcnt(7)
    v_mfma_f32_32x32x16_bf16 v[32:47], v[144:147], v[160:163], v[32:47]
    s_barrier
    ds_read_b128 v[144:147], v238 offset:49152
    ds_read_b64_tr_b16 v[152:153], v248 offset:32768
    ds_read_b64_tr_b16 v[154:155], v248 offset:33536
    s_waitcnt lgkmcnt(7)
    v_mfma_f32_32x32x16_bf16 v[0:15], v[148:151], v[164:167], v[0:15]
    ds_read_b64_tr_b16 v[156:157], v248 offset:32832
    ds_read_b64_tr_b16 v[158:159], v248 offset:33600
    s_waitcnt lgkmcnt(7)
    v_mfma_f32_32x32x16_bf16 v[16:31], v[148:151], v[168:171], v[16:31]
    ds_read_b64_tr_b16 v[160:161], v248 offset:32896
    ds_read_b64_tr_b16 v[162:163], v248 offset:33664
    s_waitcnt lgkmcnt(7)
    v_mfma_f32_32x32x16_bf16 v[32:47], v[148:151], v[172:175], v[32:47]
    ds_read_b128 v[148:151], v239 offset:49152
    ds_read_b64_tr_b16 v[164:165], v248 offset:35872
    ds_read_b64_tr_b16 v[166:167], v248 offset:36640
    s_waitcnt lgkmcnt(7)
    v_mfma_f32_32x32x16_bf16 v[0:15], v[144:147], v[152:155], v[0:15]
    ds_read_b64_tr_b16 v[168:169], v248 offset:35936
    ds_read_b64_tr_b16 v[170:171], v248 offset:36704
    s_waitcnt lgkmcnt(7)
    v_mfma_f32_32x32x16_bf16 v[16:31], v[144:147], v[156:159], v[16:31]
    ds_read_b64_tr_b16 v[172:173], v248 offset:36000
    ds_read_b64_tr_b16 v[174:175], v248 offset:36768
    s_waitcnt lgkmcnt(7)
    v_mfma_f32_32x32x16_bf16 v[32:47], v[144:147], v[160:163], v[32:47]
    s_barrier
    ds_read_b64_tr_b16 v[192:193], v252 offset:38944
    ds_read_b64_tr_b16 v[194:195], v252 offset:39712
    ds_read_b128 v[176:179], v224 offset:32768
    s_waitcnt lgkmcnt(7)
    v_mfma_f32_32x32x16_bf16 v[0:15], v[148:151], v[164:167], v[0:15]
    ds_read_b128 v[180:183], v224 offset:36864
    ds_read_b64_tr_b16 v[196:197], v252 offset:38976
    ds_read_b64_tr_b16 v[198:199], v252 offset:39744
    s_waitcnt lgkmcnt(8)
    v_mfma_f32_32x32x16_bf16 v[16:31], v[148:151], v[168:171], v[16:31]
    ds_read_b64_tr_b16 v[200:201], v252 offset:39008
    ds_read_b64_tr_b16 v[202:203], v252 offset:39776
    s_waitcnt lgkmcnt(8)
    v_mfma_f32_32x32x16_bf16 v[32:47], v[148:151], v[172:175], v[32:47]
C_P2:
    v_mov_b32 v152, v217
    s_waitcnt lgkmcnt(5)
    v_mfma_f32_32x32x16_bf16 v[48:63], v[192:195], v[176:179], v[48:63]
    v_min_u32 v251, 1, v249
    v_lshlrev_b32 v251, 31, v251
    s_waitcnt lgkmcnt(4)
    v_mfma_f32_32x32x16_bf16 v[64:79], v[192:195], v[180:183], v[64:79]
    s_waitcnt lgkmcnt(0)
    s_barrier
    ds_read_b64_tr_b16 v[204:205], v252 offset:45120
    ds_read_b64_tr_b16 v[206:207], v252 offset:45888
    ds_read_b128 v[184:187], v225 offset:32768
    v_mul_f32 v0, s65, v0
    v_mul_f32 v1, s65, v1
    v_mfma_f32_32x32x16_bf16 v[80:95], v[196:199], v[176:179], v[80:95]
    ds_read_b128 v[188:191], v225 offset:36864
    ds_read_b64_tr_b16 v[208:209], v252 offset:45152
    ds_read_b64_tr_b16 v[210:211], v252 offset:45920
    v_mul_f32 v2, s65, v2
    v_mul_f32 v3, s65, v3
    v_mfma_f32_32x32x16_bf16 v[96:111], v[196:199], v[180:183], v[96:111]
    ds_read_b64_tr_b16 v[212:213], v252 offset:45184
    ds_read_b64_tr_b16 v[214:215], v252 offset:45952
    v_mul_f32 v4, s65, v4
    v_mul_f32 v5, s65, v5
    v_mfma_f32_32x32x16_bf16 v[112:127], v[200:203], v[176:179], v[112:127]
    v_mul_f32 v6, s65, v6
    v_mul_f32 v7, s65, v7
    v_mfma_f32_32x32x16_bf16 v[128:143], v[200:203], v[180:183], v[128:143]
    v_cvt_pk_bf16_f32 v216, v0, v1
    v_cvt_pk_bf16_f32 v217, v2, v3
    s_waitcnt lgkmcnt(5)
    v_mfma_f32_32x32x16_bf16 v[48:63], v[204:207], v[184:187], v[48:63]
    v_cvt_pk_bf16_f32 v218, v4, v5
    v_cvt_pk_bf16_f32 v219, v6, v7
    s_waitcnt lgkmcnt(4)
    v_mfma_f32_32x32x16_bf16 v[64:79], v[204:207], v[188:191], v[64:79]
    s_waitcnt lgkmcnt(0)
    s_barrier
    ds_read_b64_tr_b16 v[192:193], v252 offset:51296
    ds_read_b64_tr_b16 v[194:195], v252 offset:52064
    ds_read_b128 v[176:179], v226 offset:32768
    buffer_store_dwordx4 v[216:219], v253, s[12:15], s37 offen sc1
    v_mul_f32 v8, s65, v8
    v_mfma_f32_32x32x16_bf16 v[80:95], v[208:211], v[184:187], v[80:95]
    ds_read_b128 v[180:183], v226 offset:36864
    ds_read_b64_tr_b16 v[196:197], v252 offset:51328
    ds_read_b64_tr_b16 v[198:199], v252 offset:52096
    v_mul_f32 v9, s65, v9
    v_mul_f32 v10, s65, v10
    v_mfma_f32_32x32x16_bf16 v[96:111], v[208:211], v[188:191], v[96:111]
    ds_read_b64_tr_b16 v[200:201], v252 offset:51360
    ds_read_b64_tr_b16 v[202:203], v252 offset:52128
    v_mul_f32 v11, s65, v11
    v_mul_f32 v12, s65, v12
    v_mfma_f32_32x32x16_bf16 v[112:127], v[212:215], v[184:187], v[112:127]
    v_mul_f32 v13, s65, v13
    v_mul_f32 v14, s65, v14
    v_mfma_f32_32x32x16_bf16 v[128:143], v[212:215], v[188:191], v[128:143]
    v_mul_f32 v15, s65, v15
    v_cvt_pk_bf16_f32 v220, v8, v9
    s_waitcnt lgkmcnt(5)
    v_mfma_f32_32x32x16_bf16 v[48:63], v[192:195], v[176:179], v[48:63]
    v_cvt_pk_bf16_f32 v221, v10, v11
    v_cvt_pk_bf16_f32 v222, v12, v13
    s_waitcnt lgkmcnt(4)
    v_mfma_f32_32x32x16_bf16 v[64:79], v[192:195], v[180:183], v[64:79]
    s_waitcnt lgkmcnt(0)
    s_barrier
    ds_read_b64_tr_b16 v[204:205], v252 offset:57472
    ds_read_b64_tr_b16 v[206:207], v252 offset:58240
    ds_read_b128 v[184:187], v227 offset:32768
    v_cvt_pk_bf16_f32 v223, v14, v15
    buffer_store_dwordx4 v[220:223], v253, s[12:15], s62 offen sc1
    v_mfma_f32_32x32x16_bf16 v[80:95], v[196:199], v[176:179], v[80:95]
    ds_read_b128 v[188:191], v227 offset:36864
    ds_read_b64_tr_b16 v[208:209], v252 offset:57504
    ds_read_b64_tr_b16 v[210:211], v252 offset:58272
    v_mul_f32 v16, s66, v16
    v_mul_f32 v17, s66, v17
    v_mfma_f32_32x32x16_bf16 v[96:111], v[196:199], v[180:183], v[96:111]
    ds_read_b64_tr_b16 v[212:213], v252 offset:57536
    ds_read_b64_tr_b16 v[214:215], v252 offset:58304
    v_mul_f32 v18, s66, v18
    v_mul_f32 v19, s66, v19
    v_mfma_f32_32x32x16_bf16 v[112:127], v[200:203], v[176:179], v[112:127]
    v_mul_f32 v20, s66, v20
    v_mul_f32 v21, s66, v21
    v_mfma_f32_32x32x16_bf16 v[128:143], v[200:203], v[180:183], v[128:143]
    v_mul_f32 v22, s66, v22
    v_mul_f32 v23, s66, v23
    s_waitcnt lgkmcnt(5)
    v_mfma_f32_32x32x16_bf16 v[48:63], v[204:207], v[184:187], v[48:63]
    v_cvt_pk_bf16_f32 v240, v16, v17
    v_cvt_pk_bf16_f32 v241, v18, v19
    s_waitcnt lgkmcnt(4)
    v_mfma_f32_32x32x16_bf16 v[64:79], v[204:207], v[188:191], v[64:79]
    s_waitcnt lgkmcnt(0)
    s_barrier
    ds_read_b64_tr_b16 v[192:193], v152 offset:0
    ds_read_b64_tr_b16 v[194:195], v152 offset:768
    ds_read_b128 v[176:179], v224 offset:49152
    v_cvt_pk_bf16_f32 v242, v20, v21
    v_cvt_pk_bf16_f32 v243, v22, v23
    v_mfma_f32_32x32x16_bf16 v[80:95], v[208:211], v[184:187], v[80:95]
    ds_read_b128 v[180:183], v224 offset:53248
    ds_read_b64_tr_b16 v[196:197], v152 offset:32
    ds_read_b64_tr_b16 v[198:199], v152 offset:800
    buffer_store_dwordx4 v[240:243], v254, s[12:15], s38 offen sc1
    v_mul_f32 v24, s66, v24
    v_mfma_f32_32x32x16_bf16 v[96:111], v[208:211], v[188:191], v[96:111]
    ds_read_b64_tr_b16 v[200:201], v152 offset:64
    ds_read_b64_tr_b16 v[202:203], v152 offset:832
    v_mul_f32 v25, s66, v25
    v_mul_f32 v26, s66, v26
    v_mfma_f32_32x32x16_bf16 v[112:127], v[212:215], v[184:187], v[112:127]
    v_mul_f32 v27, s66, v27
    v_mul_f32 v28, s66, v28
    v_mfma_f32_32x32x16_bf16 v[128:143], v[212:215], v[188:191], v[128:143]
    v_mul_f32 v29, s66, v29
    v_mul_f32 v30, s66, v30
    s_waitcnt lgkmcnt(5)
    v_mfma_f32_32x32x16_bf16 v[48:63], v[192:195], v[176:179], v[48:63]
    v_mul_f32 v31, s66, v31
    v_cvt_pk_bf16_f32 v244, v24, v25
    s_waitcnt lgkmcnt(4)
    v_mfma_f32_32x32x16_bf16 v[64:79], v[192:195], v[180:183], v[64:79]
    s_waitcnt lgkmcnt(0)
    s_barrier
    ds_read_b64_tr_b16 v[204:205], v152 offset:16384
    ds_read_b64_tr_b16 v[206:207], v152 offset:17152
    ds_read_b128 v[184:187], v225 offset:49152
    v_cvt_pk_bf16_f32 v245, v26, v27
    v_cvt_pk_bf16_f32 v246, v28, v29
    v_mfma_f32_32x32x16_bf16 v[80:95], v[196:199], v[176:179], v[80:95]
    ds_read_b128 v[188:191], v225 offset:53248
    ds_read_b64_tr_b16 v[208:209], v152 offset:16416
    ds_read_b64_tr_b16 v[210:211], v152 offset:17184
    v_cvt_pk_bf16_f32 v247, v30, v31
    buffer_store_dwordx4 v[244:247], v254, s[12:15], s63 offen sc1
    v_mfma_f32_32x32x16_bf16 v[96:111], v[196:199], v[180:183], v[96:111]
    ds_read_b64_tr_b16 v[212:213], v152 offset:16448
    ds_read_b64_tr_b16 v[214:215], v152 offset:17216
    v_mul_f32 v32, s67, v32
    v_mul_f32 v33, s67, v33
    v_mfma_f32_32x32x16_bf16 v[112:127], v[200:203], v[176:179], v[112:127]
    v_mul_f32 v34, s67, v34
    v_mul_f32 v35, s67, v35
    v_mfma_f32_32x32x16_bf16 v[128:143], v[200:203], v[180:183], v[128:143]
    v_mul_f32 v36, s67, v36
    v_mul_f32 v37, s67, v37
    s_waitcnt lgkmcnt(5)
    v_mfma_f32_32x32x16_bf16 v[48:63], v[204:207], v[184:187], v[48:63]
    v_mul_f32 v38, s67, v38
    v_mul_f32 v39, s67, v39
    s_waitcnt lgkmcnt(4)
    v_mfma_f32_32x32x16_bf16 v[64:79], v[204:207], v[188:191], v[64:79]
    s_waitcnt lgkmcnt(0)
    s_barrier
    ds_read_b64_tr_b16 v[192:193], v152 offset:22560
    ds_read_b64_tr_b16 v[194:195], v152 offset:23328
    ds_read_b128 v[176:179], v226 offset:49152
    v_cvt_pk_bf16_f32 v216, v32, v33
    v_cvt_pk_bf16_f32 v217, v34, v35
    v_mfma_f32_32x32x16_bf16 v[80:95], v[208:211], v[184:187], v[80:95]
    ds_read_b128 v[180:183], v226 offset:53248
    ds_read_b64_tr_b16 v[196:197], v152 offset:22592
    ds_read_b64_tr_b16 v[198:199], v152 offset:23360
    v_cvt_pk_bf16_f32 v218, v36, v37
    v_cvt_pk_bf16_f32 v219, v38, v39
    v_mfma_f32_32x32x16_bf16 v[96:111], v[208:211], v[188:191], v[96:111]
    ds_read_b64_tr_b16 v[200:201], v152 offset:22624
    ds_read_b64_tr_b16 v[202:203], v152 offset:23392
    buffer_store_dwordx4 v[216:219], v255, s[12:15], s39 offen sc1
    v_mul_f32 v40, s67, v40
    v_mfma_f32_32x32x16_bf16 v[112:127], v[212:215], v[184:187], v[112:127]
    v_mul_f32 v41, s67, v41
    v_mul_f32 v42, s67, v42
    v_mfma_f32_32x32x16_bf16 v[128:143], v[212:215], v[188:191], v[128:143]
    v_mul_f32 v43, s67, v43
    v_mul_f32 v44, s67, v44
    s_waitcnt lgkmcnt(5)
    v_mfma_f32_32x32x16_bf16 v[48:63], v[192:195], v[176:179], v[48:63]
    v_mul_f32 v45, s67, v45
    v_mul_f32 v46, s67, v46
    s_waitcnt lgkmcnt(4)
    v_mfma_f32_32x32x16_bf16 v[64:79], v[192:195], v[180:183], v[64:79]
    s_waitcnt lgkmcnt(0)
    s_barrier
    ds_read_b64_tr_b16 v[204:205], v152 offset:6176
    ds_read_b64_tr_b16 v[206:207], v152 offset:6944
    ds_read_b128 v[184:187], v227 offset:49152
    v_mul_f32 v47, s67, v47
    v_cvt_pk_bf16_f32 v220, v40, v41
    v_mfma_f32_32x32x16_bf16 v[80:95], v[196:199], v[176:179], v[80:95]
    ds_read_b128 v[188:191], v227 offset:53248
    ds_read_b64_tr_b16 v[208:209], v152 offset:6208
    ds_read_b64_tr_b16 v[210:211], v152 offset:6976
    v_cvt_pk_bf16_f32 v221, v42, v43
    v_cvt_pk_bf16_f32 v222, v44, v45
    v_mfma_f32_32x32x16_bf16 v[96:111], v[196:199], v[180:183], v[96:111]
    ds_read_b64_tr_b16 v[212:213], v152 offset:6240
    ds_read_b64_tr_b16 v[214:215], v152 offset:7008
    v_cvt_pk_bf16_f32 v223, v46, v47
    buffer_store_dwordx4 v[220:223], v255, s[12:15], s64 offen sc1
    v_mfma_f32_32x32x16_bf16 v[112:127], v[200:203], v[176:179], v[112:127]
    s_mov_b32 s4, 0x0000ffff
    s_mov_b32 s5, 0x0000ffff
    v_mfma_f32_32x32x16_bf16 v[128:143], v[200:203], v[180:183], v[128:143]
    s_lshl_b32 s32, s31, 3
    s_add_u32 s32, s32, s24
    s_waitcnt lgkmcnt(5)
    v_mfma_f32_32x32x16_bf16 v[48:63], v[204:207], v[184:187], v[48:63]
    s_lshl_b32 s8, s32, 15
    s_lshl_b32 s33, s30, 10
    s_waitcnt lgkmcnt(4)
    v_mfma_f32_32x32x16_bf16 v[64:79], v[204:207], v[188:191], v[64:79]
    s_waitcnt lgkmcnt(0)
    s_barrier
    ds_read_b64_tr_b16 v[192:193], v252 offset:32768
    ds_read_b64_tr_b16 v[194:195], v252 offset:33536
    ds_read_b128 v[176:179], v228 offset:0
    s_add_u32 s8, s8, s33
    s_add_u32 s8, s8, 16777216
    v_mfma_f32_32x32x16_bf16 v[80:95], v[208:211], v[184:187], v[80:95]
    ds_read_b128 v[180:183], v228 offset:4096
    ds_read_b64_tr_b16 v[196:197], v252 offset:32800
    ds_read_b64_tr_b16 v[198:199], v252 offset:33568
    s_lshl_b32 s67, s30, 17
    s_add_u32 s67, s67, 2097152
    v_mfma_f32_32x32x16_bf16 v[96:111], v[208:211], v[188:191], v[96:111]
    ds_read_b64_tr_b16 v[200:201], v252 offset:32832
    ds_read_b64_tr_b16 v[202:203], v252 offset:33600
    s_lshr_b32 s11, s24, 1
    s_and_b32 s32, s24, 1
    v_mfma_f32_32x32x16_bf16 v[112:127], v[212:215], v[184:187], v[112:127]
    s_lshl_b32 s33, s30, 1
    s_add_u32 s32, s32, s33
    v_mfma_f32_32x32x16_bf16 v[128:143], v[212:215], v[188:191], v[128:143]
    s_mul_i32 s33, s11, 22528
    s_mul_i32 s7, s32, 88064
    s_waitcnt lgkmcnt(5)
    v_mfma_f32_32x32x16_bf16 v[48:63], v[192:195], v[176:179], v[48:63]
    s_add_u32 s7, s7, s33
    s_add_u32 s7, s7, 6291456
    s_waitcnt lgkmcnt(4)
    v_mfma_f32_32x32x16_bf16 v[64:79], v[192:195], v[180:183], v[64:79]
    s_waitcnt lgkmcnt(0)
    s_barrier
    ds_read_b64_tr_b16 v[204:205], v252 offset:38944
    ds_read_b64_tr_b16 v[206:207], v252 offset:39712
    ds_read_b128 v[184:187], v229 offset:0
    s_mul_i32 s6, s31, 176128
    s_add_u32 s6, s6, s33
    v_mfma_f32_32x32x16_bf16 v[80:95], v[196:199], v[176:179], v[80:95]
    ds_read_b128 v[188:191], v229 offset:4096
    ds_read_b64_tr_b16 v[208:209], v252 offset:38976
    ds_read_b64_tr_b16 v[210:211], v252 offset:39744
    s_add_u32 s6, s6, 12582912
    s_add_u32 s69, s6, 88064
    v_mfma_f32_32x32x16_bf16 v[96:111], v[196:199], v[180:183], v[96:111]
    ds_read_b64_tr_b16 v[212:213], v252 offset:39008
    ds_read_b64_tr_b16 v[214:215], v252 offset:39776
    s_lshl_b32 s33, s11, 13
    s_lshl_b32 s9, s31, 16
    v_mfma_f32_32x32x16_bf16 v[112:127], v[200:203], v[176:179], v[112:127]
    s_add_u32 s9, s9, s33
    s_add_u32 s9, s9, 14680064
    v_mfma_f32_32x32x16_bf16 v[128:143], v[200:203], v[180:183], v[128:143]
    s_lshl_b32 s10, s32, 15
    s_add_u32 s10, s10, s33
    s_waitcnt lgkmcnt(5)
    v_mfma_f32_32x32x16_bf16 v[48:63], v[204:207], v[184:187], v[48:63]
    s_add_u32 s10, s10, 16777216
    s_lshl_b32 s62, s32, 9
    s_waitcnt lgkmcnt(4)
    v_mfma_f32_32x32x16_bf16 v[64:79], v[204:207], v[188:191], v[64:79]
    s_waitcnt lgkmcnt(0)
    s_barrier
    ds_read_b64_tr_b16 v[192:193], v252 offset:45120
    ds_read_b64_tr_b16 v[194:195], v252 offset:45888
    ds_read_b128 v[176:179], v230 offset:0
    s_add_u32 s62, s62, 20971520
    s_lshl_b32 s63, s32, 15
    v_mfma_f32_32x32x16_bf16 v[80:95], v[208:211], v[184:187], v[80:95]
    ds_read_b128 v[180:183], v230 offset:4096
    ds_read_b64_tr_b16 v[196:197], v252 offset:45152
    ds_read_b64_tr_b16 v[198:199], v252 offset:45920
    s_lshl_b32 s33, s31, 7
    s_add_u32 s63, s63, s33
    v_mfma_f32_32x32x16_bf16 v[96:111], v[208:211], v[188:191], v[96:111]
    ds_read_b64_tr_b16 v[200:201], v252 offset:45184
    ds_read_b64_tr_b16 v[202:203], v252 offset:45952
    s_lshl_b32 s33, s11, 5
    s_add_u32 s63, s63, s33
    v_mfma_f32_32x32x16_bf16 v[112:127], v[212:215], v[184:187], v[112:127]
    s_mov_b32 s20, s56
    s_mov_b32 s21, s57
    v_mfma_f32_32x32x16_bf16 v[128:143], v[212:215], v[188:191], v[128:143]
    s_mov_b32 s22, 2097152
    s_mov_b32 s23, 0x00020000
    v_mov_b32 v216, 162976
    ds_read_b64 v[236:237], v216
    s_waitcnt lgkmcnt(6)
    v_mfma_f32_32x32x16_bf16 v[48:63], v[192:195], v[176:179], v[48:63]
    v_mov_b32 v29, v250
    v_and_b32 v238, 15, v249
    s_waitcnt lgkmcnt(5)
    v_mfma_f32_32x32x16_bf16 v[64:79], v[192:195], v[180:183], v[64:79]
    s_waitcnt lgkmcnt(1)
    s_barrier
    ds_read_b64_tr_b16 v[204:205], v252 offset:51296
    ds_read_b64_tr_b16 v[206:207], v252 offset:52064
    ds_read_b128 v[184:187], v231 offset:0
    v_lshrrev_b32 v239, 5, v249
    v_lshlrev_b32 v238, 4, v238
    v_mfma_f32_32x32x16_bf16 v[80:95], v[196:199], v[176:179], v[80:95]
    ds_read_b128 v[188:191], v231 offset:4096
    ds_read_b64_tr_b16 v[208:209], v252 offset:51328
    ds_read_b64_tr_b16 v[210:211], v252 offset:52096
    v_lshl_add_u32 v30, v239, 8, v238
    v_and_b32 v238, 31, v249
    v_mfma_f32_32x32x16_bf16 v[96:111], v[196:199], v[180:183], v[96:111]
    ds_read_b64_tr_b16 v[212:213], v252 offset:51360
    ds_read_b64_tr_b16 v[214:215], v252 offset:52128
    v_lshlrev_b32 v239, 4, v239
    v_lshl_add_u32 v235, v238, 10, v239
    v_mfma_f32_32x32x16_bf16 v[112:127], v[200:203], v[176:179], v[112:127]
    v_lshrrev_b32 v239, 3, v238
    v_and_b32 v238, 7, v238
    v_mfma_f32_32x32x16_bf16 v[128:143], v[200:203], v[180:183], v[128:143]
    v_lshlrev_b32 v238, 2, v238
    v_lshl_add_u32 v234, v239, 7, v238
    s_waitcnt lgkmcnt(5)
    v_mfma_f32_32x32x16_bf16 v[48:63], v[204:207], v[184:187], v[48:63]
    v_mov_b32 v28, 0xdddd
    v_and_b32 v238, 27, v249
    s_waitcnt lgkmcnt(4)
    v_mfma_f32_32x32x16_bf16 v[64:79], v[204:207], v[188:191], v[64:79]
    s_waitcnt lgkmcnt(0)
    s_barrier
    ds_read_b64_tr_b16 v[192:193], v252 offset:57472
    ds_read_b64_tr_b16 v[194:195], v252 offset:58240
    ds_read_b128 v[176:179], v228 offset:16384
    v_cmp_eq_u32 vcc, 16, v238
    v_mov_b32 v239, 0x3f803f80
    v_mfma_f32_32x32x16_bf16 v[80:95], v[208:211], v[184:187], v[80:95]
    ds_read_b128 v[180:183], v228 offset:20480
    ds_read_b64_tr_b16 v[196:197], v252 offset:57504
    ds_read_b64_tr_b16 v[198:199], v252 offset:58272
    v_mov_b32 v238, 0
    v_cndmask_b32 v16, v238, v239, vcc
    s_waitcnt vmcnt(0)
    buffer_store_dwordx2 v[236:237], v251, s[12:15], s42 offen sc1
    v_mfma_f32_32x32x16_bf16 v[96:111], v[208:211], v[188:191], v[96:111]
    ds_read_b64_tr_b16 v[200:201], v252 offset:57536
    ds_read_b64_tr_b16 v[202:203], v252 offset:58304
    v_mov_b32 v17, v16
    v_mov_b32 v18, v16
    v_mfma_f32_32x32x16_bf16 v[112:127], v[212:215], v[184:187], v[112:127]
    v_mov_b32 v19, v16
    v_mov_b32 v20, v16
    v_mfma_f32_32x32x16_bf16 v[128:143], v[212:215], v[188:191], v[128:143]
    v_mov_b32 v21, v16
    v_mov_b32 v22, v16
    s_waitcnt lgkmcnt(5)
    v_mfma_f32_32x32x16_bf16 v[48:63], v[192:195], v[176:179], v[48:63]
    v_mov_b32 v23, v16
    v_mov_b32 v24, v16
    s_waitcnt lgkmcnt(4)
    v_mfma_f32_32x32x16_bf16 v[64:79], v[192:195], v[180:183], v[64:79]
    s_waitcnt lgkmcnt(0)
    s_barrier
    ds_read_b64_tr_b16 v[204:205], v152 offset:0
    ds_read_b64_tr_b16 v[206:207], v152 offset:768
    ds_read_b128 v[184:187], v229 offset:16384
    v_mov_b32 v25, v16
    v_mov_b32 v26, v16
    v_mfma_f32_32x32x16_bf16 v[80:95], v[196:199], v[176:179], v[80:95]
    ds_read_b128 v[188:191], v229 offset:20480
    ds_read_b64_tr_b16 v[208:209], v152 offset:32
    ds_read_b64_tr_b16 v[210:211], v152 offset:800
    v_mov_b32 v27, v16
    v_mov_b32 v0, 0
    v_mfma_f32_32x32x16_bf16 v[96:111], v[196:199], v[180:183], v[96:111]
    ds_read_b64_tr_b16 v[212:213], v152 offset:64
    ds_read_b64_tr_b16 v[214:215], v152 offset:832
    v_mov_b32 v1, 0
    v_mov_b32 v2, 0
    v_mfma_f32_32x32x16_bf16 v[112:127], v[200:203], v[176:179], v[112:127]
    v_mov_b32 v3, 0
    v_mov_b32 v4, 0
    v_mfma_f32_32x32x16_bf16 v[128:143], v[200:203], v[180:183], v[128:143]
    v_mov_b32 v5, 0
    v_mov_b32 v6, 0
    s_waitcnt lgkmcnt(5)
    v_mfma_f32_32x32x16_bf16 v[48:63], v[204:207], v[184:187], v[48:63]
    v_mov_b32 v7, 0
    v_mov_b32 v8, 0
    s_waitcnt lgkmcnt(4)
    v_mfma_f32_32x32x16_bf16 v[64:79], v[204:207], v[188:191], v[64:79]
    s_waitcnt lgkmcnt(0)
    s_barrier
    ds_read_b64_tr_b16 v[192:193], v152 offset:32768
    ds_read_b64_tr_b16 v[194:195], v152 offset:33536
    ds_read_b128 v[176:179], v230 offset:16384
    v_mov_b32 v9, 0
    v_mov_b32 v10, 0
    v_mfma_f32_32x32x16_bf16 v[80:95], v[208:211], v[184:187], v[80:95]
    ds_read_b128 v[180:183], v230 offset:20480
    ds_read_b64_tr_b16 v[196:197], v152 offset:32800
    ds_read_b64_tr_b16 v[198:199], v152 offset:33568
    v_mov_b32 v11, 0
    v_mov_b32 v12, 0
    v_mfma_f32_32x32x16_bf16 v[96:111], v[208:211], v[188:191], v[96:111]
    ds_read_b64_tr_b16 v[200:201], v152 offset:32832
    ds_read_b64_tr_b16 v[202:203], v152 offset:33600
    v_mov_b32 v13, 0
    v_mov_b32 v14, 0
    v_mfma_f32_32x32x16_bf16 v[112:127], v[212:215], v[184:187], v[112:127]
    v_mov_b32 v15, 0
    v_mov_b32 v40, 0
    v_mfma_f32_32x32x16_bf16 v[128:143], v[212:215], v[188:191], v[128:143]
    v_mov_b32 v41, 0
    v_mov_b32 v42, 0
    s_waitcnt lgkmcnt(5)
    v_mfma_f32_32x32x16_bf16 v[48:63], v[192:195], v[176:179], v[48:63]
    v_mov_b32 v43, 0
    v_mov_b32 v44, 0
    s_waitcnt lgkmcnt(4)
    v_mfma_f32_32x32x16_bf16 v[64:79], v[192:195], v[180:183], v[64:79]
    s_waitcnt lgkmcnt(0)
    s_barrier
    ds_read_b64_tr_b16 v[204:205], v152 offset:38944
    ds_read_b64_tr_b16 v[206:207], v152 offset:39712
    ds_read_b128 v[184:187], v231 offset:16384
    v_mov_b32 v45, 0
    v_mov_b32 v46, 0
    v_mfma_f32_32x32x16_bf16 v[80:95], v[196:199], v[176:179], v[80:95]
    ds_read_b128 v[188:191], v231 offset:20480
    ds_read_b64_tr_b16 v[208:209], v152 offset:38976
    ds_read_b64_tr_b16 v[210:211], v152 offset:39744
    v_mov_b32 v47, 0
    s_lshr_b32 s32, s30, 1
    v_mfma_f32_32x32x16_bf16 v[96:111], v[196:199], v[180:183], v[96:111]
    ds_read_b64_tr_b16 v[212:213], v152 offset:39008
    ds_read_b64_tr_b16 v[214:215], v152 offset:39776
    s_lshl_b32 s32, s32, 7
    v_and_b32 v238, 15, v249
    v_mfma_f32_32x32x16_bf16 v[112:127], v[200:203], v[176:179], v[112:127]
    v_lshl_add_u32 v232, v238, 3, s32
    s_lshl_b32 s32, s31, 8
    v_mfma_f32_32x32x16_bf16 v[128:143], v[200:203], v[180:183], v[128:143]
    v_cmp_gt_u32 vcc, 32, v249
    v_and_b32 v238, 31, v249
    s_waitcnt lgkmcnt(5)
    v_mfma_f32_32x32x16_bf16 v[48:63], v[204:207], v[184:187], v[48:63]
    v_lshl_add_u32 v238, v238, 3, s32
    v_cndmask_b32 v232, v238, v232, vcc
    s_waitcnt lgkmcnt(4)
    v_mfma_f32_32x32x16_bf16 v[64:79], v[204:207], v[188:191], v[64:79]
    s_waitcnt lgkmcnt(0)
    s_barrier
    ds_read_b64_tr_b16 v[192:193], v152 offset:16384
    ds_read_b64_tr_b16 v[194:195], v152 offset:17152
    ds_read_b128 v[176:179], v228 offset:32768
    s_lshr_b32 s32, s30, 2
    v_cmp_gt_u32 vcc, 32, v249
    v_mfma_f32_32x32x16_bf16 v[80:95], v[208:211], v[184:187], v[80:95]
    ds_read_b128 v[180:183], v228 offset:36864
    ds_read_b64_tr_b16 v[196:197], v152 offset:16416
    ds_read_b64_tr_b16 v[198:199], v152 offset:17184
    v_mov_b32 v238, s32
    v_mov_b32 v239, s31
    v_mfma_f32_32x32x16_bf16 v[96:111], v[208:211], v[188:191], v[96:111]
    ds_read_b64_tr_b16 v[200:201], v152 offset:16448
    ds_read_b64_tr_b16 v[202:203], v152 offset:17216
    v_cndmask_b32 v238, v239, v238, vcc
    v_and_b32 v239, 31, v249
    v_mfma_f32_32x32x16_bf16 v[112:127], v[212:215], v[184:187], v[112:127]
    v_lshl_add_u32 v238, v238, 5, v239
    v_add_u32 v238, 256, v238
    v_mfma_f32_32x32x16_bf16 v[128:143], v[212:215], v[188:191], v[128:143]
    v_lshlrev_b32 v233, 3, v238
    s_lshl_b32 s32, s27, 4
    s_waitcnt lgkmcnt(5)
    v_mfma_f32_32x32x16_bf16 v[48:63], v[192:195], v[176:179], v[48:63]
    s_add_u32 s32, s32, s28
    s_lshl_b32 s32, s32, 3
    s_waitcnt lgkmcnt(4)
    v_mfma_f32_32x32x16_bf16 v[64:79], v[192:195], v[180:183], v[64:79]
    s_waitcnt lgkmcnt(0)
    s_barrier
    ds_read_b64_tr_b16 v[204:205], v152 offset:22560
    ds_read_b64_tr_b16 v[206:207], v152 offset:23328
    ds_read_b128 v[184:187], v229 offset:32768
    s_lshl_b32 s33, s31, 5
    s_add_u32 s33, s33, s30
    v_mfma_f32_32x32x16_bf16 v[80:95], v[196:199], v[176:179], v[80:95]
    ds_read_b128 v[188:191], v229 offset:36864
    ds_read_b64_tr_b16 v[208:209], v152 offset:22592
    ds_read_b64_tr_b16 v[210:211], v152 offset:23360
    s_add_u32 s33, s33, 256
    s_lshl_b32 s33, s33, 3
    v_mfma_f32_32x32x16_bf16 v[96:111], v[196:199], v[180:183], v[96:111]
    ds_read_b64_tr_b16 v[212:213], v152 offset:22624
    ds_read_b64_tr_b16 v[214:215], v152 offset:23392
    v_mov_b32 v248, 2147483648
    v_writelane_b32 v248, s32, 0
    v_mfma_f32_32x32x16_bf16 v[112:127], v[200:203], v[176:179], v[112:127]
    v_writelane_b32 v248, s33, 1
    v_mfma_f32_32x32x16_bf16 v[128:143], v[200:203], v[180:183], v[128:143]
    s_waitcnt lgkmcnt(5)
    v_mfma_f32_32x32x16_bf16 v[48:63], v[204:207], v[184:187], v[48:63]
    s_waitcnt lgkmcnt(4)
    v_mfma_f32_32x32x16_bf16 v[64:79], v[204:207], v[188:191], v[64:79]
    s_waitcnt lgkmcnt(0)
    s_barrier
    ds_read_b64_tr_b16 v[192:193], v152 offset:6176
    ds_read_b64_tr_b16 v[194:195], v152 offset:6944
    ds_read_b128 v[176:179], v230 offset:32768
    v_mfma_f32_32x32x16_bf16 v[80:95], v[208:211], v[184:187], v[80:95]
    ds_read_b128 v[180:183], v230 offset:36864
    ds_read_b64_tr_b16 v[196:197], v152 offset:6208
    ds_read_b64_tr_b16 v[198:199], v152 offset:6976
    v_mfma_f32_32x32x16_bf16 v[96:111], v[208:211], v[188:191], v[96:111]
    ds_read_b64_tr_b16 v[200:201], v152 offset:6240
    ds_read_b64_tr_b16 v[202:203], v152 offset:7008
    v_mfma_f32_32x32x16_bf16 v[112:127], v[212:215], v[184:187], v[112:127]
    v_mfma_f32_32x32x16_bf16 v[128:143], v[212:215], v[188:191], v[128:143]
    s_waitcnt lgkmcnt(5)
    v_mfma_f32_32x32x16_bf16 v[48:63], v[192:195], v[176:179], v[48:63]
    s_waitcnt lgkmcnt(4)
    v_mfma_f32_32x32x16_bf16 v[64:79], v[192:195], v[180:183], v[64:79]
    s_waitcnt lgkmcnt(0)
    s_barrier
    ds_read_b64_tr_b16 v[204:205], v252 offset:32768
    ds_read_b64_tr_b16 v[206:207], v252 offset:33536
    ds_read_b128 v[184:187], v231 offset:32768
    v_mfma_f32_32x32x16_bf16 v[80:95], v[196:199], v[176:179], v[80:95]
    ds_read_b128 v[188:191], v231 offset:36864
    ds_read_b64_tr_b16 v[208:209], v252 offset:32800
    ds_read_b64_tr_b16 v[210:211], v252 offset:33568
    v_mfma_f32_32x32x16_bf16 v[96:111], v[196:199], v[180:183], v[96:111]
    ds_read_b64_tr_b16 v[212:213], v252 offset:32832
    ds_read_b64_tr_b16 v[214:215], v252 offset:33600
    v_mfma_f32_32x32x16_bf16 v[112:127], v[200:203], v[176:179], v[112:127]
    v_mfma_f32_32x32x16_bf16 v[128:143], v[200:203], v[180:183], v[128:143]
    s_waitcnt lgkmcnt(5)
    v_mfma_f32_32x32x16_bf16 v[48:63], v[204:207], v[184:187], v[48:63]
    s_waitcnt lgkmcnt(4)
    v_mfma_f32_32x32x16_bf16 v[64:79], v[204:207], v[188:191], v[64:79]
    s_waitcnt lgkmcnt(0)
    s_barrier
    ds_read_b64_tr_b16 v[192:193], v252 offset:38944
    ds_read_b64_tr_b16 v[194:195], v252 offset:39712
    ds_read_b128 v[176:179], v228 offset:49152
    v_mfma_f32_32x32x16_bf16 v[80:95], v[208:211], v[184:187], v[80:95]
    ds_read_b128 v[180:183], v228 offset:53248
    ds_read_b64_tr_b16 v[196:197], v252 offset:38976
    ds_read_b64_tr_b16 v[198:199], v252 offset:39744
    v_mfma_f32_32x32x16_bf16 v[96:111], v[208:211], v[188:191], v[96:111]
    ds_read_b64_tr_b16 v[200:201], v252 offset:39008
    ds_read_b64_tr_b16 v[202:203], v252 offset:39776
    v_mfma_f32_32x32x16_bf16 v[112:127], v[212:215], v[184:187], v[112:127]
    v_mfma_f32_32x32x16_bf16 v[128:143], v[212:215], v[188:191], v[128:143]
    s_waitcnt lgkmcnt(5)
    v_mfma_f32_32x32x16_bf16 v[48:63], v[192:195], v[176:179], v[48:63]
    s_waitcnt lgkmcnt(4)
    v_mfma_f32_32x32x16_bf16 v[64:79], v[192:195], v[180:183], v[64:79]
    s_waitcnt lgkmcnt(0)
    s_barrier
    ds_read_b64_tr_b16 v[204:205], v252 offset:45120
    ds_read_b64_tr_b16 v[206:207], v252 offset:45888
    ds_read_b128 v[184:187], v229 offset:49152
    v_mfma_f32_32x32x16_bf16 v[80:95], v[196:199], v[176:179], v[80:95]
    ds_read_b128 v[188:191], v229 offset:53248
    ds_read_b64_tr_b16 v[208:209], v252 offset:45152
    ds_read_b64_tr_b16 v[210:211], v252 offset:45920
    v_mfma_f32_32x32x16_bf16 v[96:111], v[196:199], v[180:183], v[96:111]
    ds_read_b64_tr_b16 v[212:213], v252 offset:45184
    ds_read_b64_tr_b16 v[214:215], v252 offset:45952
    v_mfma_f32_32x32x16_bf16 v[112:127], v[200:203], v[176:179], v[112:127]
    v_mfma_f32_32x32x16_bf16 v[128:143], v[200:203], v[180:183], v[128:143]
    s_waitcnt lgkmcnt(5)
    v_mfma_f32_32x32x16_bf16 v[48:63], v[204:207], v[184:187], v[48:63]
    s_waitcnt lgkmcnt(4)
    v_mfma_f32_32x32x16_bf16 v[64:79], v[204:207], v[188:191], v[64:79]
    s_waitcnt lgkmcnt(0)
    s_barrier
    ds_read_b64_tr_b16 v[192:193], v252 offset:51296
    ds_read_b64_tr_b16 v[194:195], v252 offset:52064
    ds_read_b128 v[176:179], v230 offset:49152
    v_mfma_f32_32x32x16_bf16 v[80:95], v[208:211], v[184:187], v[80:95]
    ds_read_b128 v[180:183], v230 offset:53248
    ds_read_b64_tr_b16 v[196:197], v252 offset:51328
    ds_read_b64_tr_b16 v[198:199], v252 offset:52096
    v_mfma_f32_32x32x16_bf16 v[96:111], v[208:211], v[188:191], v[96:111]
    ds_read_b64_tr_b16 v[200:201], v252 offset:51360
    ds_read_b64_tr_b16 v[202:203], v252 offset:52128
    v_mfma_f32_32x32x16_bf16 v[112:127], v[212:215], v[184:187], v[112:127]
    v_mfma_f32_32x32x16_bf16 v[128:143], v[212:215], v[188:191], v[128:143]
    s_waitcnt lgkmcnt(5)
    v_mfma_f32_32x32x16_bf16 v[48:63], v[192:195], v[176:179], v[48:63]
    s_waitcnt lgkmcnt(4)
    v_mfma_f32_32x32x16_bf16 v[64:79], v[192:195], v[180:183], v[64:79]
    s_waitcnt lgkmcnt(0)
    s_barrier
    ds_read_b64_tr_b16 v[204:205], v252 offset:57472
    ds_read_b64_tr_b16 v[206:207], v252 offset:58240
    ds_read_b128 v[184:187], v231 offset:49152
    v_mfma_f32_32x32x16_bf16 v[80:95], v[196:199], v[176:179], v[80:95]
    ds_read_b128 v[188:191], v231 offset:53248
    ds_read_b64_tr_b16 v[208:209], v252 offset:57504
    ds_read_b64_tr_b16 v[210:211], v252 offset:58272
    v_mfma_f32_32x32x16_bf16 v[96:111], v[196:199], v[180:183], v[96:111]
    ds_read_b64_tr_b16 v[212:213], v252 offset:57536
    ds_read_b64_tr_b16 v[214:215], v252 offset:58304
    v_mfma_f32_32x32x16_bf16 v[112:127], v[200:203], v[176:179], v[112:127]
    v_mfma_f32_32x32x16_bf16 v[128:143], v[200:203], v[180:183], v[128:143]
    s_waitcnt lgkmcnt(5)
    v_mfma_f32_32x32x16_bf16 v[48:63], v[204:207], v[184:187], v[48:63]
    s_waitcnt lgkmcnt(4)
    v_mfma_f32_32x32x16_bf16 v[64:79], v[204:207], v[188:191], v[64:79]
    s_waitcnt lgkmcnt(2)
    v_mfma_f32_32x32x16_bf16 v[80:95], v[208:211], v[184:187], v[80:95]
    v_mfma_f32_32x32x16_bf16 v[96:111], v[208:211], v[188:191], v[96:111]
    s_waitcnt lgkmcnt(0)
    v_mfma_f32_32x32x16_bf16 v[112:127], v[212:215], v[184:187], v[112:127]
    v_mfma_f32_32x32x16_bf16 v[128:143], v[212:215], v[188:191], v[128:143]
    v_mov_b32 v176, 0xc0135761
    v_mov_b32 v177, 0xc0135761
    v_mov_b32 v178, 0xbdd2d3e8
    v_mov_b32 v179, 0xbdd2d3e8
    v_mov_b32 v180, 1.0
    v_mov_b32 v181, 1.0
    v_pk_mul_f32 v[144:145], v[48:49], v[48:49]
    v_pk_mul_f32 v[146:147], v[50:51], v[50:51]
    v_pk_mul_f32 v[148:149], v[52:53], v[52:53]
    v_pk_mul_f32 v[150:151], v[54:55], v[54:55]
    v_pk_mul_f32 v[152:153], v[64:65], v[64:65]
    v_pk_mul_f32 v[154:155], v[66:67], v[66:67]
    v_pk_mul_f32 v[156:157], v[68:69], v[68:69]
    v_pk_mul_f32 v[158:159], v[70:71], v[70:71]
    v_pk_fma_f32 v[144:145], v[144:145], v[178:179], v[176:177]
    v_pk_fma_f32 v[146:147], v[146:147], v[178:179], v[176:177]
    v_pk_fma_f32 v[148:149], v[148:149], v[178:179], v[176:177]
    v_pk_fma_f32 v[150:151], v[150:151], v[178:179], v[176:177]
    v_pk_fma_f32 v[152:153], v[152:153], v[178:179], v[176:177]
    v_pk_fma_f32 v[154:155], v[154:155], v[178:179], v[176:177]
    v_pk_fma_f32 v[156:157], v[156:157], v[178:179], v[176:177]
    v_pk_fma_f32 v[158:159], v[158:159], v[178:179], v[176:177]
    v_pk_mul_f32 v[144:145], v[144:145], v[48:49]
    v_pk_mul_f32 v[146:147], v[146:147], v[50:51]
    v_pk_mul_f32 v[148:149], v[148:149], v[52:53]
    v_pk_mul_f32 v[150:151], v[150:151], v[54:55]
    v_pk_mul_f32 v[152:153], v[152:153], v[64:65]
    v_pk_mul_f32 v[154:155], v[154:155], v[66:67]
    v_pk_mul_f32 v[156:157], v[156:157], v[68:69]
    v_pk_mul_f32 v[158:159], v[158:159], v[70:71]
    v_exp_f32 v144, v144
    v_exp_f32 v145, v145
    v_exp_f32 v146, v146
    v_exp_f32 v147, v147
    v_exp_f32 v148, v148
    v_exp_f32 v149, v149
    v_exp_f32 v150, v150
    v_exp_f32 v151, v151
    v_exp_f32 v152, v152
    v_exp_f32 v153, v153
    v_exp_f32 v154, v154
    v_exp_f32 v155, v155
    v_exp_f32 v156, v156
    v_exp_f32 v157, v157
    v_exp_f32 v158, v158
    v_exp_f32 v159, v159
    v_pk_mul_f32 v[48:49], v[48:49], v[56:57]
    v_pk_mul_f32 v[50:51], v[50:51], v[58:59]
    v_pk_mul_f32 v[52:53], v[52:53], v[60:61]
    v_pk_mul_f32 v[54:55], v[54:55], v[62:63]
    v_pk_mul_f32 v[64:65], v[64:65], v[72:73]
    v_pk_mul_f32 v[66:67], v[66:67], v[74:75]
    v_pk_mul_f32 v[68:69], v[68:69], v[76:77]
    v_pk_mul_f32 v[70:71], v[70:71], v[78:79]
    v_pk_add_f32 v[144:145], v[144:145], v[180:181]
    v_pk_add_f32 v[146:147], v[146:147], v[180:181]
    v_pk_add_f32 v[148:149], v[148:149], v[180:181]
    v_pk_add_f32 v[150:151], v[150:151], v[180:181]
    v_pk_add_f32 v[152:153], v[152:153], v[180:181]
    v_pk_add_f32 v[154:155], v[154:155], v[180:181]
    v_pk_add_f32 v[156:157], v[156:157], v[180:181]
    v_pk_add_f32 v[158:159], v[158:159], v[180:181]
    v_rcp_f32 v144, v144
    v_rcp_f32 v145, v145
    v_rcp_f32 v146, v146
    v_rcp_f32 v147, v147
    v_rcp_f32 v148, v148
    v_rcp_f32 v149, v149
    v_rcp_f32 v150, v150
    v_rcp_f32 v151, v151
    v_rcp_f32 v152, v152
    v_rcp_f32 v153, v153
    v_rcp_f32 v154, v154
    v_rcp_f32 v155, v155
    v_rcp_f32 v156, v156
    v_rcp_f32 v157, v157
    v_rcp_f32 v158, v158
    v_rcp_f32 v159, v159
    s_nop 0
    v_pk_mul_f32 v[48:49], v[48:49], v[144:145]
    v_pk_mul_f32 v[50:51], v[50:51], v[146:147]
    v_pk_mul_f32 v[52:53], v[52:53], v[148:149]
    v_pk_mul_f32 v[54:55], v[54:55], v[150:151]
    v_pk_mul_f32 v[64:65], v[64:65], v[152:153]
    v_pk_mul_f32 v[66:67], v[66:67], v[154:155]
    v_pk_mul_f32 v[68:69], v[68:69], v[156:157]
    v_pk_mul_f32 v[70:71], v[70:71], v[158:159]
    v_cvt_pk_bf16_f32 v184, v48, v49
    v_cvt_pk_bf16_f32 v185, v50, v51
    v_cvt_pk_bf16_f32 v186, v52, v53
    v_cvt_pk_bf16_f32 v187, v54, v55
    v_cvt_pk_bf16_f32 v188, v64, v65
    v_cvt_pk_bf16_f32 v189, v66, v67
    v_cvt_pk_bf16_f32 v190, v68, v69
    v_cvt_pk_bf16_f32 v191, v70, v71
    buffer_store_dwordx4 v[184:187], v250, s[12:15], s40 offen offset:0 sc1
    buffer_store_dwordx4 v[188:191], v250, s[12:15], s41 offen offset:0 sc1
    v_pk_mul_f32 v[144:145], v[80:81], v[80:81]
    v_pk_mul_f32 v[146:147], v[82:83], v[82:83]
    v_pk_mul_f32 v[148:149], v[84:85], v[84:85]
    v_pk_mul_f32 v[150:151], v[86:87], v[86:87]
    v_pk_mul_f32 v[152:153], v[96:97], v[96:97]
    v_pk_mul_f32 v[154:155], v[98:99], v[98:99]
    v_pk_mul_f32 v[156:157], v[100:101], v[100:101]
    v_pk_mul_f32 v[158:159], v[102:103], v[102:103]
    v_pk_fma_f32 v[144:145], v[144:145], v[178:179], v[176:177]
    v_pk_fma_f32 v[146:147], v[146:147], v[178:179], v[176:177]
    v_pk_fma_f32 v[148:149], v[148:149], v[178:179], v[176:177]
    v_pk_fma_f32 v[150:151], v[150:151], v[178:179], v[176:177]
    v_pk_fma_f32 v[152:153], v[152:153], v[178:179], v[176:177]
    v_pk_fma_f32 v[154:155], v[154:155], v[178:179], v[176:177]
    v_pk_fma_f32 v[156:157], v[156:157], v[178:179], v[176:177]
    v_pk_fma_f32 v[158:159], v[158:159], v[178:179], v[176:177]
    v_pk_mul_f32 v[144:145], v[144:145], v[80:81]
    v_pk_mul_f32 v[146:147], v[146:147], v[82:83]
    v_pk_mul_f32 v[148:149], v[148:149], v[84:85]
    v_pk_mul_f32 v[150:151], v[150:151], v[86:87]
    v_pk_mul_f32 v[152:153], v[152:153], v[96:97]
    v_pk_mul_f32 v[154:155], v[154:155], v[98:99]
    v_pk_mul_f32 v[156:157], v[156:157], v[100:101]
    v_pk_mul_f32 v[158:159], v[158:159], v[102:103]
    v_exp_f32 v144, v144
    v_exp_f32 v145, v145
    v_exp_f32 v146, v146
    v_exp_f32 v147, v147
    v_exp_f32 v148, v148
    v_exp_f32 v149, v149
    v_exp_f32 v150, v150
    v_exp_f32 v151, v151
    v_exp_f32 v152, v152
    v_exp_f32 v153, v153
    v_exp_f32 v154, v154
    v_exp_f32 v155, v155
    v_exp_f32 v156, v156
    v_exp_f32 v157, v157
    v_exp_f32 v158, v158
    v_exp_f32 v159, v159
    v_pk_mul_f32 v[80:81], v[80:81], v[88:89]
    v_pk_mul_f32 v[82:83], v[82:83], v[90:91]
    v_pk_mul_f32 v[84:85], v[84:85], v[92:93]
    v_pk_mul_f32 v[86:87], v[86:87], v[94:95]
    v_pk_mul_f32 v[96:97], v[96:97], v[104:105]
    v_pk_mul_f32 v[98:99], v[98:99], v[106:107]
    v_pk_mul_f32 v[100:101], v[100:101], v[108:109]
    v_pk_mul_f32 v[102:103], v[102:103], v[110:111]
    v_pk_add_f32 v[144:145], v[144:145], v[180:181]
    v_pk_add_f32 v[146:147], v[146:147], v[180:181]
    v_pk_add_f32 v[148:149], v[148:149], v[180:181]
    v_pk_add_f32 v[150:151], v[150:151], v[180:181]
    v_pk_add_f32 v[152:153], v[152:153], v[180:181]
    v_pk_add_f32 v[154:155], v[154:155], v[180:181]
    v_pk_add_f32 v[156:157], v[156:157], v[180:181]
    v_pk_add_f32 v[158:159], v[158:159], v[180:181]
    v_rcp_f32 v144, v144
    v_rcp_f32 v145, v145
    v_rcp_f32 v146, v146
    v_rcp_f32 v147, v147
    v_rcp_f32 v148, v148
    v_rcp_f32 v149, v149
    v_rcp_f32 v150, v150
    v_rcp_f32 v151, v151
    v_rcp_f32 v152, v152
    v_rcp_f32 v153, v153
    v_rcp_f32 v154, v154
    v_rcp_f32 v155, v155
    v_rcp_f32 v156, v156
    v_rcp_f32 v157, v157
    v_rcp_f32 v158, v158
    v_rcp_f32 v159, v159
    s_nop 0
    v_pk_mul_f32 v[80:81], v[80:81], v[144:145]
    v_pk_mul_f32 v[82:83], v[82:83], v[146:147]
    v_pk_mul_f32 v[84:85], v[84:85], v[148:149]
    v_pk_mul_f32 v[86:87], v[86:87], v[150:151]
    v_pk_mul_f32 v[96:97], v[96:97], v[152:153]
    v_pk_mul_f32 v[98:99], v[98:99], v[154:155]
    v_pk_mul_f32 v[100:101], v[100:101], v[156:157]
    v_pk_mul_f32 v[102:103], v[102:103], v[158:159]
    v_cvt_pk_bf16_f32 v192, v80, v81
    v_cvt_pk_bf16_f32 v193, v82, v83
    v_cvt_pk_bf16_f32 v194, v84, v85
    v_cvt_pk_bf16_f32 v195, v86, v87
    v_cvt_pk_bf16_f32 v196, v96, v97
    v_cvt_pk_bf16_f32 v197, v98, v99
    v_cvt_pk_bf16_f32 v198, v100, v101
    v_cvt_pk_bf16_f32 v199, v102, v103
    buffer_store_dwordx4 v[192:195], v250, s[12:15], s40 offen offset:1024 sc1
    buffer_store_dwordx4 v[196:199], v250, s[12:15], s41 offen offset:1024 sc1
    s_cmp_lg_u32 s43, 0
    s_cbranch_scc1 C_GEND
    v_pk_mul_f32 v[144:145], v[112:113], v[112:113]
    v_pk_mul_f32 v[146:147], v[114:115], v[114:115]
    v_pk_mul_f32 v[148:149], v[116:117], v[116:117]
    v_pk_mul_f32 v[150:151], v[118:119], v[118:119]
    v_pk_mul_f32 v[152:153], v[128:129], v[128:129]
    v_pk_mul_f32 v[154:155], v[130:131], v[130:131]
    v_pk_mul_f32 v[156:157], v[132:133], v[132:133]
    v_pk_mul_f32 v[158:159], v[134:135], v[134:135]
    v_pk_fma_f32 v[144:145], v[144:145], v[178:179], v[176:177]
    v_pk_fma_f32 v[146:147], v[146:147], v[178:179], v[176:177]
    v_pk_fma_f32 v[148:149], v[148:149], v[178:179], v[176:177]
    v_pk_fma_f32 v[150:151], v[150:151], v[178:179], v[176:177]
    v_pk_fma_f32 v[152:153], v[152:153], v[178:179], v[176:177]
    v_pk_fma_f32 v[154:155], v[154:155], v[178:179], v[176:177]
    v_pk_fma_f32 v[156:157], v[156:157], v[178:179], v[176:177]
    v_pk_fma_f32 v[158:159], v[158:159], v[178:179], v[176:177]
    v_pk_mul_f32 v[144:145], v[144:145], v[112:113]
    v_pk_mul_f32 v[146:147], v[146:147], v[114:115]
    v_pk_mul_f32 v[148:149], v[148:149], v[116:117]
    v_pk_mul_f32 v[150:151], v[150:151], v[118:119]
    v_pk_mul_f32 v[152:153], v[152:153], v[128:129]
    v_pk_mul_f32 v[154:155], v[154:155], v[130:131]
    v_pk_mul_f32 v[156:157], v[156:157], v[132:133]
    v_pk_mul_f32 v[158:159], v[158:159], v[134:135]
    v_exp_f32 v144, v144
    v_exp_f32 v145, v145
    v_exp_f32 v146, v146
    v_exp_f32 v147, v147
    v_exp_f32 v148, v148
    v_exp_f32 v149, v149
    v_exp_f32 v150, v150
    v_exp_f32 v151, v151
    v_exp_f32 v152, v152
    v_exp_f32 v153, v153
    v_exp_f32 v154, v154
    v_exp_f32 v155, v155
    v_exp_f32 v156, v156
    v_exp_f32 v157, v157
    v_exp_f32 v158, v158
    v_exp_f32 v159, v159
    v_pk_mul_f32 v[112:113], v[112:113], v[120:121]
    v_pk_mul_f32 v[114:115], v[114:115], v[122:123]
    v_pk_mul_f32 v[116:117], v[116:117], v[124:125]
    v_pk_mul_f32 v[118:119], v[118:119], v[126:127]
    v_pk_mul_f32 v[128:129], v[128:129], v[136:137]
    v_pk_mul_f32 v[130:131], v[130:131], v[138:139]
    v_pk_mul_f32 v[132:133], v[132:133], v[140:141]
    v_pk_mul_f32 v[134:135], v[134:135], v[142:143]
    v_pk_add_f32 v[144:145], v[144:145], v[180:181]
    v_pk_add_f32 v[146:147], v[146:147], v[180:181]
    v_pk_add_f32 v[148:149], v[148:149], v[180:181]
    v_pk_add_f32 v[150:151], v[150:151], v[180:181]
    v_pk_add_f32 v[152:153], v[152:153], v[180:181]
    v_pk_add_f32 v[154:155], v[154:155], v[180:181]
    v_pk_add_f32 v[156:157], v[156:157], v[180:181]
    v_pk_add_f32 v[158:159], v[158:159], v[180:181]
    v_rcp_f32 v144, v144
    v_rcp_f32 v145, v145
    v_rcp_f32 v146, v146
    v_rcp_f32 v147, v147
    v_rcp_f32 v148, v148
    v_rcp_f32 v149, v149
    v_rcp_f32 v150, v150
    v_rcp_f32 v151, v151
    v_rcp_f32 v152, v152
    v_rcp_f32 v153, v153
    v_rcp_f32 v154, v154
    v_rcp_f32 v155, v155
    v_rcp_f32 v156, v156
    v_rcp_f32 v157, v157
    v_rcp_f32 v158, v158
    v_rcp_f32 v159, v159
    s_nop 0
    v_pk_mul_f32 v[112:113], v[112:113], v[144:145]
    v_pk_mul_f32 v[114:115], v[114:115], v[146:147]
    v_pk_mul_f32 v[116:117], v[116:117], v[148:149]
    v_pk_mul_f32 v[118:119], v[118:119], v[150:151]
    v_pk_mul_f32 v[128:129], v[128:129], v[152:153]
    v_pk_mul_f32 v[130:131], v[130:131], v[154:155]
    v_pk_mul_f32 v[132:133], v[132:133], v[156:157]
    v_pk_mul_f32 v[134:135], v[134:135], v[158:159]
    v_cvt_pk_bf16_f32 v200, v112, v113
    v_cvt_pk_bf16_f32 v201, v114, v115
    v_cvt_pk_bf16_f32 v202, v116, v117
    v_cvt_pk_bf16_f32 v203, v118, v119
    v_cvt_pk_bf16_f32 v204, v128, v129
    v_cvt_pk_bf16_f32 v205, v130, v131
    v_cvt_pk_bf16_f32 v206, v132, v133
    v_cvt_pk_bf16_f32 v207, v134, v135
    buffer_store_dwordx4 v[200:203], v250, s[12:15], s40 offen offset:2048 sc1
    buffer_store_dwordx4 v[204:207], v250, s[12:15], s41 offen offset:2048 sc1
C_GEND:
ATT:
    s_barrier
    s_lshl_b32 s32, s24, 10
    s_add_u32 s32, s32, 90112
    v_add_u32 v238, s32, v250
    ds_read_b128 v[80:83], v238
    ds_read_b128 v[84:87], v29
    s_waitcnt lgkmcnt(0)
    s_cmp_ge_u32 s24, 4
    s_cbranch_scc1 A_NOM
    v_mfma_f32_32x32x16_bf16 v[48:63], v[84:87], v[80:83], 0
    s_nop 11
    v_max3_f32 v31, v48, v49, v50
    v_max3_f32 v31, v31, v51, v52
    v_max3_f32 v31, v31, v53, v54
    v_max3_f32 v31, v31, v55, v56
    v_max3_f32 v31, v31, v57, v58
    v_max3_f32 v31, v31, v59, v60
    v_max3_f32 v31, v31, v61, v62
    v_max_f32 v31, v31, v63
    v_mov_b32 v238, v31
    s_nop 1
    v_permlane32_swap_b32 v238, v31
    s_nop 1
    v_max_f32 v31, v31, v238
    v_sub_f32 v64, 0, v31
    v_sub_f32 v65, 0, v31
    v_sub_f32 v66, 0, v31
    v_sub_f32 v67, 0, v31
    v_sub_f32 v68, 0, v31
    v_sub_f32 v69, 0, v31
    v_sub_f32 v70, 0, v31
    v_sub_f32 v71, 0, v31
    v_sub_f32 v72, 0, v31
    v_sub_f32 v73, 0, v31
    v_sub_f32 v74, 0, v31
    v_sub_f32 v75, 0, v31
    v_sub_f32 v76, 0, v31
    v_sub_f32 v77, 0, v31
    v_sub_f32 v78, 0, v31
    v_sub_f32 v79, 0, v31
    s_nop 1
A_NOM:
    v_mfma_f32_32x32x16_bf16 v[48:63], v[84:87], v[80:83], v[64:79]
    ds_read_b128 v[84:87], v29 offset:2048
    s_mov_b64 exec, s[4:5]
    ds_read_b128 v[16:19], v30 offset:1024
    ds_read_b128 v[20:23], v30 offset:1536
    s_mov_b64 exec, -1
    s_nop 6
    v_exp_f32 v48, v48
    v_exp_f32 v49, v49
    v_smfmac_f32_32x32x32_bf16 v[0:15], v[24:27], v[40:47], v28
    s_setprio 3
    v_exp_f32 v50, v50
    v_exp_f32 v51, v51
    v_exp_f32 v52, v52
    s_waitcnt lgkmcnt(2)
    v_mfma_f32_32x32x16_bf16 v[32:47], v[84:87], v[80:83], v[64:79]
    ds_read_b128 v[84:87], v29 offset:4096
    v_exp_f32 v53, v53
    v_exp_f32 v54, v54
    v_exp_f32 v55, v55
    s_cmp_lt_u32 s24, 4
    s_cbranch_scc1 A_R0
    s_lshl_b32 s34, s36, 1
    s_add_u32 m0, s34, 131072
    s_add_u32 s33, s64, 8192
    buffer_load_dwordx4 v170, s[44:47], s64 offen lds
    s_add_u32 m0, s34, 132096
    s_nop 0
    buffer_load_dwordx4 v170, s[44:47], s33 offen lds
A_R0:
    v_exp_f32 v56, v56
    v_exp_f32 v57, v57
    s_waitcnt lgkmcnt(1)
    v_smfmac_f32_32x32x32_bf16 v[0:15], v[16:19], v[48:55], v28
    s_mov_b64 exec, s[4:5]
    ds_read_b128 v[16:19], v30 offset:3072
    ds_read_b128 v[24:27], v30 offset:3584
    s_mov_b64 exec, -1
    v_exp_f32 v58, v58
    v_exp_f32 v59, v59
    v_exp_f32 v60, v60
    v_exp_f32 v61, v61
    v_exp_f32 v62, v62
    v_exp_f32 v63, v63
    v_exp_f32 v32, v32
    v_exp_f32 v33, v33
    v_smfmac_f32_32x32x32_bf16 v[0:15], v[20:23], v[56:63], v28
    s_setprio 2
    v_exp_f32 v34, v34
    v_exp_f32 v35, v35
    v_exp_f32 v36, v36
    s_waitcnt lgkmcnt(2)
    v_mfma_f32_32x32x16_bf16 v[48:63], v[84:87], v[80:83], v[64:79]
    ds_read_b128 v[84:87], v29 offset:6144
    v_exp_f32 v37, v37
    v_exp_f32 v38, v38
    v_exp_f32 v39, v39
    v_exp_f32 v40, v40
    v_exp_f32 v41, v41
    s_waitcnt lgkmcnt(1)
    v_smfmac_f32_32x32x32_bf16 v[0:15], v[16:19], v[32:39], v28
    s_mov_b64 exec, s[4:5]
    ds_read_b128 v[16:19], v30 offset:5120
    ds_read_b128 v[20:23], v30 offset:5632
    s_mov_b64 exec, -1
    v_exp_f32 v42, v42
    v_exp_f32 v43, v43
    v_exp_f32 v44, v44
    v_exp_f32 v45, v45
    v_exp_f32 v46, v46
    v_exp_f32 v47, v47
    v_exp_f32 v48, v48
    v_exp_f32 v49, v49
    v_smfmac_f32_32x32x32_bf16 v[0:15], v[24:27], v[40:47], v28
    s_setprio 1
    v_exp_f32 v50, v50
    v_exp_f32 v51, v51
    v_exp_f32 v52, v52
    s_waitcnt lgkmcnt(2)
    v_mfma_f32_32x32x16_bf16 v[32:47], v[84:87], v[80:83], v[64:79]
    ds_read_b128 v[84:87], v29 offset:8192
    v_exp_f32 v53, v53
    v_exp_f32 v54, v54
    v_exp_f32 v55, v55
    v_exp_f32 v56, v56
    v_exp_f32 v57, v57
    s_waitcnt lgkmcnt(1)
    v_smfmac_f32_32x32x32_bf16 v[0:15], v[16:19], v[48:55], v28
    s_mov_b64 exec, s[4:5]
    ds_read_b128 v[16:19], v30 offset:7168
    ds_read_b128 v[24:27], v30 offset:7680
    s_mov_b64 exec, -1
    v_exp_f32 v58, v58
    v_exp_f32 v59, v59
    v_exp_f32 v60, v60
    v_exp_f32 v61, v61
    v_exp_f32 v62, v62
    v_exp_f32 v63, v63
    v_exp_f32 v32, v32
    v_exp_f32 v33, v33
    v_smfmac_f32_32x32x32_bf16 v[0:15], v[20:23], v[56:63], v28
    s_setprio 0
    v_exp_f32 v34, v34
    v_exp_f32 v35, v35
    v_exp_f32 v36, v36
    s_waitcnt lgkmcnt(2)
    v_mfma_f32_32x32x16_bf16 v[48:63], v[84:87], v[80:83], v[64:79]
    ds_read_b128 v[84:87], v29 offset:10240
    v_exp_f32 v37, v37
    v_exp_f32 v38, v38
    v_exp_f32 v39, v39
    v_exp_f32 v40, v40
    v_exp_f32 v41, v41
    s_waitcnt lgkmcnt(1)
    v_smfmac_f32_32x32x32_bf16 v[0:15], v[16:19], v[32:39], v28
    s_mov_b64 exec, s[4:5]
    ds_read_b128 v[16:19], v30 offset:9216
    ds_read_b128 v[20:23], v30 offset:9728
    s_mov_b64 exec, -1
    v_exp_f32 v42, v42
    v_exp_f32 v43, v43
    v_exp_f32 v44, v44
    v_exp_f32 v45, v45
    v_exp_f32 v46, v46
    v_exp_f32 v47, v47
    s_lshl_b32 s70, s24, 11
    s_add_u32 s70, s70, 49152
    s_add_u32 s67, s67, s70
    s_add_u32 m0, s70, 0
    s_add_u32 s32, s67, 0
    buffer_load_dwordx4 v250, s[12:15], s32 offen lds
    v_exp_f32 v48, v48
    v_exp_f32 v49, v49
    v_smfmac_f32_32x32x32_bf16 v[0:15], v[24:27], v[40:47], v28
    s_setprio 3
    v_exp_f32 v50, v50
    v_exp_f32 v51, v51
    v_exp_f32 v52, v52
    s_waitcnt lgkmcnt(2)
    v_mfma_f32_32x32x16_bf16 v[32:47], v[84:87], v[80:83], v[64:79]
    ds_read_b128 v[84:87], v29 offset:12288
    v_exp_f32 v53, v53
    v_exp_f32 v54, v54
    s_add_u32 m0, s70, 1024
    s_add_u32 s32, s67, 1024
    buffer_load_dwordx4 v250, s[12:15], s32 offen lds
    v_exp_f32 v55, v55
    v_exp_f32 v56, v56
    v_exp_f32 v57, v57
    s_waitcnt lgkmcnt(1)
    v_smfmac_f32_32x32x32_bf16 v[0:15], v[16:19], v[48:55], v28
    s_mov_b64 exec, s[4:5]
    ds_read_b128 v[16:19], v30 offset:11264
    ds_read_b128 v[24:27], v30 offset:11776
    s_mov_b64 exec, -1
    v_exp_f32 v58, v58
    v_exp_f32 v59, v59
    v_exp_f32 v60, v60
    s_add_u32 m0, s70, 16384
    s_add_u32 s32, s67, 16384
    buffer_load_dwordx4 v250, s[12:15], s32 offen lds
    v_exp_f32 v61, v61
    v_exp_f32 v62, v62
    v_exp_f32 v63, v63
    s_add_u32 m0, s70, 17408
    s_add_u32 s32, s67, 17408
    buffer_load_dwordx4 v250, s[12:15], s32 offen lds
    v_exp_f32 v32, v32
    v_exp_f32 v33, v33
    v_smfmac_f32_32x32x32_bf16 v[0:15], v[20:23], v[56:63], v28
    s_setprio 2
    v_exp_f32 v34, v34
    v_exp_f32 v35, v35
    v_exp_f32 v36, v36
    s_waitcnt lgkmcnt(2)
    v_mfma_f32_32x32x16_bf16 v[48:63], v[84:87], v[80:83], v[64:79]
    ds_read_b128 v[84:87], v29 offset:14336
    v_exp_f32 v37, v37
    v_exp_f32 v38, v38
    s_cmp_ge_u32 s24, 4
    s_cbranch_scc1 A_KD4
    s_add_u32 m0, s70, 32768
    s_add_u32 s32, s67, 32768
    buffer_load_dwordx4 v250, s[12:15], s32 offen lds
A_KD4:
    v_exp_f32 v39, v39
    v_exp_f32 v40, v40
    v_exp_f32 v41, v41
    s_waitcnt lgkmcnt(1)
    v_smfmac_f32_32x32x32_bf16 v[0:15], v[16:19], v[32:39], v28
    s_mov_b64 exec, s[4:5]
    ds_read_b128 v[16:19], v30 offset:13312
    ds_read_b128 v[20:23], v30 offset:13824
    s_mov_b64 exec, -1
    v_exp_f32 v42, v42
    v_exp_f32 v43, v43
    v_exp_f32 v44, v44
    s_cmp_ge_u32 s24, 4
    s_cbranch_scc1 A_KD5
    s_add_u32 m0, s70, 33792
    s_add_u32 s32, s67, 33792
    buffer_load_dwordx4 v250, s[12:15], s32 offen lds
A_KD5:
    v_exp_f32 v45, v45
    v_exp_f32 v46, v46
    v_exp_f32 v47, v47
    s_add_u32 m0, s70, 49152
    s_add_u32 s32, s67, 49152
    buffer_load_dwordx4 v250, s[12:15], s32 offen lds
    v_exp_f32 v48, v48
    v_exp_f32 v49, v49
    v_smfmac_f32_32x32x32_bf16 v[0:15], v[24:27], v[40:47], v28
    s_setprio 1
    v_exp_f32 v50, v50
    v_exp_f32 v51, v51
    v_exp_f32 v52, v52
    s_waitcnt lgkmcnt(2)
    v_mfma_f32_32x32x16_bf16 v[32:47], v[84:87], v[80:83], v[64:79]
    ds_read_b128 v[84:87], v29 offset:16384
    v_exp_f32 v53, v53
    v_exp_f32 v54, v54
    s_add_u32 m0, s70, 50176
    s_add_u32 s32, s67, 50176
    buffer_load_dwordx4 v250, s[12:15], s32 offen lds
    v_exp_f32 v55, v55
    v_exp_f32 v56, v56
    v_exp_f32 v57, v57
    s_waitcnt lgkmcnt(1)
    v_smfmac_f32_32x32x32_bf16 v[0:15], v[16:19], v[48:55], v28
    s_mov_b64 exec, s[4:5]
    ds_read_b128 v[16:19], v30 offset:15360
    ds_read_b128 v[24:27], v30 offset:15872
    s_mov_b64 exec, -1
    v_exp_f32 v58, v58
    v_exp_f32 v59, v59
    v_exp_f32 v60, v60
    s_add_u32 m0, s70, 65536
    s_add_u32 s32, s67, 65536
    buffer_load_dwordx4 v250, s[12:15], s32 offen lds
    v_exp_f32 v61, v61
    v_exp_f32 v62, v62
    v_exp_f32 v63, v63
    s_add_u32 m0, s70, 66560
    s_add_u32 s32, s67, 66560
    buffer_load_dwordx4 v250, s[12:15], s32 offen lds
    v_exp_f32 v32, v32
    v_exp_f32 v33, v33
    v_smfmac_f32_32x32x32_bf16 v[0:15], v[20:23], v[56:63], v28
    s_setprio 0
    v_exp_f32 v34, v34
    v_exp_f32 v35, v35
    v_exp_f32 v36, v36
    s_waitcnt lgkmcnt(2)
    v_mfma_f32_32x32x16_bf16 v[48:63], v[84:87], v[80:83], v[64:79]
    ds_read_b128 v[84:87], v29 offset:18432
    v_exp_f32 v37, v37
    v_exp_f32 v38, v38
    v_exp_f32 v39, v39
    v_exp_f32 v40, v40
    v_exp_f32 v41, v41
    s_waitcnt lgkmcnt(1)
    v_smfmac_f32_32x32x32_bf16 v[0:15], v[16:19], v[32:39], v28
    s_mov_b64 exec, s[4:5]
    ds_read_b128 v[16:19], v30 offset:17408
    ds_read_b128 v[20:23], v30 offset:17920
    s_mov_b64 exec, -1
    v_exp_f32 v42, v42
    v_exp_f32 v43, v43
    v_exp_f32 v44, v44
    v_exp_f32 v45, v45
    v_exp_f32 v46, v46
    v_exp_f32 v47, v47
    s_cmp_lt_u32 s24, 4
    s_cbranch_scc1 A_R1
    s_waitcnt vmcnt(8)
    ds_read_b64_tr_b16 v[144:145], v171 offset:0
    ds_read_b64_tr_b16 v[146:147], v171 offset:1024
    ds_read_b64_tr_b16 v[148:149], v171 offset:256
    ds_read_b64_tr_b16 v[150:151], v171 offset:1280
    s_waitcnt lgkmcnt(0)
    buffer_store_dwordx4 v[144:147], v250, s[12:15], s65 offen sc1
    buffer_store_dwordx4 v[148:151], v250, s[12:15], s66 offen sc1
    buffer_store_dword v188, v189, s[12:15], s38 offen sc1
A_R1:
    v_exp_f32 v48, v48
    v_exp_f32 v49, v49
    v_smfmac_f32_32x32x32_bf16 v[0:15], v[24:27], v[40:47], v28
    s_setprio 3
    v_exp_f32 v50, v50
    v_exp_f32 v51, v51
    v_exp_f32 v52, v52
    s_waitcnt lgkmcnt(2)
    v_mfma_f32_32x32x16_bf16 v[32:47], v[84:87], v[80:83], v[64:79]
    ds_read_b128 v[84:87], v29 offset:20480
    v_exp_f32 v53, v53
    v_exp_f32 v54, v54
    v_exp_f32 v55, v55
    v_exp_f32 v56, v56
    v_exp_f32 v57, v57
    s_waitcnt lgkmcnt(1)
    v_smfmac_f32_32x32x32_bf16 v[0:15], v[16:19], v[48:55], v28
    s_mov_b64 exec, s[4:5]
    ds_read_b128 v[16:19], v30 offset:19456
    ds_read_b128 v[24:27], v30 offset:19968
    s_mov_b64 exec, -1
    v_exp_f32 v58, v58
    v_exp_f32 v59, v59
    v_exp_f32 v60, v60
    v_exp_f32 v61, v61
    v_exp_f32 v62, v62
    v_exp_f32 v63, v63
    v_exp_f32 v32, v32
    v_exp_f32 v33, v33
    v_smfmac_f32_32x32x32_bf16 v[0:15], v[20:23], v[56:63], v28
    s_setprio 2
    v_exp_f32 v34, v34
    v_exp_f32 v35, v35
    v_exp_f32 v36, v36
    s_waitcnt lgkmcnt(2)
    v_mfma_f32_32x32x16_bf16 v[48:63], v[84:87], v[80:83], v[64:79]
    ds_read_b128 v[84:87], v29 offset:22528
    v_exp_f32 v37, v37
    v_exp_f32 v38, v38
    v_exp_f32 v39, v39
    v_exp_f32 v40, v40
    v_exp_f32 v41, v41
    s_waitcnt lgkmcnt(1)
    v_smfmac_f32_32x32x32_bf16 v[0:15], v[16:19], v[32:39], v28
    s_mov_b64 exec, s[4:5]
    ds_read_b128 v[16:19], v30 offset:21504
    ds_read_b128 v[20:23], v30 offset:22016
    s_mov_b64 exec, -1
    v_exp_f32 v42, v42
    v_exp_f32 v43, v43
    v_exp_f32 v44, v44
    v_exp_f32 v45, v45
    v_exp_f32 v46, v46
    v_exp_f32 v47, v47
    v_exp_f32 v48, v48
    v_exp_f32 v49, v49
    v_smfmac_f32_32x32x32_bf16 v[0:15], v[24:27], v[40:47], v28
    s_setprio 1
    v_exp_f32 v50, v50
    v_exp_f32 v51, v51
    v_exp_f32 v52, v52
    s_waitcnt lgkmcnt(2)
    v_mfma_f32_32x32x16_bf16 v[32:47], v[84:87], v[80:83], v[64:79]
    ds_read_b128 v[84:87], v29 offset:24576
    v_exp_f32 v53, v53
    v_exp_f32 v54, v54
    v_exp_f32 v55, v55
    v_exp_f32 v56, v56
    v_exp_f32 v57, v57
    s_waitcnt lgkmcnt(1)
    v_smfmac_f32_32x32x32_bf16 v[0:15], v[16:19], v[48:55], v28
    s_mov_b64 exec, s[4:5]
    ds_read_b128 v[16:19], v30 offset:23552
    ds_read_b128 v[24:27], v30 offset:24064
    s_mov_b64 exec, -1
    v_exp_f32 v58, v58
    v_exp_f32 v59, v59
    v_exp_f32 v60, v60
    v_exp_f32 v61, v61
    v_exp_f32 v62, v62
    v_exp_f32 v63, v63
    v_exp_f32 v32, v32
    v_exp_f32 v33, v33
    v_smfmac_f32_32x32x32_bf16 v[0:15], v[20:23], v[56:63], v28
    s_setprio 0
    v_exp_f32 v34, v34
    v_exp_f32 v35, v35
    v_exp_f32 v36, v36
    s_waitcnt lgkmcnt(2)
    v_mfma_f32_32x32x16_bf16 v[48:63], v[84:87], v[80:83], v[64:79]
    ds_read_b128 v[84:87], v29 offset:26624
    v_exp_f32 v37, v37
    v_exp_f32 v38, v38
    v_exp_f32 v39, v39
    v_exp_f32 v40, v40
    v_exp_f32 v41, v41
    s_waitcnt lgkmcnt(1)
    v_smfmac_f32_32x32x32_bf16 v[0:15], v[16:19], v[32:39], v28
    s_mov_b64 exec, s[4:5]
    ds_read_b128 v[16:19], v30 offset:25600
    ds_read_b128 v[20:23], v30 offset:26112
    s_mov_b64 exec, -1
    v_exp_f32 v42, v42
    v_exp_f32 v43, v43
    v_exp_f32 v44, v44
    v_exp_f32 v45, v45
    v_exp_f32 v46, v46
    v_exp_f32 v47, v47
    s_waitcnt vmcnt(0)
    s_barrier
    s_cmp_lg_u32 s24, 0
    s_cbranch_scc1 A_NOFB
    s_mov_b32 s32, 22151168
    buffer_store_dwordx2 v[236:237], v248, s[12:15], s32 offen sc1
A_NOFB:
    v_exp_f32 v48, v48
    v_exp_f32 v49, v49
    v_smfmac_f32_32x32x32_bf16 v[0:15], v[24:27], v[40:47], v28
    s_setprio 3
    v_exp_f32 v50, v50
    v_exp_f32 v51, v51
    v_exp_f32 v52, v52
    s_waitcnt lgkmcnt(2)
    v_mfma_f32_32x32x16_bf16 v[32:47], v[84:87], v[80:83], v[64:79]
    ds_read_b128 v[84:87], v29 offset:28672
    v_exp_f32 v53, v53
    v_exp_f32 v54, v54
    s_cmp_lt_u32 s24, 4
    s_cbranch_scc1 A_KD
    s_add_u32 m0, s70, 32768
    s_add_u32 s32, s67, 32768
    buffer_load_dwordx4 v250, s[12:15], s32 offen lds
    s_add_u32 m0, s70, 33792
    s_add_u32 s32, s67, 33792
    buffer_load_dwordx4 v250, s[12:15], s32 offen lds
A_KD:
    v_exp_f32 v55, v55
    v_exp_f32 v56, v56
    v_exp_f32 v57, v57
    s_waitcnt lgkmcnt(1)
    v_smfmac_f32_32x32x32_bf16 v[0:15], v[16:19], v[48:55], v28
    s_mov_b64 exec, s[4:5]
    ds_read_b128 v[16:19], v30 offset:27648
    ds_read_b128 v[24:27], v30 offset:28160
    s_mov_b64 exec, -1
    v_exp_f32 v58, v58
    v_exp_f32 v59, v59
    v_exp_f32 v60, v60
    v_exp_f32 v61, v61
    v_exp_f32 v62, v62
    v_exp_f32 v63, v63
    v_exp_f32 v32, v32
    v_exp_f32 v33, v33
    v_smfmac_f32_32x32x32_bf16 v[0:15], v[20:23], v[56:63], v28
    s_setprio 2
    v_exp_f32 v34, v34
    v_exp_f32 v35, v35
    v_exp_f32 v36, v36
    s_waitcnt lgkmcnt(2)
    v_mfma_f32_32x32x16_bf16 v[48:63], v[84:87], v[80:83], v[64:79]
    ds_read_b128 v[84:87], v29 offset:30720
    v_exp_f32 v37, v37
    v_exp_f32 v38, v38
    v_exp_f32 v39, v39
    v_exp_f32 v40, v40
    v_exp_f32 v41, v41
    s_waitcnt lgkmcnt(1)
    v_smfmac_f32_32x32x32_bf16 v[0:15], v[16:19], v[32:39], v28
    s_mov_b64 exec, s[4:5]
    ds_read_b128 v[16:19], v30 offset:29696
    ds_read_b128 v[20:23], v30 offset:30208
    s_mov_b64 exec, -1
    v_exp_f32 v42, v42
    v_exp_f32 v43, v43
    v_exp_f32 v44, v44
    v_exp_f32 v45, v45
    v_exp_f32 v46, v46
    v_exp_f32 v47, v47
    v_exp_f32 v48, v48
    v_exp_f32 v49, v49
    v_smfmac_f32_32x32x32_bf16 v[0:15], v[24:27], v[40:47], v28
    s_setprio 1
    v_exp_f32 v50, v50
    v_exp_f32 v51, v51
    v_exp_f32 v52, v52
    s_waitcnt lgkmcnt(2)
    v_mfma_f32_32x32x16_bf16 v[32:47], v[84:87], v[80:83], v[64:79]
    ds_read_b128 v[84:87], v29 offset:32768
    v_exp_f32 v53, v53
    v_exp_f32 v54, v54
    v_exp_f32 v55, v55
    v_exp_f32 v56, v56
    v_exp_f32 v57, v57
    s_waitcnt lgkmcnt(1)
    v_smfmac_f32_32x32x32_bf16 v[0:15], v[16:19], v[48:55], v28
    s_mov_b64 exec, s[4:5]
    ds_read_b128 v[16:19], v30 offset:31744
    ds_read_b128 v[24:27], v30 offset:32256
    s_mov_b64 exec, -1
    v_exp_f32 v58, v58
    v_exp_f32 v59, v59
    v_exp_f32 v60, v60
    v_exp_f32 v61, v61
    v_exp_f32 v62, v62
    v_exp_f32 v63, v63
    v_exp_f32 v32, v32
    v_exp_f32 v33, v33
    v_smfmac_f32_32x32x32_bf16 v[0:15], v[20:23], v[56:63], v28
    s_setprio 0
    v_exp_f32 v34, v34
    v_exp_f32 v35, v35
    v_exp_f32 v36, v36
    s_waitcnt lgkmcnt(2)
    v_mfma_f32_32x32x16_bf16 v[48:63], v[84:87], v[80:83], v[64:79]
    ds_read_b128 v[84:87], v29 offset:34816
    v_exp_f32 v37, v37
    v_exp_f32 v38, v38
    v_exp_f32 v39, v39
    v_exp_f32 v40, v40
    v_exp_f32 v41, v41
    s_waitcnt lgkmcnt(1)
    v_smfmac_f32_32x32x32_bf16 v[0:15], v[16:19], v[32:39], v28
    s_mov_b64 exec, s[4:5]
    ds_read_b128 v[16:19], v30 offset:33792
    ds_read_b128 v[20:23], v30 offset:34304
    s_mov_b64 exec, -1
    v_exp_f32 v42, v42
    v_exp_f32 v43, v43
    v_exp_f32 v44, v44
    v_exp_f32 v45, v45
    v_exp_f32 v46, v46
    v_exp_f32 v47, v47
    v_exp_f32 v48, v48
    v_exp_f32 v49, v49
    v_smfmac_f32_32x32x32_bf16 v[0:15], v[24:27], v[40:47], v28
    s_setprio 3
    v_exp_f32 v50, v50
    v_exp_f32 v51, v51
    v_exp_f32 v52, v52
    s_waitcnt lgkmcnt(2)
    v_mfma_f32_32x32x16_bf16 v[32:47], v[84:87], v[80:83], v[64:79]
    ds_read_b128 v[84:87], v29 offset:36864
    v_exp_f32 v53, v53
    v_exp_f32 v54, v54
    v_exp_f32 v55, v55
    v_exp_f32 v56, v56
    v_exp_f32 v57, v57
    s_waitcnt lgkmcnt(1)
    v_smfmac_f32_32x32x32_bf16 v[0:15], v[16:19], v[48:55], v28
    s_mov_b64 exec, s[4:5]
    ds_read_b128 v[16:19], v30 offset:35840
    ds_read_b128 v[24:27], v30 offset:36352
    s_mov_b64 exec, -1
    v_exp_f32 v58, v58
    v_exp_f32 v59, v59
    v_exp_f32 v60, v60
    v_exp_f32 v61, v61
    v_exp_f32 v62, v62
    v_exp_f32 v63, v63
    v_exp_f32 v32, v32
    v_exp_f32 v33, v33
    v_smfmac_f32_32x32x32_bf16 v[0:15], v[20:23], v[56:63], v28
    s_setprio 2
    v_exp_f32 v34, v34
    v_exp_f32 v35, v35
    v_exp_f32 v36, v36
    s_waitcnt lgkmcnt(2)
    v_mfma_f32_32x32x16_bf16 v[48:63], v[84:87], v[80:83], v[64:79]
    ds_read_b128 v[84:87], v29 offset:38912
    v_exp_f32 v37, v37
    v_exp_f32 v38, v38
    v_exp_f32 v39, v39
    v_exp_f32 v40, v40
    v_exp_f32 v41, v41
    s_waitcnt lgkmcnt(1)
    v_smfmac_f32_32x32x32_bf16 v[0:15], v[16:19], v[32:39], v28
    s_mov_b64 exec, s[4:5]
    ds_read_b128 v[16:19], v30 offset:37888
    ds_read_b128 v[20:23], v30 offset:38400
    s_mov_b64 exec, -1
    v_exp_f32 v42, v42
    v_exp_f32 v43, v43
    v_exp_f32 v44, v44
    v_exp_f32 v45, v45
    v_exp_f32 v46, v46
    v_exp_f32 v47, v47
    s_mov_b32 s34, 22151168
    s_cmp_lg_u32 s24, 1
    s_cbranch_scc1 A_NOP1
    buffer_load_dwordx2 v[224:225], v232, s[12:15], s34 offen sc1
    buffer_load_dwordx2 v[226:227], v233, s[12:15], s34 offen sc1
A_NOP1:
    v_exp_f32 v48, v48
    v_exp_f32 v49, v49
    v_smfmac_f32_32x32x32_bf16 v[0:15], v[24:27], v[40:47], v28
    s_setprio 1
    v_exp_f32 v50, v50
    v_exp_f32 v51, v51
    v_exp_f32 v52, v52
    s_waitcnt lgkmcnt(2)
    v_mfma_f32_32x32x16_bf16 v[32:47], v[84:87], v[80:83], v[64:79]
    ds_read_b128 v[84:87], v29 offset:40960
    v_exp_f32 v53, v53
    v_exp_f32 v54, v54
    v_exp_f32 v55, v55
    v_exp_f32 v56, v56
    v_exp_f32 v57, v57
    s_waitcnt lgkmcnt(1)
    v_smfmac_f32_32x32x32_bf16 v[0:15], v[16:19], v[48:55], v28
    s_mov_b64 exec, s[4:5]
    ds_read_b128 v[16:19], v30 offset:39936
    ds_read_b128 v[24:27], v30 offset:40448
    s_mov_b64 exec, -1
    v_exp_f32 v58, v58
    v_exp_f32 v59, v59
    v_exp_f32 v60, v60
    v_exp_f32 v61, v61
    v_exp_f32 v62, v62
    v_exp_f32 v63, v63
    v_exp_f32 v32, v32
    v_exp_f32 v33, v33
    v_smfmac_f32_32x32x32_bf16 v[0:15], v[20:23], v[56:63], v28
    s_setprio 0
    v_exp_f32 v34, v34
    v_exp_f32 v35, v35
    v_exp_f32 v36, v36
    s_waitcnt lgkmcnt(2)
    v_mfma_f32_32x32x16_bf16 v[48:63], v[84:87], v[80:83], v[64:79]
    ds_read_b128 v[84:87], v29 offset:43008
    v_exp_f32 v37, v37
    v_exp_f32 v38, v38
    v_exp_f32 v39, v39
    v_exp_f32 v40, v40
    v_exp_f32 v41, v41
    s_waitcnt lgkmcnt(1)
    v_smfmac_f32_32x32x32_bf16 v[0:15], v[16:19], v[32:39], v28
    s_mov_b64 exec, s[4:5]
    ds_read_b128 v[16:19], v30 offset:41984
    ds_read_b128 v[20:23], v30 offset:42496
    s_mov_b64 exec, -1
    v_exp_f32 v42, v42
    v_exp_f32 v43, v43
    v_exp_f32 v44, v44
    v_exp_f32 v45, v45
    v_exp_f32 v46, v46
    v_exp_f32 v47, v47
    v_exp_f32 v48, v48
    v_exp_f32 v49, v49
    v_smfmac_f32_32x32x32_bf16 v[0:15], v[24:27], v[40:47], v28
    s_setprio 3
    v_exp_f32 v50, v50
    v_exp_f32 v51, v51
    v_exp_f32 v52, v52
    s_waitcnt lgkmcnt(2)
    v_mfma_f32_32x32x16_bf16 v[32:47], v[84:87], v[80:83], v[64:79]
    ds_read_b128 v[84:87], v29 offset:45056
    v_exp_f32 v53, v53
    v_exp_f32 v54, v54
    v_exp_f32 v55, v55
    v_exp_f32 v56, v56
    v_exp_f32 v57, v57
    s_waitcnt lgkmcnt(1)
    v_smfmac_f32_32x32x32_bf16 v[0:15], v[16:19], v[48:55], v28
    s_mov_b64 exec, s[4:5]
    ds_read_b128 v[16:19], v30 offset:44032
    ds_read_b128 v[24:27], v30 offset:44544
    s_mov_b64 exec, -1
    v_exp_f32 v58, v58
    v_exp_f32 v59, v59
    v_exp_f32 v60, v60
    v_exp_f32 v61, v61
    v_exp_f32 v62, v62
    v_exp_f32 v63, v63
    v_exp_f32 v32, v32
    v_exp_f32 v33, v33
    v_smfmac_f32_32x32x32_bf16 v[0:15], v[20:23], v[56:63], v28
    s_setprio 2
    v_exp_f32 v34, v34
    v_exp_f32 v35, v35
    v_exp_f32 v36, v36
    s_waitcnt lgkmcnt(2)
    v_mfma_f32_32x32x16_bf16 v[48:63], v[84:87], v[80:83], v[64:79]
    ds_read_b128 v[84:87], v29 offset:47104
    v_exp_f32 v37, v37
    v_exp_f32 v38, v38
    v_exp_f32 v39, v39
    v_exp_f32 v40, v40
    v_exp_f32 v41, v41
    s_waitcnt lgkmcnt(1)
    v_smfmac_f32_32x32x32_bf16 v[0:15], v[16:19], v[32:39], v28
    s_mov_b64 exec, s[4:5]
    ds_read_b128 v[16:19], v30 offset:46080
    ds_read_b128 v[20:23], v30 offset:46592
    s_mov_b64 exec, -1
    v_exp_f32 v42, v42
    v_exp_f32 v43, v43
    v_exp_f32 v44, v44
    v_exp_f32 v45, v45
    v_exp_f32 v46, v46
    v_exp_f32 v47, v47
    v_exp_f32 v48, v48
    v_exp_f32 v49, v49
    v_smfmac_f32_32x32x32_bf16 v[0:15], v[24:27], v[40:47], v28
    s_setprio 1
    v_exp_f32 v50, v50
    v_exp_f32 v51, v51
    v_exp_f32 v52, v52
    s_waitcnt lgkmcnt(2)
    v_mfma_f32_32x32x16_bf16 v[32:47], v[84:87], v[80:83], v[64:79]
    ds_read_b128 v[84:87], v29 offset:49152
    v_exp_f32 v53, v53
    v_exp_f32 v54, v54
    v_exp_f32 v55, v55
    v_exp_f32 v56, v56
    v_exp_f32 v57, v57
    s_waitcnt lgkmcnt(1)
    v_smfmac_f32_32x32x32_bf16 v[0:15], v[16:19], v[48:55], v28
    s_mov_b64 exec, s[4:5]
    ds_read_b128 v[16:19], v30 offset:48128
    ds_read_b128 v[24:27], v30 offset:48640
    s_mov_b64 exec, -1
    v_exp_f32 v58, v58
    v_exp_f32 v59, v59
    v_exp_f32 v60, v60
    v_exp_f32 v61, v61
    v_exp_f32 v62, v62
    v_exp_f32 v63, v63
    v_exp_f32 v32, v32
    v_exp_f32 v33, v33
    v_smfmac_f32_32x32x32_bf16 v[0:15], v[20:23], v[56:63], v28
    s_setprio 0
    v_exp_f32 v34, v34
    v_exp_f32 v35, v35
    v_exp_f32 v36, v36
    s_waitcnt lgkmcnt(2)
    v_mfma_f32_32x32x16_bf16 v[48:63], v[84:87], v[80:83], v[64:79]
    ds_read_b128 v[84:87], v29 offset:51200
    v_exp_f32 v37, v37
    v_exp_f32 v38, v38
    v_exp_f32 v39, v39
    v_exp_f32 v40, v40
    v_exp_f32 v41, v41
    s_waitcnt lgkmcnt(1)
    v_smfmac_f32_32x32x32_bf16 v[0:15], v[16:19], v[32:39], v28
    s_mov_b64 exec, s[4:5]
    ds_read_b128 v[16:19], v30 offset:50176
    ds_read_b128 v[20:23], v30 offset:50688
    s_mov_b64 exec, -1
    v_exp_f32 v42, v42
    v_exp_f32 v43, v43
    v_exp_f32 v44, v44
    v_exp_f32 v45, v45
    v_exp_f32 v46, v46
    v_exp_f32 v47, v47
    s_cmp_lg_u32 s24, 1
    s_cbranch_scc1 A_B4
    s_mov_b32 s68, 20000
A_PB:
    s_waitcnt vmcnt(0)
    v_cmp_ne_u64 s[32:33], v[224:225], v[236:237]
    v_cmp_ne_u64 vcc, v[226:227], v[236:237]
    s_nop 1
    s_or_b64 vcc, vcc, s[32:33]
    s_cbranch_scc0 A_B4
    buffer_load_dwordx2 v[224:225], v232, s[12:15], s34 offen sc1
    buffer_load_dwordx2 v[226:227], v233, s[12:15], s34 offen sc1
    s_sub_u32 s68, s68, 1
    s_cmp_lg_u32 s68, 0
    s_cbranch_scc1 A_PB
A_B4:
    s_waitcnt vmcnt(0)
    s_barrier
    buffer_load_dword v228, v234, s[12:15], s62 offen
    s_lshl_b32 s32, s31, 3
    s_add_u32 s32, s32, s24
    s_lshl_b32 s32, s32, 9
    s_add_u32 s32, s32, 20971520
    buffer_load_dword v229, v234, s[12:15], s32 offen
    v_exp_f32 v48, v48
    v_exp_f32 v49, v49
    v_smfmac_f32_32x32x32_bf16 v[0:15], v[24:27], v[40:47], v28
    s_setprio 3
    v_exp_f32 v50, v50
    v_exp_f32 v51, v51
    v_exp_f32 v52, v52
    s_waitcnt lgkmcnt(2)
    v_mfma_f32_32x32x16_bf16 v[32:47], v[84:87], v[80:83], v[64:79]
    ds_read_b128 v[84:87], v29 offset:53248
    v_exp_f32 v53, v53
    v_exp_f32 v54, v54
    v_exp_f32 v55, v55
    buffer_load_dwordx4 v[124:127], v250, s[12:15], s6 offen offset:0
    v_exp_f32 v56, v56
    v_exp_f32 v57, v57
    s_waitcnt lgkmcnt(1)
    v_smfmac_f32_32x32x32_bf16 v[0:15], v[16:19], v[48:55], v28
    s_mov_b64 exec, s[4:5]
    ds_read_b128 v[16:19], v30 offset:52224
    ds_read_b128 v[24:27], v30 offset:52736
    s_mov_b64 exec, -1
    v_exp_f32 v58, v58
    v_exp_f32 v59, v59
    v_exp_f32 v60, v60
    buffer_load_dwordx4 v[128:131], v250, s[12:15], s69 offen offset:0
    v_exp_f32 v61, v61
    v_exp_f32 v62, v62
    v_exp_f32 v63, v63
    v_exp_f32 v32, v32
    v_exp_f32 v33, v33
    v_smfmac_f32_32x32x32_bf16 v[0:15], v[20:23], v[56:63], v28
    s_setprio 2
    v_exp_f32 v34, v34
    v_exp_f32 v35, v35
    v_exp_f32 v36, v36
    s_waitcnt lgkmcnt(2)
    v_mfma_f32_32x32x16_bf16 v[48:63], v[84:87], v[80:83], v[64:79]
    ds_read_b128 v[84:87], v29 offset:55296
    v_exp_f32 v37, v37
    v_exp_f32 v38, v38
    v_exp_f32 v39, v39
    buffer_load_dwordx4 v[120:123], v250, s[12:15], s7 offen offset:0
    v_exp_f32 v40, v40
    v_exp_f32 v41, v41
    s_waitcnt lgkmcnt(1)
    v_smfmac_f32_32x32x32_bf16 v[0:15], v[16:19], v[32:39], v28
    s_mov_b64 exec, s[4:5]
    ds_read_b128 v[16:19], v30 offset:54272
    ds_read_b128 v[20:23], v30 offset:54784
    s_mov_b64 exec, -1
    v_exp_f32 v42, v42
    v_exp_f32 v43, v43
    v_exp_f32 v44, v44
    buffer_load_dwordx4 v[136:139], v250, s[12:15], s6 offen offset:1024
    v_exp_f32 v45, v45
    v_exp_f32 v46, v46
    v_exp_f32 v47, v47
    v_exp_f32 v48, v48
    v_exp_f32 v49, v49
    v_smfmac_f32_32x32x32_bf16 v[0:15], v[24:27], v[40:47], v28
    s_setprio 1
    v_exp_f32 v50, v50
    v_exp_f32 v51, v51
    v_exp_f32 v52, v52
    s_waitcnt lgkmcnt(2)
    v_mfma_f32_32x32x16_bf16 v[32:47], v[84:87], v[80:83], v[64:79]
    ds_read_b128 v[84:87], v29 offset:57344
    v_exp_f32 v53, v53
    v_exp_f32 v54, v54
    v_exp_f32 v55, v55
    buffer_load_dwordx4 v[140:143], v250, s[12:15], s69 offen offset:1024
    v_exp_f32 v56, v56
    v_exp_f32 v57, v57
    s_waitcnt lgkmcnt(1)
    v_smfmac_f32_32x32x32_bf16 v[0:15], v[16:19], v[48:55], v28
    s_mov_b64 exec, s[4:5]
    ds_read_b128 v[16:19], v30 offset:56320
    ds_read_b128 v[24:27], v30 offset:56832
    s_mov_b64 exec, -1
    v_exp_f32 v58, v58
    v_exp_f32 v59, v59
    buffer_load_dwordx4 v[132:135], v250, s[12:15], s7 offen offset:1024
    v_exp_f32 v60, v60
    v_exp_f32 v61, v61
    buffer_load_dwordx4 v[148:151], v250, s[12:15], s6 offen offset:2048
    v_exp_f32 v62, v62
    v_exp_f32 v63, v63
    v_exp_f32 v32, v32
    v_exp_f32 v33, v33
    v_smfmac_f32_32x32x32_bf16 v[0:15], v[20:23], v[56:63], v28
    s_setprio 0
    v_exp_f32 v34, v34
    v_exp_f32 v35, v35
    v_exp_f32 v36, v36
    s_waitcnt lgkmcnt(2)
    v_mfma_f32_32x32x16_bf16 v[48:63], v[84:87], v[80:83], v[64:79]
    ds_read_b128 v[84:87], v29 offset:59392
    v_exp_f32 v37, v37
    v_exp_f32 v38, v38
    v_exp_f32 v39, v39
    buffer_load_dwordx4 v[152:155], v250, s[12:15], s69 offen offset:2048
    v_exp_f32 v40, v40
    v_exp_f32 v41, v41
    s_waitcnt lgkmcnt(1)
    v_smfmac_f32_32x32x32_bf16 v[0:15], v[16:19], v[32:39], v28
    s_mov_b64 exec, s[4:5]
    ds_read_b128 v[16:19], v30 offset:58368
    ds_read_b128 v[20:23], v30 offset:58880
    s_mov_b64 exec, -1
    v_exp_f32 v42, v42
    v_exp_f32 v43, v43
    v_exp_f32 v44, v44
    buffer_load_dwordx4 v[144:147], v250, s[12:15], s7 offen offset:2048
    v_exp_f32 v45, v45
    v_exp_f32 v46, v46
    v_exp_f32 v47, v47
    v_add_u32 v29, 57344, v29
    v_add_u32 v30, 57344, v30
    v_exp_f32 v48, v48
    v_exp_f32 v49, v49
    v_smfmac_f32_32x32x32_bf16 v[0:15], v[24:27], v[40:47], v28
    s_setprio 3
    v_exp_f32 v50, v50
    v_exp_f32 v51, v51
    v_exp_f32 v52, v52
    s_waitcnt lgkmcnt(2)
    v_mfma_f32_32x32x16_bf16 v[32:47], v[84:87], v[80:83], v[64:79]
    ds_read_b128 v[84:87], v29 offset:4096
    v_exp_f32 v53, v53
    v_exp_f32 v54, v54
    v_exp_f32 v55, v55
    buffer_load_dwordx4 v[160:163], v250, s[12:15], s6 offen offset:3072
    v_exp_f32 v56, v56
    v_exp_f32 v57, v57
    s_waitcnt lgkmcnt(1)
    v_smfmac_f32_32x32x32_bf16 v[0:15], v[16:19], v[48:55], v28
    s_mov_b64 exec, s[4:5]
    ds_read_b128 v[16:19], v30 offset:3072
    ds_read_b128 v[24:27], v30 offset:3584
    s_mov_b64 exec, -1
    v_exp_f32 v58, v58
    v_exp_f32 v59, v59
    v_exp_f32 v60, v60
    buffer_load_dwordx4 v[164:167], v250, s[12:15], s69 offen offset:3072
    v_exp_f32 v61, v61
    v_exp_f32 v62, v62
    v_exp_f32 v63, v63
    v_exp_f32 v32, v32
    v_exp_f32 v33, v33
    v_smfmac_f32_32x32x32_bf16 v[0:15], v[20:23], v[56:63], v28
    s_setprio 2
    v_exp_f32 v34, v34
    v_exp_f32 v35, v35
    v_exp_f32 v36, v36
    s_waitcnt lgkmcnt(2)
    v_mfma_f32_32x32x16_bf16 v[48:63], v[84:87], v[80:83], v[64:79]
    ds_read_b128 v[84:87], v29 offset:6144
    v_exp_f32 v37, v37
    v_exp_f32 v38, v38
    v_exp_f32 v39, v39
    buffer_load_dwordx4 v[156:159], v250, s[12:15], s7 offen offset:3072
    v_exp_f32 v40, v40
    v_exp_f32 v41, v41
    s_waitcnt lgkmcnt(1)
    v_smfmac_f32_32x32x32_bf16 v[0:15], v[16:19], v[32:39], v28
    s_mov_b64 exec, s[4:5]
    ds_read_b128 v[16:19], v30 offset:5120
    ds_read_b128 v[20:23], v30 offset:5632
    s_mov_b64 exec, -1
    v_exp_f32 v42, v42
    v_exp_f32 v43, v43
    v_exp_f32 v44, v44
    s_add_u32 s6, s6, 4096
    buffer_load_dwordx4 v[172:175], v250, s[12:15], s6 offen offset:0
    v_exp_f32 v45, v45
    v_exp_f32 v46, v46
    v_exp_f32 v47, v47
    v_exp_f32 v48, v48
    v_exp_f32 v49, v49
    v_smfmac_f32_32x32x32_bf16 v[0:15], v[24:27], v[40:47], v28
    s_setprio 1
    v_exp_f32 v50, v50
    v_exp_f32 v51, v51
    v_exp_f32 v52, v52
    s_waitcnt lgkmcnt(2)
    v_mfma_f32_32x32x16_bf16 v[32:47], v[84:87], v[80:83], v[64:79]
    ds_read_b128 v[84:87], v29 offset:8192
    v_exp_f32 v53, v53
    v_exp_f32 v54, v54
    v_exp_f32 v55, v55
    s_add_u32 s69, s69, 4096
    buffer_load_dwordx4 v[176:179], v250, s[12:15], s69 offen offset:0
    v_exp_f32 v56, v56
    v_exp_f32 v57, v57
    s_waitcnt lgkmcnt(1)
    v_smfmac_f32_32x32x32_bf16 v[0:15], v[16:19], v[48:55], v28
    s_mov_b64 exec, s[4:5]
    ds_read_b128 v[16:19], v30 offset:7168
    ds_read_b128 v[24:27], v30 offset:7680
    s_mov_b64 exec, -1
    v_exp_f32 v58, v58
    v_exp_f32 v59, v59
    s_add_u32 s7, s7, 4096
    buffer_load_dwordx4 v[168:171], v250, s[12:15], s7 offen offset:0
    v_exp_f32 v60, v60
    v_exp_f32 v61, v61
    s_waitcnt vmcnt(12)
    v_mfma_f32_32x32x16_bf16 v[88:103], v[124:127], v[120:123], 0
    buffer_load_dwordx4 v[124:127], v250, s[12:15], s6 offen offset:1024
    v_exp_f32 v62, v62
    v_exp_f32 v63, v63
    v_exp_f32 v32, v32
    v_exp_f32 v33, v33
    v_smfmac_f32_32x32x32_bf16 v[0:15], v[20:23], v[56:63], v28
    s_setprio 0
    v_exp_f32 v34, v34
    v_exp_f32 v35, v35
    v_exp_f32 v36, v36
    s_waitcnt lgkmcnt(2)
    v_mfma_f32_32x32x16_bf16 v[48:63], v[84:87], v[80:83], v[64:79]
    ds_read_b128 v[84:87], v29 offset:10240
    v_exp_f32 v37, v37
    v_exp_f32 v38, v38
    v_exp_f32 v39, v39
    v_mfma_f32_32x32x16_bf16 v[104:119], v[128:131], v[120:123], 0
    buffer_load_dwordx4 v[128:131], v250, s[12:15], s69 offen offset:1024
    v_exp_f32 v40, v40
    v_exp_f32 v41, v41
    s_waitcnt lgkmcnt(1)
    v_smfmac_f32_32x32x32_bf16 v[0:15], v[16:19], v[32:39], v28
    s_mov_b64 exec, s[4:5]
    ds_read_b128 v[16:19], v30 offset:9216
    ds_read_b128 v[20:23], v30 offset:9728
    s_mov_b64 exec, -1
    v_exp_f32 v42, v42
    v_exp_f32 v43, v43
    v_exp_f32 v44, v44
    buffer_load_dwordx4 v[120:123], v250, s[12:15], s7 offen offset:1024
    v_exp_f32 v45, v45
    v_exp_f32 v46, v46
    v_exp_f32 v47, v47
    v_exp_f32 v48, v48
    v_exp_f32 v49, v49
    v_smfmac_f32_32x32x32_bf16 v[0:15], v[24:27], v[40:47], v28
    s_setprio 3
    v_exp_f32 v50, v50
    v_exp_f32 v51, v51
    v_exp_f32 v52, v52
    s_waitcnt lgkmcnt(2)
    v_mfma_f32_32x32x16_bf16 v[32:47], v[84:87], v[80:83], v[64:79]
    ds_read_b128 v[84:87], v29 offset:12288
    v_exp_f32 v53, v53
    v_exp_f32 v54, v54
    v_exp_f32 v55, v55
    s_waitcnt vmcnt(12)
    v_mfma_f32_32x32x16_bf16 v[88:103], v[136:139], v[132:135], v[88:103]
    buffer_load_dwordx4 v[136:139], v250, s[12:15], s6 offen offset:2048
    v_exp_f32 v56, v56
    v_exp_f32 v57, v57
    s_waitcnt lgkmcnt(1)
    v_smfmac_f32_32x32x32_bf16 v[0:15], v[16:19], v[48:55], v28
    s_mov_b64 exec, s[4:5]
    ds_read_b128 v[16:19], v30 offset:11264
    ds_read_b128 v[24:27], v30 offset:11776
    s_mov_b64 exec, -1
    v_exp_f32 v58, v58
    v_exp_f32 v59, v59
    v_exp_f32 v60, v60
    v_mfma_f32_32x32x16_bf16 v[104:119], v[140:143], v[132:135], v[104:119]
    buffer_load_dwordx4 v[140:143], v250, s[12:15], s69 offen offset:2048
    v_exp_f32 v61, v61
    v_exp_f32 v62, v62
    v_exp_f32 v63, v63
    v_exp_f32 v32, v32
    v_exp_f32 v33, v33
    v_smfmac_f32_32x32x32_bf16 v[0:15], v[20:23], v[56:63], v28
    s_setprio 2
    v_exp_f32 v34, v34
    v_exp_f32 v35, v35
    v_exp_f32 v36, v36
    s_waitcnt lgkmcnt(2)
    v_mfma_f32_32x32x16_bf16 v[48:63], v[84:87], v[80:83], v[64:79]
    ds_read_b128 v[84:87], v29 offset:14336
    v_exp_f32 v37, v37
    v_exp_f32 v38, v38
    v_exp_f32 v39, v39
    buffer_load_dwordx4 v[132:135], v250, s[12:15], s7 offen offset:2048
    v_exp_f32 v40, v40
    v_exp_f32 v41, v41
    s_waitcnt lgkmcnt(1)
    v_smfmac_f32_32x32x32_bf16 v[0:15], v[16:19], v[32:39], v28
    s_mov_b64 exec, s[4:5]
    ds_read_b128 v[16:19], v30 offset:13312
    ds_read_b128 v[20:23], v30 offset:13824
    s_mov_b64 exec, -1
    v_exp_f32 v42, v42
    v_exp_f32 v43, v43
    v_exp_f32 v44, v44
    s_waitcnt vmcnt(12)
    v_mfma_f32_32x32x16_bf16 v[88:103], v[148:151], v[144:147], v[88:103]
    buffer_load_dwordx4 v[148:151], v250, s[12:15], s6 offen offset:3072
    v_exp_f32 v45, v45
    v_exp_f32 v46, v46
    v_exp_f32 v47, v47
    v_exp_f32 v48, v48
    v_exp_f32 v49, v49
    v_smfmac_f32_32x32x32_bf16 v[0:15], v[24:27], v[40:47], v28
    s_setprio 1
    v_exp_f32 v50, v50
    v_exp_f32 v51, v51
    v_exp_f32 v52, v52
    s_waitcnt lgkmcnt(2)
    v_mfma_f32_32x32x16_bf16 v[32:47], v[84:87], v[80:83], v[64:79]
    ds_read_b128 v[84:87], v29 offset:16384
    v_exp_f32 v53, v53
    v_exp_f32 v54, v54
    v_exp_f32 v55, v55
    v_mfma_f32_32x32x16_bf16 v[104:119], v[152:155], v[144:147], v[104:119]
    buffer_load_dwordx4 v[152:155], v250, s[12:15], s69 offen offset:3072
    v_exp_f32 v56, v56
    v_exp_f32 v57, v57
    s_waitcnt lgkmcnt(1)
    v_smfmac_f32_32x32x32_bf16 v[0:15], v[16:19], v[48:55], v28
    s_mov_b64 exec, s[4:5]
    ds_read_b128 v[16:19], v30 offset:15360
    ds_read_b128 v[24:27], v30 offset:15872
    s_mov_b64 exec, -1
    v_exp_f32 v58, v58
    v_exp_f32 v59, v59
    buffer_load_dwordx4 v[144:147], v250, s[12:15], s7 offen offset:3072
    v_exp_f32 v60, v60
    v_exp_f32 v61, v61
    s_waitcnt vmcnt(12)
    v_mfma_f32_32x32x16_bf16 v[88:103], v[160:163], v[156:159], v[88:103]
    s_add_u32 s6, s6, 4096
    buffer_load_dwordx4 v[160:163], v250, s[12:15], s6 offen offset:0
    v_exp_f32 v62, v62
    v_exp_f32 v63, v63
    v_exp_f32 v32, v32
    v_exp_f32 v33, v33
    v_smfmac_f32_32x32x32_bf16 v[0:15], v[20:23], v[56:63], v28
    s_setprio 0
    v_exp_f32 v34, v34
    v_exp_f32 v35, v35
    v_exp_f32 v36, v36
    s_waitcnt lgkmcnt(2)
    v_mfma_f32_32x32x16_bf16 v[48:63], v[84:87], v[80:83], v[64:79]
    ds_read_b128 v[84:87], v29 offset:18432
    v_exp_f32 v37, v37
    v_exp_f32 v38, v38
    v_exp_f32 v39, v39
    v_mfma_f32_32x32x16_bf16 v[104:119], v[164:167], v[156:159], v[104:119]
    s_add_u32 s69, s69, 4096
    buffer_load_dwordx4 v[164:167], v250, s[12:15], s69 offen offset:0
    v_exp_f32 v40, v40
    v_exp_f32 v41, v41
    s_waitcnt lgkmcnt(1)
    v_smfmac_f32_32x32x32_bf16 v[0:15], v[16:19], v[32:39], v28
    s_mov_b64 exec, s[4:5]
    ds_read_b128 v[16:19], v30 offset:17408
    ds_read_b128 v[20:23], v30 offset:17920
    s_mov_b64 exec, -1
    v_exp_f32 v42, v42
    v_exp_f32 v43, v43
    v_exp_f32 v44, v44
    s_add_u32 s7, s7, 4096
    buffer_load_dwordx4 v[156:159], v250, s[12:15], s7 offen offset:0
    v_exp_f32 v45, v45
    v_exp_f32 v46, v46
    v_exp_f32 v47, v47
    v_exp_f32 v48, v48
    v_exp_f32 v49, v49
    v_smfmac_f32_32x32x32_bf16 v[0:15], v[24:27], v[40:47], v28
    s_setprio 3
    v_exp_f32 v50, v50
    v_exp_f32 v51, v51
    v_exp_f32 v52, v52
    s_waitcnt lgkmcnt(2)
    v_mfma_f32_32x32x16_bf16 v[32:47], v[84:87], v[80:83], v[64:79]
    ds_read_b128 v[84:87], v29 offset:20480
    v_exp_f32 v53, v53
    v_exp_f32 v54, v54
    v_exp_f32 v55, v55
    s_waitcnt vmcnt(12)
    v_mfma_f32_32x32x16_bf16 v[88:103], v[172:175], v[168:171], v[88:103]
    buffer_load_dwordx4 v[172:175], v250, s[12:15], s6 offen offset:1024
    v_exp_f32 v56, v56
    v_exp_f32 v57, v57
    s_waitcnt lgkmcnt(1)
    v_smfmac_f32_32x32x32_bf16 v[0:15], v[16:19], v[48:55], v28
    s_mov_b64 exec, s[4:5]
    ds_read_b128 v[16:19], v30 offset:19456
    ds_read_b128 v[24:27], v30 offset:19968
    s_mov_b64 exec, -1
    v_exp_f32 v58, v58
    v_exp_f32 v59, v59
    v_exp_f32 v60, v60
    v_mfma_f32_32x32x16_bf16 v[104:119], v[176:179], v[168:171], v[104:119]
    buffer_load_dwordx4 v[176:179], v250, s[12:15], s69 offen offset:1024
    v_exp_f32 v61, v61
    v_exp_f32 v62, v62
    v_exp_f32 v63, v63
    v_exp_f32 v32, v32
    v_exp_f32 v33, v33
    v_smfmac_f32_32x32x32_bf16 v[0:15], v[20:23], v[56:63], v28
    s_setprio 2
    v_exp_f32 v34, v34
    v_exp_f32 v35, v35
    v_exp_f32 v36, v36
    s_waitcnt lgkmcnt(2)
    v_mfma_f32_32x32x16_bf16 v[48:63], v[84:87], v[80:83], v[64:79]
    ds_read_b128 v[84:87], v29 offset:22528
    v_exp_f32 v37, v37
    v_exp_f32 v38, v38
    v_exp_f32 v39, v39
    buffer_load_dwordx4 v[168:171], v250, s[12:15], s7 offen offset:1024
    v_exp_f32 v40, v40
    v_exp_f32 v41, v41
    s_waitcnt lgkmcnt(1)
    v_smfmac_f32_32x32x32_bf16 v[0:15], v[16:19], v[32:39], v28
    s_mov_b64 exec, s[4:5]
    ds_read_b128 v[16:19], v30 offset:21504
    ds_read_b128 v[20:23], v30 offset:22016
    s_mov_b64 exec, -1
    v_exp_f32 v42, v42
    v_exp_f32 v43, v43
    v_exp_f32 v44, v44
    s_waitcnt vmcnt(12)
    v_mfma_f32_32x32x16_bf16 v[88:103], v[124:127], v[120:123], v[88:103]
    buffer_load_dwordx4 v[124:127], v250, s[12:15], s6 offen offset:2048
    v_exp_f32 v45, v45
    v_exp_f32 v46, v46
    v_exp_f32 v47, v47
    v_exp_f32 v48, v48
    v_exp_f32 v49, v49
    v_smfmac_f32_32x32x32_bf16 v[0:15], v[24:27], v[40:47], v28
    s_setprio 1
    v_exp_f32 v50, v50
    v_exp_f32 v51, v51
    v_exp_f32 v52, v52
    s_waitcnt lgkmcnt(2)
    v_mfma_f32_32x32x16_bf16 v[32:47], v[84:87], v[80:83], v[64:79]
    ds_read_b128 v[84:87], v29 offset:24576
    v_exp_f32 v53, v53
    v_exp_f32 v54, v54
    v_exp_f32 v55, v55
    v_mfma_f32_32x32x16_bf16 v[104:119], v[128:131], v[120:123], v[104:119]
    buffer_load_dwordx4 v[128:131], v250, s[12:15], s69 offen offset:2048
    v_exp_f32 v56, v56
    v_exp_f32 v57, v57
    s_waitcnt lgkmcnt(1)
    v_smfmac_f32_32x32x32_bf16 v[0:15], v[16:19], v[48:55], v28
    s_mov_b64 exec, s[4:5]
    ds_read_b128 v[16:19], v30 offset:23552
    ds_read_b128 v[24:27], v30 offset:24064
    s_mov_b64 exec, -1
    v_exp_f32 v58, v58
    v_exp_f32 v59, v59
    buffer_load_dwordx4 v[120:123], v250, s[12:15], s7 offen offset:2048
    v_exp_f32 v60, v60
    v_exp_f32 v61, v61
    s_waitcnt vmcnt(12)
    v_mfma_f32_32x32x16_bf16 v[88:103], v[136:139], v[132:135], v[88:103]
    buffer_load_dwordx4 v[136:139], v250, s[12:15], s6 offen offset:3072
    v_exp_f32 v62, v62
    v_exp_f32 v63, v63
    v_exp_f32 v32, v32
    v_exp_f32 v33, v33
    v_smfmac_f32_32x32x32_bf16 v[0:15], v[20:23], v[56:63], v28
    s_setprio 0
    v_exp_f32 v34, v34
    v_exp_f32 v35, v35
    v_exp_f32 v36, v36
    s_waitcnt lgkmcnt(2)
    v_mfma_f32_32x32x16_bf16 v[48:63], v[84:87], v[80:83], v[64:79]
    ds_read_b128 v[84:87], v29 offset:26624
    v_exp_f32 v37, v37
    v_exp_f32 v38, v38
    v_exp_f32 v39, v39
    v_mfma_f32_32x32x16_bf16 v[104:119], v[140:143], v[132:135], v[104:119]
    buffer_load_dwordx4 v[140:143], v250, s[12:15], s69 offen offset:3072
    v_exp_f32 v40, v40
    v_exp_f32 v41, v41
    s_waitcnt lgkmcnt(1)
    v_smfmac_f32_32x32x32_bf16 v[0:15], v[16:19], v[32:39], v28
    s_mov_b64 exec, s[4:5]
    ds_read_b128 v[16:19], v30 offset:25600
    ds_read_b128 v[20:23], v30 offset:26112
    s_mov_b64 exec, -1
    v_exp_f32 v42, v42
    v_exp_f32 v43, v43
    v_exp_f32 v44, v44
    buffer_load_dwordx4 v[132:135], v250, s[12:15], s7 offen offset:3072
    v_exp_f32 v45, v45
    v_exp_f32 v46, v46
    v_exp_f32 v47, v47
    v_exp_f32 v48, v48
    v_exp_f32 v49, v49
    v_smfmac_f32_32x32x32_bf16 v[0:15], v[24:27], v[40:47], v28
    s_setprio 3
    v_exp_f32 v50, v50
    v_exp_f32 v51, v51
    v_exp_f32 v52, v52
    s_waitcnt lgkmcnt(2)
    v_mfma_f32_32x32x16_bf16 v[32:47], v[84:87], v[80:83], v[64:79]
    ds_read_b128 v[84:87], v29 offset:28672
    v_exp_f32 v53, v53
    v_exp_f32 v54, v54
    v_exp_f32 v55, v55
    s_waitcnt vmcnt(12)
    v_mfma_f32_32x32x16_bf16 v[88:103], v[148:151], v[144:147], v[88:103]
    s_add_u32 s6, s6, 4096
    buffer_load_dwordx4 v[148:151], v250, s[12:15], s6 offen offset:0
    v_exp_f32 v56, v56
    v_exp_f32 v57, v57
    s_waitcnt lgkmcnt(1)
    v_smfmac_f32_32x32x32_bf16 v[0:15], v[16:19], v[48:55], v28
    s_mov_b64 exec, s[4:5]
    ds_read_b128 v[16:19], v30 offset:27648
    ds_read_b128 v[24:27], v30 offset:28160
    s_mov_b64 exec, -1
    v_exp_f32 v58, v58
    v_exp_f32 v59, v59
    v_exp_f32 v60, v60
    v_mfma_f32_32x32x16_bf16 v[104:119], v[152:155], v[144:147], v[104:119]
    s_add_u32 s69, s69, 4096
    buffer_load_dwordx4 v[152:155], v250, s[12:15], s69 offen offset:0
    v_exp_f32 v61, v61
    v_exp_f32 v62, v62
    v_exp_f32 v63, v63
    v_exp_f32 v32, v32
    v_exp_f32 v33, v33
    v_smfmac_f32_32x32x32_bf16 v[0:15], v[20:23], v[56:63], v28
    s_setprio 2
    v_exp_f32 v34, v34
    v_exp_f32 v35, v35
    v_exp_f32 v36, v36
    s_waitcnt lgkmcnt(2)
    v_mfma_f32_32x32x16_bf16 v[48:63], v[84:87], v[80:83], v[64:79]
    ds_read_b128 v[84:87], v29 offset:30720
    v_exp_f32 v37, v37
    v_exp_f32 v38, v38
    v_exp_f32 v39, v39
    s_add_u32 s7, s7, 4096
    buffer_load_dwordx4 v[144:147], v250, s[12:15], s7 offen offset:0
    v_exp_f32 v40, v40
    v_exp_f32 v41, v41
    s_waitcnt lgkmcnt(1)
    v_smfmac_f32_32x32x32_bf16 v[0:15], v[16:19], v[32:39], v28
    s_mov_b64 exec, s[4:5]
    ds_read_b128 v[16:19], v30 offset:29696
    ds_read_b128 v[20:23], v30 offset:30208
    s_mov_b64 exec, -1
    v_exp_f32 v42, v42
    v_exp_f32 v43, v43
    v_exp_f32 v44, v44
    s_waitcnt vmcnt(12)
    v_mfma_f32_32x32x16_bf16 v[88:103], v[160:163], v[156:159], v[88:103]
    buffer_load_dwordx4 v[160:163], v250, s[12:15], s6 offen offset:1024
    v_exp_f32 v45, v45
    v_exp_f32 v46, v46
    v_exp_f32 v47, v47
    v_exp_f32 v48, v48
    v_exp_f32 v49, v49
    v_smfmac_f32_32x32x32_bf16 v[0:15], v[24:27], v[40:47], v28
    s_setprio 1
    v_exp_f32 v50, v50
    v_exp_f32 v51, v51
    v_exp_f32 v52, v52
    s_waitcnt lgkmcnt(2)
    v_mfma_f32_32x32x16_bf16 v[32:47], v[84:87], v[80:83], v[64:79]
    ds_read_b128 v[84:87], v29 offset:32768
    v_exp_f32 v53, v53
    v_exp_f32 v54, v54
    v_exp_f32 v55, v55
    v_mfma_f32_32x32x16_bf16 v[104:119], v[164:167], v[156:159], v[104:119]
    buffer_load_dwordx4 v[164:167], v250, s[12:15], s69 offen offset:1024
    v_exp_f32 v56, v56
    v_exp_f32 v57, v57
    s_waitcnt lgkmcnt(1)
    v_smfmac_f32_32x32x32_bf16 v[0:15], v[16:19], v[48:55], v28
    s_mov_b64 exec, s[4:5]
    ds_read_b128 v[16:19], v30 offset:31744
    ds_read_b128 v[24:27], v30 offset:32256
    s_mov_b64 exec, -1
    v_exp_f32 v58, v58
    v_exp_f32 v59, v59
    buffer_load_dwordx4 v[156:159], v250, s[12:15], s7 offen offset:1024
    v_exp_f32 v60, v60
    v_exp_f32 v61, v61
    s_waitcnt vmcnt(12)
    v_mfma_f32_32x32x16_bf16 v[88:103], v[172:175], v[168:171], v[88:103]
    buffer_load_dwordx4 v[172:175], v250, s[12:15], s6 offen offset:2048
    v_exp_f32 v62, v62
    v_exp_f32 v63, v63
    v_exp_f32 v32, v32
    v_exp_f32 v33, v33
    v_smfmac_f32_32x32x32_bf16 v[0:15], v[20:23], v[56:63], v28
    s_setprio 0
    v_exp_f32 v34, v34
    v_exp_f32 v35, v35
    v_exp_f32 v36, v36
    s_waitcnt lgkmcnt(2)
    v_mfma_f32_32x32x16_bf16 v[48:63], v[84:87], v[80:83], v[64:79]
    ds_read_b128 v[84:87], v29 offset:34816
    v_exp_f32 v37, v37
    v_exp_f32 v38, v38
    v_exp_f32 v39, v39
    v_mfma_f32_32x32x16_bf16 v[104:119], v[176:179], v[168:171], v[104:119]
    buffer_load_dwordx4 v[176:179], v250, s[12:15], s69 offen offset:2048
    v_exp_f32 v40, v40
    v_exp_f32 v41, v41
    s_waitcnt lgkmcnt(1)
    v_smfmac_f32_32x32x32_bf16 v[0:15], v[16:19], v[32:39], v28
    s_mov_b64 exec, s[4:5]
    ds_read_b128 v[16:19], v30 offset:33792
    ds_read_b128 v[20:23], v30 offset:34304
    s_mov_b64 exec, -1
    v_exp_f32 v42, v42
    v_exp_f32 v43, v43
    v_exp_f32 v44, v44
    buffer_load_dwordx4 v[168:171], v250, s[12:15], s7 offen offset:2048
    v_exp_f32 v45, v45
    v_exp_f32 v46, v46
    v_exp_f32 v47, v47
    v_exp_f32 v48, v48
    v_exp_f32 v49, v49
    v_smfmac_f32_32x32x32_bf16 v[0:15], v[24:27], v[40:47], v28
    s_setprio 3
    v_exp_f32 v50, v50
    v_exp_f32 v51, v51
    v_exp_f32 v52, v52
    s_waitcnt lgkmcnt(2)
    v_mfma_f32_32x32x16_bf16 v[32:47], v[84:87], v[80:83], v[64:79]
    ds_read_b128 v[84:87], v29 offset:36864
    v_exp_f32 v53, v53
    v_exp_f32 v54, v54
    v_exp_f32 v55, v55
    s_waitcnt vmcnt(12)
    v_mfma_f32_32x32x16_bf16 v[88:103], v[124:127], v[120:123], v[88:103]
    buffer_load_dwordx4 v[124:127], v250, s[12:15], s6 offen offset:3072
    v_exp_f32 v56, v56
    v_exp_f32 v57, v57
    s_waitcnt lgkmcnt(1)
    v_smfmac_f32_32x32x32_bf16 v[0:15], v[16:19], v[48:55], v28
    s_mov_b64 exec, s[4:5]
    ds_read_b128 v[16:19], v30 offset:35840
    ds_read_b128 v[24:27], v30 offset:36352
    s_mov_b64 exec, -1
    v_exp_f32 v58, v58
    v_exp_f32 v59, v59
    v_exp_f32 v60, v60
    v_mfma_f32_32x32x16_bf16 v[104:119], v[128:131], v[120:123], v[104:119]
    buffer_load_dwordx4 v[128:131], v250, s[12:15], s69 offen offset:3072
    v_exp_f32 v61, v61
    v_exp_f32 v62, v62
    v_exp_f32 v63, v63
    v_exp_f32 v32, v32
    v_exp_f32 v33, v33
    v_smfmac_f32_32x32x32_bf16 v[0:15], v[20:23], v[56:63], v28
    s_setprio 2
    v_exp_f32 v34, v34
    v_exp_f32 v35, v35
    v_exp_f32 v36, v36
    s_waitcnt lgkmcnt(2)
    v_mfma_f32_32x32x16_bf16 v[48:63], v[84:87], v[80:83], v[64:79]
    ds_read_b128 v[84:87], v29 offset:38912
    v_exp_f32 v37, v37
    v_exp_f32 v38, v38
    v_exp_f32 v39, v39
    buffer_load_dwordx4 v[120:123], v250, s[12:15], s7 offen offset:3072
    v_exp_f32 v40, v40
    v_exp_f32 v41, v41
    s_waitcnt lgkmcnt(1)
    v_smfmac_f32_32x32x32_bf16 v[0:15], v[16:19], v[32:39], v28
    s_mov_b64 exec, s[4:5]
    ds_read_b128 v[16:19], v30 offset:37888
    ds_read_b128 v[20:23], v30 offset:38400
    s_mov_b64 exec, -1
    v_exp_f32 v42, v42
    v_exp_f32 v43, v43
    v_exp_f32 v44, v44
    s_waitcnt vmcnt(12)
    v_mfma_f32_32x32x16_bf16 v[88:103], v[136:139], v[132:135], v[88:103]
    s_add_u32 s6, s6, 4096
    buffer_load_dwordx4 v[136:139], v250, s[12:15], s6 offen offset:0
    v_exp_f32 v45, v45
    v_exp_f32 v46, v46
    v_exp_f32 v47, v47
    v_exp_f32 v48, v48
    v_exp_f32 v49, v49
    v_smfmac_f32_32x32x32_bf16 v[0:15], v[24:27], v[40:47], v28
    s_setprio 1
    v_exp_f32 v50, v50
    v_exp_f32 v51, v51
    v_exp_f32 v52, v52
    s_waitcnt lgkmcnt(2)
    v_mfma_f32_32x32x16_bf16 v[32:47], v[84:87], v[80:83], v[64:79]
    ds_read_b128 v[84:87], v29 offset:40960
    v_exp_f32 v53, v53
    v_exp_f32 v54, v54
    v_exp_f32 v55, v55
    v_mfma_f32_32x32x16_bf16 v[104:119], v[140:143], v[132:135], v[104:119]
    s_add_u32 s69, s69, 4096
    buffer_load_dwordx4 v[140:143], v250, s[12:15], s69 offen offset:0
    v_exp_f32 v56, v56
    v_exp_f32 v57, v57
    s_waitcnt lgkmcnt(1)
    v_smfmac_f32_32x32x32_bf16 v[0:15], v[16:19], v[48:55], v28
    s_mov_b64 exec, s[4:5]
    ds_read_b128 v[16:19], v30 offset:39936
    ds_read_b128 v[24:27], v30 offset:40448
    s_mov_b64 exec, -1
    v_exp_f32 v58, v58
    v_exp_f32 v59, v59
    s_add_u32 s7, s7, 4096
    buffer_load_dwordx4 v[132:135], v250, s[12:15], s7 offen offset:0
    v_exp_f32 v60, v60
    v_exp_f32 v61, v61
    s_waitcnt vmcnt(12)
    v_mfma_f32_32x32x16_bf16 v[88:103], v[148:151], v[144:147], v[88:103]
    buffer_load_dwordx4 v[148:151], v250, s[12:15], s6 offen offset:1024
    v_exp_f32 v62, v62
    v_exp_f32 v63, v63
    v_exp_f32 v32, v32
    v_exp_f32 v33, v33
    v_smfmac_f32_32x32x32_bf16 v[0:15], v[20:23], v[56:63], v28
    s_setprio 0
    v_exp_f32 v34, v34
    v_exp_f32 v35, v35
    v_exp_f32 v36, v36
    s_waitcnt lgkmcnt(2)
    v_mfma_f32_32x32x16_bf16 v[48:63], v[84:87], v[80:83], v[64:79]
    ds_read_b128 v[84:87], v29 offset:43008
    v_exp_f32 v37, v37
    v_exp_f32 v38, v38
    v_exp_f32 v39, v39
    v_mfma_f32_32x32x16_bf16 v[104:119], v[152:155], v[144:147], v[104:119]
    buffer_load_dwordx4 v[152:155], v250, s[12:15], s69 offen offset:1024
    v_exp_f32 v40, v40
    v_exp_f32 v41, v41
    s_waitcnt lgkmcnt(1)
    v_smfmac_f32_32x32x32_bf16 v[0:15], v[16:19], v[32:39], v28
    s_mov_b64 exec, s[4:5]
    ds_read_b128 v[16:19], v30 offset:41984
    ds_read_b128 v[20:23], v30 offset:42496
    s_mov_b64 exec, -1
    v_exp_f32 v42, v42
    v_exp_f32 v43, v43
    v_exp_f32 v44, v44
    buffer_load_dwordx4 v[144:147], v250, s[12:15], s7 offen offset:1024
    v_exp_f32 v45, v45
    v_exp_f32 v46, v46
    v_exp_f32 v47, v47
    v_exp_f32 v48, v48
    v_exp_f32 v49, v49
    v_smfmac_f32_32x32x32_bf16 v[0:15], v[24:27], v[40:47], v28
    s_setprio 3
    v_exp_f32 v50, v50
    v_exp_f32 v51, v51
    v_exp_f32 v52, v52
    s_waitcnt lgkmcnt(2)
    v_mfma_f32_32x32x16_bf16 v[32:47], v[84:87], v[80:83], v[64:79]
    ds_read_b128 v[84:87], v29 offset:45056
    v_exp_f32 v53, v53
    v_exp_f32 v54, v54
    v_exp_f32 v55, v55
    s_waitcnt vmcnt(12)
    v_mfma_f32_32x32x16_bf16 v[88:103], v[160:163], v[156:159], v[88:103]
    buffer_load_dwordx4 v[160:163], v250, s[12:15], s6 offen offset:2048
    v_exp_f32 v56, v56
    v_exp_f32 v57, v57
    s_waitcnt lgkmcnt(1)
    v_smfmac_f32_32x32x32_bf16 v[0:15], v[16:19], v[48:55], v28
    s_mov_b64 exec, s[4:5]
    ds_read_b128 v[16:19], v30 offset:44032
    ds_read_b128 v[24:27], v30 offset:44544
    s_mov_b64 exec, -1
    v_exp_f32 v58, v58
    v_exp_f32 v59, v59
    v_exp_f32 v60, v60
    v_mfma_f32_32x32x16_bf16 v[104:119], v[164:167], v[156:159], v[104:119]
    buffer_load_dwordx4 v[164:167], v250, s[12:15], s69 offen offset:2048
    v_exp_f32 v61, v61
    v_exp_f32 v62, v62
    v_exp_f32 v63, v63
    v_exp_f32 v32, v32
    v_exp_f32 v33, v33
    v_smfmac_f32_32x32x32_bf16 v[0:15], v[20:23], v[56:63], v28
    s_setprio 2
    v_exp_f32 v34, v34
    v_exp_f32 v35, v35
    v_exp_f32 v36, v36
    s_waitcnt lgkmcnt(2)
    v_mfma_f32_32x32x16_bf16 v[48:63], v[84:87], v[80:83], v[64:79]
    ds_read_b128 v[84:87], v29 offset:47104
    v_exp_f32 v37, v37
    v_exp_f32 v38, v38
    v_exp_f32 v39, v39
    buffer_load_dwordx4 v[156:159], v250, s[12:15], s7 offen offset:2048
    v_exp_f32 v40, v40
    v_exp_f32 v41, v41
    s_waitcnt lgkmcnt(1)
    v_smfmac_f32_32x32x32_bf16 v[0:15], v[16:19], v[32:39], v28
    s_mov_b64 exec, s[4:5]
    ds_read_b128 v[16:19], v30 offset:46080
    ds_read_b128 v[20:23], v30 offset:46592
    s_mov_b64 exec, -1
    v_exp_f32 v42, v42
    v_exp_f32 v43, v43
    v_exp_f32 v44, v44
    s_waitcnt vmcnt(12)
    v_mfma_f32_32x32x16_bf16 v[88:103], v[172:175], v[168:171], v[88:103]
    buffer_load_dwordx4 v[172:175], v250, s[12:15], s6 offen offset:3072
    v_exp_f32 v45, v45
    v_exp_f32 v46, v46
    v_exp_f32 v47, v47
    v_exp_f32 v48, v48
    v_exp_f32 v49, v49
    v_smfmac_f32_32x32x32_bf16 v[0:15], v[24:27], v[40:47], v28
    s_setprio 1
    v_exp_f32 v50, v50
    v_exp_f32 v51, v51
    v_exp_f32 v52, v52
    s_waitcnt lgkmcnt(2)
    v_mfma_f32_32x32x16_bf16 v[32:47], v[84:87], v[80:83], v[64:79]
    ds_read_b128 v[84:87], v29 offset:49152
    v_exp_f32 v53, v53
    v_exp_f32 v54, v54
    v_exp_f32 v55, v55
    v_mfma_f32_32x32x16_bf16 v[104:119], v[176:179], v[168:171], v[104:119]
    buffer_load_dwordx4 v[176:179], v250, s[12:15], s69 offen offset:3072
    v_exp_f32 v56, v56
    v_exp_f32 v57, v57
    s_waitcnt lgkmcnt(1)
    v_smfmac_f32_32x32x32_bf16 v[0:15], v[16:19], v[48:55], v28
    s_mov_b64 exec, s[4:5]
    ds_read_b128 v[16:19], v30 offset:48128
    ds_read_b128 v[24:27], v30 offset:48640
    s_mov_b64 exec, -1
    v_exp_f32 v58, v58
    v_exp_f32 v59, v59
    buffer_load_dwordx4 v[168:171], v250, s[12:15], s7 offen offset:3072
    v_exp_f32 v60, v60
    v_exp_f32 v61, v61
    s_waitcnt vmcnt(12)
    v_mfma_f32_32x32x16_bf16 v[88:103], v[124:127], v[120:123], v[88:103]
    s_add_u32 s6, s6, 4096
    buffer_load_dwordx4 v[124:127], v250, s[12:15], s6 offen offset:0
    v_exp_f32 v62, v62
    v_exp_f32 v63, v63
    v_exp_f32 v32, v32
    v_exp_f32 v33, v33
    v_smfmac_f32_32x32x32_bf16 v[0:15], v[20:23], v[56:63], v28
    s_setprio 0
    v_exp_f32 v34, v34
    v_exp_f32 v35, v35
    v_exp_f32 v36, v36
    s_waitcnt lgkmcnt(2)
    v_mfma_f32_32x32x16_bf16 v[48:63], v[84:87], v[80:83], v[64:79]
    ds_read_b128 v[84:87], v29 offset:51200
    v_exp_f32 v37, v37
    v_exp_f32 v38, v38
    v_exp_f32 v39, v39
    v_mfma_f32_32x32x16_bf16 v[104:119], v[128:131], v[120:123], v[104:119]
    s_add_u32 s69, s69, 4096
    buffer_load_dwordx4 v[128:131], v250, s[12:15], s69 offen offset:0
    v_exp_f32 v40, v40
    v_exp_f32 v41, v41
    s_waitcnt lgkmcnt(1)
    v_smfmac_f32_32x32x32_bf16 v[0:15], v[16:19], v[32:39], v28
    s_mov_b64 exec, s[4:5]
    ds_read_b128 v[16:19], v30 offset:50176
    ds_read_b128 v[20:23], v30 offset:50688
    s_mov_b64 exec, -1
    v_exp_f32 v42, v42
    v_exp_f32 v43, v43
    v_exp_f32 v44, v44
    s_add_u32 s7, s7, 4096
    buffer_load_dwordx4 v[120:123], v250, s[12:15], s7 offen offset:0
    v_exp_f32 v45, v45
    v_exp_f32 v46, v46
    v_exp_f32 v47, v47
    v_exp_f32 v48, v48
    v_exp_f32 v49, v49
    v_smfmac_f32_32x32x32_bf16 v[0:15], v[24:27], v[40:47], v28
    s_setprio 3
    v_exp_f32 v50, v50
    v_exp_f32 v51, v51
    v_exp_f32 v52, v52
    s_waitcnt lgkmcnt(2)
    v_mfma_f32_32x32x16_bf16 v[32:47], v[84:87], v[80:83], v[64:79]
    ds_read_b128 v[84:87], v29 offset:53248
    v_exp_f32 v53, v53
    v_exp_f32 v54, v54
    v_exp_f32 v55, v55
    s_waitcnt vmcnt(12)
    v_mfma_f32_32x32x16_bf16 v[88:103], v[136:139], v[132:135], v[88:103]
    buffer_load_dwordx4 v[136:139], v250, s[12:15], s6 offen offset:1024
    v_exp_f32 v56, v56
    v_exp_f32 v57, v57
    s_waitcnt lgkmcnt(1)
    v_smfmac_f32_32x32x32_bf16 v[0:15], v[16:19], v[48:55], v28
    s_mov_b64 exec, s[4:5]
    ds_read_b128 v[16:19], v30 offset:52224
    ds_read_b128 v[24:27], v30 offset:52736
    s_mov_b64 exec, -1
    v_exp_f32 v58, v58
    v_exp_f32 v59, v59
    v_exp_f32 v60, v60
    v_mfma_f32_32x32x16_bf16 v[104:119], v[140:143], v[132:135], v[104:119]
    buffer_load_dwordx4 v[140:143], v250, s[12:15], s69 offen offset:1024
    v_exp_f32 v61, v61
    v_exp_f32 v62, v62
    v_exp_f32 v63, v63
    v_exp_f32 v32, v32
    v_exp_f32 v33, v33
    v_smfmac_f32_32x32x32_bf16 v[0:15], v[20:23], v[56:63], v28
    s_setprio 2
    v_exp_f32 v34, v34
    v_exp_f32 v35, v35
    v_exp_f32 v36, v36
    s_waitcnt lgkmcnt(2)
    v_mfma_f32_32x32x16_bf16 v[48:63], v[84:87], v[80:83], v[64:79]
    ds_read_b128 v[84:87], v29 offset:55296
    v_exp_f32 v37, v37
    v_exp_f32 v38, v38
    v_exp_f32 v39, v39
    buffer_load_dwordx4 v[132:135], v250, s[12:15], s7 offen offset:1024
    v_exp_f32 v40, v40
    v_exp_f32 v41, v41
    s_waitcnt lgkmcnt(1)
    v_smfmac_f32_32x32x32_bf16 v[0:15], v[16:19], v[32:39], v28
    s_mov_b64 exec, s[4:5]
    ds_read_b128 v[16:19], v30 offset:54272
    ds_read_b128 v[20:23], v30 offset:54784
    s_mov_b64 exec, -1
    v_exp_f32 v42, v42
    v_exp_f32 v43, v43
    v_exp_f32 v44, v44
    s_add_u32 s32, s9, 0
    buffer_load_dwordx4 v[180:183], v250, s[12:15], s32 offen offset:0
    v_exp_f32 v45, v45
    v_exp_f32 v46, v46
    v_exp_f32 v47, v47
    v_exp_f32 v48, v48
    v_exp_f32 v49, v49
    v_smfmac_f32_32x32x32_bf16 v[0:15], v[24:27], v[40:47], v28
    s_setprio 1
    v_exp_f32 v50, v50
    v_exp_f32 v51, v51
    v_exp_f32 v52, v52
    s_waitcnt lgkmcnt(2)
    v_mfma_f32_32x32x16_bf16 v[32:47], v[84:87], v[80:83], v[64:79]
    ds_read_b128 v[84:87], v29 offset:57344
    v_exp_f32 v53, v53
    v_exp_f32 v54, v54
    v_exp_f32 v55, v55
    s_add_u32 s32, s9, 32768
    buffer_load_dwordx4 v[184:187], v250, s[12:15], s32 offen offset:0
    v_exp_f32 v56, v56
    v_exp_f32 v57, v57
    s_waitcnt lgkmcnt(1)
    v_smfmac_f32_32x32x32_bf16 v[0:15], v[16:19], v[48:55], v28
    s_mov_b64 exec, s[4:5]
    ds_read_b128 v[16:19], v30 offset:56320
    ds_read_b128 v[24:27], v30 offset:56832
    s_mov_b64 exec, -1
    v_exp_f32 v58, v58
    v_exp_f32 v59, v59
    s_add_u32 s32, s9, 0
    buffer_load_dwordx4 v[188:191], v250, s[12:15], s32 offen offset:1024
    v_exp_f32 v60, v60
    v_exp_f32 v61, v61
    s_add_u32 s32, s9, 32768
    buffer_load_dwordx4 v[192:195], v250, s[12:15], s32 offen offset:1024
    v_exp_f32 v62, v62
    v_exp_f32 v63, v63
    v_exp_f32 v32, v32
    v_exp_f32 v33, v33
    v_smfmac_f32_32x32x32_bf16 v[0:15], v[20:23], v[56:63], v28
    s_setprio 0
    v_exp_f32 v34, v34
    v_exp_f32 v35, v35
    v_exp_f32 v36, v36
    s_waitcnt lgkmcnt(2)
    v_mfma_f32_32x32x16_bf16 v[48:63], v[84:87], v[80:83], v[64:79]
    ds_read_b128 v[84:87], v29 offset:59392
    v_exp_f32 v37, v37
    v_exp_f32 v38, v38
    v_exp_f32 v39, v39
    s_add_u32 s32, s9, 0
    buffer_load_dwordx4 v[196:199], v250, s[12:15], s32 offen offset:2048
    v_exp_f32 v40, v40
    v_exp_f32 v41, v41
    s_waitcnt lgkmcnt(1)
    v_smfmac_f32_32x32x32_bf16 v[0:15], v[16:19], v[32:39], v28
    s_mov_b64 exec, s[4:5]
    ds_read_b128 v[16:19], v30 offset:58368
    ds_read_b128 v[20:23], v30 offset:58880
    s_mov_b64 exec, -1
    v_exp_f32 v42, v42
    v_exp_f32 v43, v43
    v_exp_f32 v44, v44
    s_add_u32 s32, s9, 32768
    buffer_load_dwordx4 v[200:203], v250, s[12:15], s32 offen offset:2048
    v_exp_f32 v45, v45
    v_exp_f32 v46, v46
    v_exp_f32 v47, v47
    v_add_u32 v29, 57344, v29
    v_add_u32 v30, 57344, v30
    v_exp_f32 v48, v48
    v_exp_f32 v49, v49
    v_smfmac_f32_32x32x32_bf16 v[0:15], v[24:27], v[40:47], v28
    s_setprio 3
    v_exp_f32 v50, v50
    v_exp_f32 v51, v51
    v_exp_f32 v52, v52
    s_waitcnt lgkmcnt(2)
    v_mfma_f32_32x32x16_bf16 v[32:47], v[84:87], v[80:83], v[64:79]
    ds_read_b128 v[84:87], v29 offset:4096
    v_exp_f32 v53, v53
    v_exp_f32 v54, v54
    v_exp_f32 v55, v55
    s_add_u32 s32, s9, 0
    buffer_load_dwordx4 v[204:207], v250, s[12:15], s32 offen offset:3072
    v_exp_f32 v56, v56
    v_exp_f32 v57, v57
    s_waitcnt lgkmcnt(1)
    v_smfmac_f32_32x32x32_bf16 v[0:15], v[16:19], v[48:55], v28
    s_mov_b64 exec, s[4:5]
    ds_read_b128 v[16:19], v30 offset:3072
    ds_read_b128 v[24:27], v30 offset:3584
    s_mov_b64 exec, -1
    v_exp_f32 v58, v58
    v_exp_f32 v59, v59
    v_exp_f32 v60, v60
    s_add_u32 s32, s9, 32768
    buffer_load_dwordx4 v[208:211], v250, s[12:15], s32 offen offset:3072
    v_exp_f32 v61, v61
    v_exp_f32 v62, v62
    v_exp_f32 v63, v63
    v_exp_f32 v32, v32
    v_exp_f32 v33, v33
    v_smfmac_f32_32x32x32_bf16 v[0:15], v[20:23], v[56:63], v28
    s_setprio 2
    v_exp_f32 v34, v34
    v_exp_f32 v35, v35
    v_exp_f32 v36, v36
    s_waitcnt lgkmcnt(2)
    v_mfma_f32_32x32x16_bf16 v[48:63], v[84:87], v[80:83], v[64:79]
    ds_read_b128 v[84:87], v29 offset:6144
    v_exp_f32 v37, v37
    v_exp_f32 v38, v38
    v_exp_f32 v39, v39
    s_add_u32 s32, s9, 4096
    buffer_load_dwordx4 v[212:215], v250, s[12:15], s32 offen offset:0
    v_exp_f32 v40, v40
    v_exp_f32 v41, v41
    s_waitcnt lgkmcnt(1)
    v_smfmac_f32_32x32x32_bf16 v[0:15], v[16:19], v[32:39], v28
    s_mov_b64 exec, s[4:5]
    ds_read_b128 v[16:19], v30 offset:5120
    ds_read_b128 v[20:23], v30 offset:5632
    s_mov_b64 exec, -1
    v_exp_f32 v42, v42
    v_exp_f32 v43, v43
    v_exp_f32 v44, v44
    s_add_u32 s32, s9, 36864
    buffer_load_dwordx4 v[216:219], v250, s[12:15], s32 offen offset:0
    v_exp_f32 v45, v45
    v_exp_f32 v46, v46
    v_exp_f32 v47, v47
    v_exp_f32 v48, v48
    v_exp_f32 v49, v49
    v_smfmac_f32_32x32x32_bf16 v[0:15], v[24:27], v[40:47], v28
    s_setprio 1
    v_exp_f32 v50, v50
    v_exp_f32 v51, v51
    v_exp_f32 v52, v52
    s_waitcnt lgkmcnt(2)
    v_mfma_f32_32x32x16_bf16 v[32:47], v[84:87], v[80:83], v[64:79]
    ds_read_b128 v[84:87], v29 offset:8192
    v_exp_f32 v53, v53
    v_exp_f32 v54, v54
    v_exp_f32 v55, v55
    s_add_u32 s32, s9, 4096
    buffer_load_dwordx4 v[220:223], v250, s[12:15], s32 offen offset:1024
    v_exp_f32 v56, v56
    v_exp_f32 v57, v57
    s_waitcnt lgkmcnt(1)
    v_smfmac_f32_32x32x32_bf16 v[0:15], v[16:19], v[48:55], v28
    s_mov_b64 exec, s[4:5]
    ds_read_b128 v[16:19], v30 offset:7168
    ds_read_b128 v[24:27], v30 offset:7680
    s_mov_b64 exec, -1
    v_exp_f32 v58, v58
    v_exp_f32 v59, v59
    s_add_u32 s32, s9, 36864
    buffer_load_dwordx4 v[224:227], v250, s[12:15], s32 offen offset:1024
    v_exp_f32 v60, v60
    v_exp_f32 v61, v61
    s_add_u32 s32, s9, 4096
    buffer_load_dwordx4 v[230:233], v250, s[12:15], s32 offen offset:2048
    v_exp_f32 v62, v62
    v_exp_f32 v63, v63
    v_exp_f32 v32, v32
    v_exp_f32 v33, v33
    v_smfmac_f32_32x32x32_bf16 v[0:15], v[20:23], v[56:63], v28
    s_setprio 0
    v_exp_f32 v34, v34
    v_exp_f32 v35, v35
    v_exp_f32 v36, v36
    s_waitcnt lgkmcnt(2)
    v_mfma_f32_32x32x16_bf16 v[48:63], v[84:87], v[80:83], v[64:79]
    ds_read_b128 v[84:87], v29 offset:10240
    v_exp_f32 v37, v37
    v_exp_f32 v38, v38
    v_exp_f32 v39, v39
    s_add_u32 s32, s9, 36864
    buffer_load_dwordx4 v[240:243], v250, s[12:15], s32 offen offset:2048
    v_exp_f32 v40, v40
    v_exp_f32 v41, v41
    s_waitcnt lgkmcnt(1)
    v_smfmac_f32_32x32x32_bf16 v[0:15], v[16:19], v[32:39], v28
    s_mov_b64 exec, s[4:5]
    ds_read_b128 v[16:19], v30 offset:9216
    ds_read_b128 v[20:23], v30 offset:9728
    s_mov_b64 exec, -1
    v_exp_f32 v42, v42
    v_exp_f32 v43, v43
    v_exp_f32 v44, v44
    s_add_u32 s32, s9, 4096
    buffer_load_dwordx4 v[252:255], v250, s[12:15], s32 offen offset:3072
    v_exp_f32 v45, v45
    v_exp_f32 v46, v46
    v_exp_f32 v47, v47
    v_exp_f32 v48, v48
    v_exp_f32 v49, v49
    v_smfmac_f32_32x32x32_bf16 v[0:15], v[24:27], v[40:47], v28
    s_setprio 3
    v_exp_f32 v50, v50
    v_exp_f32 v51, v51
    v_exp_f32 v52, v52
    s_waitcnt lgkmcnt(2)
    v_mfma_f32_32x32x16_bf16 v[32:47], v[84:87], v[80:83], v[64:79]
    ds_read_b128 v[84:87], v29 offset:12288
    v_exp_f32 v53, v53
    v_exp_f32 v54, v54
    v_exp_f32 v55, v55
    v_exp_f32 v56, v56
    v_exp_f32 v57, v57
    s_waitcnt lgkmcnt(1)
    v_smfmac_f32_32x32x32_bf16 v[0:15], v[16:19], v[48:55], v28
    s_mov_b64 exec, s[4:5]
    ds_read_b128 v[16:19], v30 offset:11264
    ds_read_b128 v[24:27], v30 offset:11776
    s_mov_b64 exec, -1
    v_exp_f32 v58, v58
    v_exp_f32 v59, v59
    v_exp_f32 v60, v60
    v_exp_f32 v61, v61
    v_exp_f32 v62, v62
    v_exp_f32 v63, v63
    v_exp_f32 v32, v32
    v_exp_f32 v33, v33
    v_smfmac_f32_32x32x32_bf16 v[0:15], v[20:23], v[56:63], v28
    s_setprio 2
    v_exp_f32 v34, v34
    v_exp_f32 v35, v35
    v_exp_f32 v36, v36
    s_waitcnt lgkmcnt(2)
    v_mfma_f32_32x32x16_bf16 v[48:63], v[84:87], v[80:83], v[64:79]
    ds_read_b128 v[84:87], v29 offset:14336
    v_exp_f32 v37, v37
    v_exp_f32 v38, v38
    v_exp_f32 v39, v39
    v_exp_f32 v40, v40
    v_exp_f32 v41, v41
    s_waitcnt lgkmcnt(1)
    v_smfmac_f32_32x32x32_bf16 v[0:15], v[16:19], v[32:39], v28
    s_mov_b64 exec, s[4:5]
    ds_read_b128 v[16:19], v30 offset:13312
    ds_read_b128 v[20:23], v30 offset:13824
    s_mov_b64 exec, -1
    v_exp_f32 v42, v42
    v_exp_f32 v43, v43
    v_exp_f32 v44, v44
    v_exp_f32 v45, v45
    v_exp_f32 v46, v46
    v_exp_f32 v47, v47
    v_exp_f32 v48, v48
    v_exp_f32 v49, v49
    v_smfmac_f32_32x32x32_bf16 v[0:15], v[24:27], v[40:47], v28
    s_setprio 1
    v_exp_f32 v50, v50
    v_exp_f32 v51, v51
    v_exp_f32 v52, v52
    s_waitcnt lgkmcnt(2)
    v_mfma_f32_32x32x16_bf16 v[32:47], v[84:87], v[80:83], v[64:79]
    ds_read_b128 v[84:87], v29 offset:16384
    v_exp_f32 v53, v53
    v_exp_f32 v54, v54
    v_exp_f32 v55, v55
    v_exp_f32 v56, v56
    v_exp_f32 v57, v57
    s_waitcnt lgkmcnt(1)
    v_smfmac_f32_32x32x32_bf16 v[0:15], v[16:19], v[48:55], v28
    s_mov_b64 exec, s[4:5]
    ds_read_b128 v[16:19], v30 offset:15360
    ds_read_b128 v[24:27], v30 offset:15872
    s_mov_b64 exec, -1
    v_exp_f32 v58, v58
    v_exp_f32 v59, v59
    v_exp_f32 v60, v60
    v_exp_f32 v61, v61
    v_exp_f32 v62, v62
    v_exp_f32 v63, v63
    v_exp_f32 v32, v32
    v_exp_f32 v33, v33
    v_smfmac_f32_32x32x32_bf16 v[0:15], v[20:23], v[56:63], v28
    s_setprio 0
    v_exp_f32 v34, v34
    v_exp_f32 v35, v35
    v_exp_f32 v36, v36
    s_waitcnt lgkmcnt(2)
    v_mfma_f32_32x32x16_bf16 v[48:63], v[84:87], v[80:83], v[64:79]
    ds_read_b128 v[84:87], v29 offset:18432
    v_exp_f32 v37, v37
    v_exp_f32 v38, v38
    v_exp_f32 v39, v39
    v_exp_f32 v40, v40
    v_exp_f32 v41, v41
    s_waitcnt lgkmcnt(1)
    v_smfmac_f32_32x32x32_bf16 v[0:15], v[16:19], v[32:39], v28
    s_mov_b64 exec, s[4:5]
    ds_read_b128 v[16:19], v30 offset:17408
    ds_read_b128 v[20:23], v30 offset:17920
    s_mov_b64 exec, -1
    v_exp_f32 v42, v42
    v_exp_f32 v43, v43
    v_exp_f32 v44, v44
    v_exp_f32 v45, v45
    v_exp_f32 v46, v46
    v_exp_f32 v47, v47
    s_nop 1
    s_nop 0
    v_smfmac_f32_32x32x32_bf16 v[0:15], v[24:27], v[40:47], v28
    s_nop 11
    s_setprio 0
    v_mov_b32 v238, 0x4e800000
    v_cmp_nle_f32 vcc, v8, v238
    s_nop 1
    s_cbranch_vccnz A_SLOW
A_FIN:
    v_rcp_f32 v238, v8
    s_nop 0
    v_mul_f32 v238, v238, v229
    v_mul_f32 v0, v0, v238
    v_mul_f32 v1, v1, v238
    v_mul_f32 v2, v2, v238
    v_mul_f32 v3, v3, v238
    v_mul_f32 v4, v4, v238
    v_mul_f32 v5, v5, v238
    v_mul_f32 v6, v6, v238
    v_mul_f32 v7, v7, v238
    v_cvt_pk_bf16_f32 v80, v0, v1
    v_cvt_pk_bf16_f32 v81, v2, v3
    v_cvt_pk_bf16_f32 v82, v4, v5
    v_cvt_pk_bf16_f32 v83, v6, v7
    v_min_u32 v80, -2, v80
    v_min_u32 v81, -2, v81
    v_min_u32 v82, -2, v82
    v_min_u32 v83, -2, v83
    buffer_store_dwordx4 v[80:83], v250, s[12:15], s8 offen sc1
    s_waitcnt lgkmcnt(0)
    s_add_u32 s32, s9, 36864
    buffer_load_dwordx4 v[0:3], v250, s[12:15], s32 offen offset:3072
    s_barrier
    s_add_u32 s32, s10, 4096
    buffer_load_dwordx4 v[32:35], v250, s[12:15], s10 offen offset:0 sc1
    buffer_load_dwordx4 v[36:39], v250, s[12:15], s10 offen offset:1024 sc1
    buffer_load_dwordx4 v[40:43], v250, s[12:15], s10 offen offset:2048 sc1
    buffer_load_dwordx4 v[44:47], v250, s[12:15], s10 offen offset:3072 sc1
    buffer_load_dwordx4 v[48:51], v250, s[12:15], s32 offen offset:0 sc1
    buffer_load_dwordx4 v[52:55], v250, s[12:15], s32 offen offset:1024 sc1
    buffer_load_dwordx4 v[56:59], v250, s[12:15], s32 offen offset:2048 sc1
    buffer_load_dwordx4 v[60:63], v250, s[12:15], s32 offen offset:3072 sc1
    v_sub_f32 v72, 1.0, v228
    v_mov_b32 v64, v228
    v_mov_b32 v65, v228
    v_mov_b32 v73, v72
    s_waitcnt vmcnt(37)
    v_mfma_f32_32x32x16_bf16 v[88:103], v[148:151], v[144:147], v[88:103]
    v_mfma_f32_32x32x16_bf16 v[104:119], v[152:155], v[144:147], v[104:119]
    s_waitcnt vmcnt(34)
    v_mfma_f32_32x32x16_bf16 v[88:103], v[160:163], v[156:159], v[88:103]
    v_mfma_f32_32x32x16_bf16 v[104:119], v[164:167], v[156:159], v[104:119]
    s_waitcnt vmcnt(31)
    v_mfma_f32_32x32x16_bf16 v[88:103], v[172:175], v[168:171], v[88:103]
    v_mfma_f32_32x32x16_bf16 v[104:119], v[176:179], v[168:171], v[104:119]
    s_waitcnt vmcnt(28)
    s_cmp_eq_u32 s11, 3
    s_cbranch_scc1 A_SK20_0
    v_mfma_f32_32x32x16_bf16 v[88:103], v[124:127], v[120:123], v[88:103]
A_SK20_0:
    s_cmp_eq_u32 s11, 3
    s_cbranch_scc1 A_SK20_1
    v_mfma_f32_32x32x16_bf16 v[104:119], v[128:131], v[120:123], v[104:119]
A_SK20_1:
    s_waitcnt vmcnt(25)
    s_cmp_eq_u32 s11, 3
    s_cbranch_scc1 A_SK21_0
    v_mfma_f32_32x32x16_bf16 v[88:103], v[136:139], v[132:135], v[88:103]
A_SK21_0:
    s_cmp_eq_u32 s11, 3
    s_cbranch_scc1 A_SK21_1
    v_mfma_f32_32x32x16_bf16 v[104:119], v[140:143], v[132:135], v[104:119]
A_SK21_1:
    s_nop 9
    v_pk_mul_f32 v[88:89], v[88:89], v[72:73]
    v_pk_mul_f32 v[90:91], v[90:91], v[72:73]
    v_pk_mul_f32 v[92:93], v[92:93], v[72:73]
    v_pk_mul_f32 v[94:95], v[94:95], v[72:73]
    v_pk_mul_f32 v[96:97], v[96:97], v[72:73]
    v_pk_mul_f32 v[98:99], v[98:99], v[72:73]
    v_pk_mul_f32 v[100:101], v[100:101], v[72:73]
    v_pk_mul_f32 v[102:103], v[102:103], v[72:73]
    s_nop 1
    v_pk_mul_f32 v[104:105], v[104:105], v[72:73]
    v_pk_mul_f32 v[106:107], v[106:107], v[72:73]
    v_pk_mul_f32 v[108:109], v[108:109], v[72:73]
    v_pk_mul_f32 v[110:111], v[110:111], v[72:73]
    v_pk_mul_f32 v[112:113], v[112:113], v[72:73]
    v_pk_mul_f32 v[114:115], v[114:115], v[72:73]
    v_pk_mul_f32 v[116:117], v[116:117], v[72:73]
    v_pk_mul_f32 v[118:119], v[118:119], v[72:73]
    s_mov_b32 s68, 20000
    s_mov_b32 s34, 0
    s_waitcnt vmcnt(7)
    v_max3_u32 v74, v32, v33, v34
    v_max_u32 v74, v74, v35
    v_cmp_eq_u32 s[36:37], -1, v74
    s_waitcnt vmcnt(6)
    v_max3_u32 v75, v36, v37, v38
    v_max_u32 v75, v75, v39
    v_cmp_eq_u32 s[38:39], -1, v75
    s_cmp_lg_u64 s[36:37], 0
    s_cbranch_scc1 A_U0
    v_mfma_f32_32x32x16_bf16 v[88:103], v[180:183], v[32:35], v[88:103]
    v_mfma_f32_32x32x16_bf16 v[104:119], v[184:187], v[32:35], v[104:119]
    s_bitset1_b32 s34, 0
A_U0:
    s_waitcnt vmcnt(5)
    v_max3_u32 v76, v40, v41, v42
    v_max_u32 v76, v76, v43
    v_cmp_eq_u32 s[40:41], -1, v76
    s_cmp_lg_u64 s[38:39], 0
    s_cbranch_scc1 A_U1
    v_mfma_f32_32x32x16_bf16 v[88:103], v[188:191], v[36:39], v[88:103]
    v_mfma_f32_32x32x16_bf16 v[104:119], v[192:195], v[36:39], v[104:119]
    s_bitset1_b32 s34, 1
A_U1:
    s_waitcnt vmcnt(4)
    v_max3_u32 v77, v44, v45, v46
    v_max_u32 v77, v77, v47
    v_cmp_eq_u32 s[42:43], -1, v77
    s_cmp_lg_u64 s[40:41], 0
    s_cbranch_scc1 A_U2
    v_mfma_f32_32x32x16_bf16 v[88:103], v[196:199], v[40:43], v[88:103]
    v_mfma_f32_32x32x16_bf16 v[104:119], v[200:203], v[40:43], v[104:119]
    s_bitset1_b32 s34, 2
A_U2:
    s_waitcnt vmcnt(3)
    v_max3_u32 v78, v48, v49, v50
    v_max_u32 v78, v78, v51
    v_cmp_eq_u32 s[48:49], -1, v78
    s_cmp_lg_u64 s[42:43], 0
    s_cbranch_scc1 A_U3
    v_mfma_f32_32x32x16_bf16 v[88:103], v[204:207], v[44:47], v[88:103]
    v_mfma_f32_32x32x16_bf16 v[104:119], v[208:211], v[44:47], v[104:119]
    s_bitset1_b32 s34, 3
A_U3:
    s_waitcnt vmcnt(2)
    v_max3_u32 v79, v52, v53, v54
    v_max_u32 v79, v79, v55
    v_cmp_eq_u32 s[50:51], -1, v79
    s_cmp_lg_u64 s[48:49], 0
    s_cbranch_scc1 A_U4
    v_mfma_f32_32x32x16_bf16 v[88:103], v[212:215], v[48:51], v[88:103]
    v_mfma_f32_32x32x16_bf16 v[104:119], v[216:219], v[48:51], v[104:119]
    s_bitset1_b32 s34, 4
A_U4:
    s_waitcnt vmcnt(1)
    v_max3_u32 v80, v56, v57, v58
    v_max_u32 v80, v80, v59
    v_cmp_eq_u32 s[52:53], -1, v80
    s_cmp_lg_u64 s[50:51], 0
    s_cbranch_scc1 A_U5
    v_mfma_f32_32x32x16_bf16 v[88:103], v[220:223], v[52:55], v[88:103]
    v_mfma_f32_32x32x16_bf16 v[104:119], v[224:227], v[52:55], v[104:119]
    s_bitset1_b32 s34, 5
A_U5:
    s_waitcnt vmcnt(0)
    v_max3_u32 v81, v60, v61, v62
    v_max_u32 v81, v81, v63
    v_cmp_eq_u32 s[54:55], -1, v81
    s_cmp_lg_u64 s[52:53], 0
    s_cbranch_scc1 A_U6
    v_mfma_f32_32x32x16_bf16 v[88:103], v[230:233], v[56:59], v[88:103]
    v_mfma_f32_32x32x16_bf16 v[104:119], v[240:243], v[56:59], v[104:119]
    s_bitset1_b32 s34, 6
A_U6:
    s_cmp_lg_u64 s[54:55], 0
    s_cbranch_scc1 A_U7
    v_mfma_f32_32x32x16_bf16 v[88:103], v[252:255], v[60:63], v[88:103]
    v_mfma_f32_32x32x16_bf16 v[104:119], v[0:3], v[60:63], v[104:119]
    s_bitset1_b32 s34, 7
A_U7:
A_PO:
    s_cmp_eq_u32 s34, 255
    s_cbranch_scc1 A_POK
    s_sub_u32 s68, s68, 1
    s_cbranch_scc1 A_POK
    s_mov_b32 s33, s34
    s_bitcmp1_b32 s33, 0
    s_cbranch_scc1 A_L0
    buffer_load_dwordx4 v[32:35], v250, s[12:15], s10 offen offset:0 sc1
A_L0:
    s_bitcmp1_b32 s33, 1
    s_cbranch_scc1 A_L1
    buffer_load_dwordx4 v[36:39], v250, s[12:15], s10 offen offset:1024 sc1
A_L1:
    s_bitcmp1_b32 s33, 2
    s_cbranch_scc1 A_L2
    buffer_load_dwordx4 v[40:43], v250, s[12:15], s10 offen offset:2048 sc1
A_L2:
    s_bitcmp1_b32 s33, 3
    s_cbranch_scc1 A_L3
    buffer_load_dwordx4 v[44:47], v250, s[12:15], s10 offen offset:3072 sc1
A_L3:
    s_bitcmp1_b32 s33, 4
    s_cbranch_scc1 A_L4
    buffer_load_dwordx4 v[48:51], v250, s[12:15], s32 offen offset:0 sc1
A_L4:
    s_bitcmp1_b32 s33, 5
    s_cbranch_scc1 A_L5
    buffer_load_dwordx4 v[52:55], v250, s[12:15], s32 offen offset:1024 sc1
A_L5:
    s_bitcmp1_b32 s33, 6
    s_cbranch_scc1 A_L6
    buffer_load_dwordx4 v[56:59], v250, s[12:15], s32 offen offset:2048 sc1
A_L6:
    s_bitcmp1_b32 s33, 7
    s_cbranch_scc1 A_L7
    buffer_load_dwordx4 v[60:63], v250, s[12:15], s32 offen offset:3072 sc1
A_L7:
    s_waitcnt vmcnt(0)
    v_max3_u32 v74, v32, v33, v34
    v_max_u32 v74, v74, v35
    v_cmp_eq_u32 s[36:37], -1, v74
    v_max3_u32 v75, v36, v37, v38
    v_max_u32 v75, v75, v39
    v_cmp_eq_u32 s[38:39], -1, v75
    v_max3_u32 v76, v40, v41, v42
    v_max_u32 v76, v76, v43
    v_cmp_eq_u32 s[40:41], -1, v76
    v_max3_u32 v77, v44, v45, v46
    v_max_u32 v77, v77, v47
    v_cmp_eq_u32 s[42:43], -1, v77
    v_max3_u32 v78, v48, v49, v50
    v_max_u32 v78, v78, v51
    v_cmp_eq_u32 s[48:49], -1, v78
    v_max3_u32 v79, v52, v53, v54
    v_max_u32 v79, v79, v55
    v_cmp_eq_u32 s[50:51], -1, v79
    v_max3_u32 v80, v56, v57, v58
    v_max_u32 v80, v80, v59
    v_cmp_eq_u32 s[52:53], -1, v80
    v_max3_u32 v81, v60, v61, v62
    v_max_u32 v81, v81, v63
    v_cmp_eq_u32 s[54:55], -1, v81
    s_bitcmp1_b32 s33, 0
    s_cbranch_scc1 A_V0
    s_cmp_lg_u64 s[36:37], 0
    s_cbranch_scc1 A_V0
    v_mfma_f32_32x32x16_bf16 v[88:103], v[180:183], v[32:35], v[88:103]
    v_mfma_f32_32x32x16_bf16 v[104:119], v[184:187], v[32:35], v[104:119]
    s_bitset1_b32 s34, 0
A_V0:
    s_bitcmp1_b32 s33, 1
    s_cbranch_scc1 A_V1
    s_cmp_lg_u64 s[38:39], 0
    s_cbranch_scc1 A_V1
    v_mfma_f32_32x32x16_bf16 v[88:103], v[188:191], v[36:39], v[88:103]
    v_mfma_f32_32x32x16_bf16 v[104:119], v[192:195], v[36:39], v[104:119]
    s_bitset1_b32 s34, 1
A_V1:
    s_bitcmp1_b32 s33, 2
    s_cbranch_scc1 A_V2
    s_cmp_lg_u64 s[40:41], 0
    s_cbranch_scc1 A_V2
    v_mfma_f32_32x32x16_bf16 v[88:103], v[196:199], v[40:43], v[88:103]
    v_mfma_f32_32x32x16_bf16 v[104:119], v[200:203], v[40:43], v[104:119]
    s_bitset1_b32 s34, 2
A_V2:
    s_bitcmp1_b32 s33, 3
    s_cbranch_scc1 A_V3
    s_cmp_lg_u64 s[42:43], 0
    s_cbranch_scc1 A_V3
    v_mfma_f32_32x32x16_bf16 v[88:103], v[204:207], v[44:47], v[88:103]
    v_mfma_f32_32x32x16_bf16 v[104:119], v[208:211], v[44:47], v[104:119]
    s_bitset1_b32 s34, 3
A_V3:
    s_bitcmp1_b32 s33, 4
    s_cbranch_scc1 A_V4
    s_cmp_lg_u64 s[48:49], 0
    s_cbranch_scc1 A_V4
    v_mfma_f32_32x32x16_bf16 v[88:103], v[212:215], v[48:51], v[88:103]
    v_mfma_f32_32x32x16_bf16 v[104:119], v[216:219], v[48:51], v[104:119]
    s_bitset1_b32 s34, 4
A_V4:
    s_bitcmp1_b32 s33, 5
    s_cbranch_scc1 A_V5
    s_cmp_lg_u64 s[50:51], 0
    s_cbranch_scc1 A_V5
    v_mfma_f32_32x32x16_bf16 v[88:103], v[220:223], v[52:55], v[88:103]
    v_mfma_f32_32x32x16_bf16 v[104:119], v[224:227], v[52:55], v[104:119]
    s_bitset1_b32 s34, 5
A_V5:
    s_bitcmp1_b32 s33, 6
    s_cbranch_scc1 A_V6
    s_cmp_lg_u64 s[52:53], 0
    s_cbranch_scc1 A_V6
    v_mfma_f32_32x32x16_bf16 v[88:103], v[230:233], v[56:59], v[88:103]
    v_mfma_f32_32x32x16_bf16 v[104:119], v[240:243], v[56:59], v[104:119]
    s_bitset1_b32 s34, 6
A_V6:
    s_bitcmp1_b32 s33, 7
    s_cbranch_scc1 A_V7
    s_cmp_lg_u64 s[54:55], 0
    s_cbranch_scc1 A_V7
    v_mfma_f32_32x32x16_bf16 v[88:103], v[252:255], v[60:63], v[88:103]
    v_mfma_f32_32x32x16_bf16 v[104:119], v[0:3], v[60:63], v[104:119]
    s_bitset1_b32 s34, 7
A_V7:
    s_branch A_PO
A_POK:
    s_and_b32 s32, s24, 1
    s_lshl_b32 s32, s32, 13
    s_lshl_b32 s33, s11, 11
    s_add_u32 s32, s32, s33
    v_add_u32 v238, s32, v250
    s_lshl_b32 s32, s24, 13
    v_add_u32 v239, s32, v250
    s_nop 11
    ds_write_b128 v238, v[88:91] offset:0
    ds_write_b128 v238, v[92:95] offset:1024
    ds_write_b128 v238, v[96:99] offset:16384
    ds_write_b128 v238, v[100:103] offset:17408
    s_nop 1
    ds_write_b128 v238, v[104:107] offset:32768
    ds_write_b128 v238, v[108:111] offset:33792
    ds_write_b128 v238, v[112:115] offset:49152
    ds_write_b128 v238, v[116:119] offset:50176
    s_waitcnt lgkmcnt(0)
    s_barrier
    ds_read_b128 v[32:35], v239 offset:0
    ds_read_b128 v[36:39], v239 offset:1024
    ds_read_b128 v[40:43], v239 offset:2048
    ds_read_b128 v[44:47], v239 offset:3072
    ds_read_b128 v[48:51], v239 offset:4096
    ds_read_b128 v[52:55], v239 offset:5120
    ds_read_b128 v[56:59], v239 offset:6144
    ds_read_b128 v[60:63], v239 offset:7168
    s_waitcnt lgkmcnt(4)
    v_pk_add_f32 v[32:33], v[32:33], v[40:41]
    v_pk_add_f32 v[34:35], v[34:35], v[42:43]
    v_pk_add_f32 v[36:37], v[36:37], v[44:45]
    v_pk_add_f32 v[38:39], v[38:39], v[46:47]
    s_waitcnt lgkmcnt(0)
    v_pk_add_f32 v[48:49], v[48:49], v[56:57]
    v_pk_add_f32 v[50:51], v[50:51], v[58:59]
    v_pk_add_f32 v[52:53], v[52:53], v[60:61]
    v_pk_add_f32 v[54:55], v[54:55], v[62:63]
    v_pk_add_f32 v[32:33], v[32:33], v[48:49]
    v_pk_add_f32 v[34:35], v[34:35], v[50:51]
    v_pk_add_f32 v[36:37], v[36:37], v[52:53]
    v_pk_add_f32 v[38:39], v[38:39], v[54:55]
    v_cvt_pk_bf16_f32 v80, v32, v33
    v_cvt_pk_bf16_f32 v81, v34, v35
    v_cvt_pk_bf16_f32 v82, v36, v37
    v_cvt_pk_bf16_f32 v83, v38, v39
    s_nop 1
    v_permlane32_swap_b32 v80, v82
    v_permlane32_swap_b32 v81, v83
    buffer_store_dwordx4 v[80:83], v235, s[20:23], s63 offen nt
K_END:
    s_endpgm
A_SLOW:
    s_waitcnt lgkmcnt(0)
    v_mov_b32 v29, v250
    v_mov_b32 v31, 0xff800000
    s_mov_b32 s68, 64
A_SLOW1:
    ds_read_b128 v[84:87], v29
    v_add_u32 v29, 2048, v29
    s_waitcnt lgkmcnt(0)
    v_mfma_f32_32x32x16_bf16 v[48:63], v[84:87], v[80:83], 0
    s_nop 11
    v_max3_f32 v31, v31, v48, v49
    v_max3_f32 v31, v31, v50, v51
    v_max3_f32 v31, v31, v52, v53
    v_max3_f32 v31, v31, v54, v55
    v_max3_f32 v31, v31, v56, v57
    v_max3_f32 v31, v31, v58, v59
    v_max3_f32 v31, v31, v60, v61
    v_max3_f32 v31, v31, v62, v63
    s_sub_u32 s68, s68, 1
    s_cmp_lg_u32 s68, 0
    s_cbranch_scc1 A_SLOW1
    v_mov_b32 v238, v31
    s_nop 1
    v_permlane32_swap_b32 v238, v31
    s_nop 1
    v_max_f32 v31, v31, v238
    v_sub_f32 v64, 0, v31
    v_sub_f32 v65, 0, v31
    v_sub_f32 v66, 0, v31
    v_sub_f32 v67, 0, v31
    v_sub_f32 v68, 0, v31
    v_sub_f32 v69, 0, v31
    v_sub_f32 v70, 0, v31
    v_sub_f32 v71, 0, v31
    v_sub_f32 v72, 0, v31
    v_sub_f32 v73, 0, v31
    v_sub_f32 v74, 0, v31
    v_sub_f32 v75, 0, v31
    v_sub_f32 v76, 0, v31
    v_sub_f32 v77, 0, v31
    v_sub_f32 v78, 0, v31
    v_sub_f32 v79, 0, v31
    s_nop 1
    v_mov_b32 v29, v250
    v_subrev_u32 v30, 114688, v30
    v_mov_b32 v0, 0
    v_mov_b32 v1, 0
    v_mov_b32 v2, 0
    v_mov_b32 v3, 0
    v_mov_b32 v4, 0
    v_mov_b32 v5, 0
    v_mov_b32 v6, 0
    v_mov_b32 v7, 0
    v_mov_b32 v8, 0
    v_mov_b32 v9, 0
    v_mov_b32 v10, 0
    v_mov_b32 v11, 0
    v_mov_b32 v12, 0
    v_mov_b32 v13, 0
    v_mov_b32 v14, 0
    v_mov_b32 v15, 0
    v_mov_b32 v40, 0
    v_mov_b32 v41, 0
    v_mov_b32 v42, 0
    v_mov_b32 v43, 0
    v_mov_b32 v44, 0
    v_mov_b32 v45, 0
    v_mov_b32 v46, 0
    v_mov_b32 v47, 0
    s_mov_b64 exec, s[4:5]
    v_mov_b32 v24, 0
    v_mov_b32 v25, 0
    v_mov_b32 v26, 0
    v_mov_b32 v27, 0
    s_mov_b64 exec, -1
    ds_read_b128 v[84:87], v29
    s_waitcnt lgkmcnt(0)
    v_mfma_f32_32x32x16_bf16 v[48:63], v[84:87], v[80:83], v[64:79]
    ds_read_b128 v[84:87], v29 offset:2048
    s_mov_b64 exec, s[4:5]
    ds_read_b128 v[16:19], v30 offset:1024
    ds_read_b128 v[20:23], v30 offset:1536
    s_mov_b64 exec, -1
    s_nop 6
    s_mov_b32 s68, 16
A_SLOW2:
    v_exp_f32 v48, v48
    v_exp_f32 v49, v49
    v_smfmac_f32_32x32x32_bf16 v[0:15], v[24:27], v[40:47], v28
    s_setprio 3
    v_exp_f32 v50, v50
    v_exp_f32 v51, v51
    v_exp_f32 v52, v52
    s_waitcnt lgkmcnt(2)
    v_mfma_f32_32x32x16_bf16 v[32:47], v[84:87], v[80:83], v[64:79]
    ds_read_b128 v[84:87], v29 offset:4096
    v_exp_f32 v53, v53
    v_exp_f32 v54, v54
    v_exp_f32 v55, v55
    v_exp_f32 v56, v56
    v_exp_f32 v57, v57
    s_waitcnt lgkmcnt(1)
    v_smfmac_f32_32x32x32_bf16 v[0:15], v[16:19], v[48:55], v28
    s_mov_b64 exec, s[4:5]
    ds_read_b128 v[16:19], v30 offset:3072
    ds_read_b128 v[24:27], v30 offset:3584
    s_mov_b64 exec, -1
    v_exp_f32 v58, v58
    v_exp_f32 v59, v59
    v_exp_f32 v60, v60
    v_exp_f32 v61, v61
    v_exp_f32 v62, v62
    v_exp_f32 v63, v63
    v_exp_f32 v32, v32
    v_exp_f32 v33, v33
    v_smfmac_f32_32x32x32_bf16 v[0:15], v[20:23], v[56:63], v28
    s_setprio 2
    v_exp_f32 v34, v34
    v_exp_f32 v35, v35
    v_exp_f32 v36, v36
    s_waitcnt lgkmcnt(2)
    v_mfma_f32_32x32x16_bf16 v[48:63], v[84:87], v[80:83], v[64:79]
    ds_read_b128 v[84:87], v29 offset:6144
    v_exp_f32 v37, v37
    v_exp_f32 v38, v38
    v_exp_f32 v39, v39
    v_exp_f32 v40, v40
    v_exp_f32 v41, v41
    s_waitcnt lgkmcnt(1)
    v_smfmac_f32_32x32x32_bf16 v[0:15], v[16:19], v[32:39], v28
    s_mov_b64 exec, s[4:5]
    ds_read_b128 v[16:19], v30 offset:5120
    ds_read_b128 v[20:23], v30 offset:5632
    s_mov_b64 exec, -1
    v_exp_f32 v42, v42
    v_exp_f32 v43, v43
    v_exp_f32 v44, v44
    v_exp_f32 v45, v45
    v_exp_f32 v46, v46
    v_exp_f32 v47, v47
    v_exp_f32 v48, v48
    v_exp_f32 v49, v49
    v_smfmac_f32_32x32x32_bf16 v[0:15], v[24:27], v[40:47], v28
    s_setprio 1
    v_exp_f32 v50, v50
    v_exp_f32 v51, v51
    v_exp_f32 v52, v52
    s_waitcnt lgkmcnt(2)
    v_mfma_f32_32x32x16_bf16 v[32:47], v[84:87], v[80:83], v[64:79]
    ds_read_b128 v[84:87], v29 offset:8192
    v_exp_f32 v53, v53
    v_exp_f32 v54, v54
    v_exp_f32 v55, v55
    v_exp_f32 v56, v56
    v_exp_f32 v57, v57
    s_waitcnt lgkmcnt(1)
    v_smfmac_f32_32x32x32_bf16 v[0:15], v[16:19], v[48:55], v28
    s_mov_b64 exec, s[4:5]
    ds_read_b128 v[16:19], v30 offset:7168
    ds_read_b128 v[24:27], v30 offset:7680
    s_mov_b64 exec, -1
    v_exp_f32 v58, v58
    v_exp_f32 v59, v59
    v_exp_f32 v60, v60
    v_exp_f32 v61, v61
    v_exp_f32 v62, v62
    v_exp_f32 v63, v63
    v_exp_f32 v32, v32
    v_exp_f32 v33, v33
    v_smfmac_f32_32x32x32_bf16 v[0:15], v[20:23], v[56:63], v28
    s_setprio 0
    v_exp_f32 v34, v34
    v_exp_f32 v35, v35
    v_exp_f32 v36, v36
    s_waitcnt lgkmcnt(2)
    v_mfma_f32_32x32x16_bf16 v[48:63], v[84:87], v[80:83], v[64:79]
    ds_read_b128 v[84:87], v29 offset:10240
    v_exp_f32 v37, v37
    v_exp_f32 v38, v38
    v_exp_f32 v39, v39
    v_exp_f32 v40, v40
    v_exp_f32 v41, v41
    s_waitcnt lgkmcnt(1)
    v_smfmac_f32_32x32x32_bf16 v[0:15], v[16:19], v[32:39], v28
    s_mov_b64 exec, s[4:5]
    ds_read_b128 v[16:19], v30 offset:9216
    ds_read_b128 v[20:23], v30 offset:9728
    s_mov_b64 exec, -1
    v_exp_f32 v42, v42
    v_exp_f32 v43, v43
    v_exp_f32 v44, v44
    v_exp_f32 v45, v45
    v_exp_f32 v46, v46
    v_exp_f32 v47, v47
    v_add_u32 v29, 8192, v29
    v_add_u32 v30, 8192, v30
    s_sub_u32 s68, s68, 1
    s_cmp_lg_u32 s68, 0
    s_cbranch_scc1 A_SLOW2
    s_nop 0
    v_smfmac_f32_32x32x32_bf16 v[0:15], v[24:27], v[40:47], v28
    s_nop 11
    s_branch A_FIN
K_LAST:
.section .rodata,"a"
.p2align 6
.amdhsa_kernel gated_mix__softmax_full_mha__geglu_ffn__prompt_kernel
  .amdhsa_next_free_vgpr 256
  .amdhsa_next_free_sgpr 102
  .amdhsa_accum_offset 256
  .amdhsa_group_segment_fixed_size 0
  .amdhsa_kernarg_size 88
  .amdhsa_user_sgpr_count 2
  .amdhsa_user_sgpr_kernarg_segment_ptr 1
  .amdhsa_system_sgpr_workgroup_id_x 1
.end_amdhsa_kernel
```
